```python
import torch

def _softmax(x, axis=-1):
    return torch.softmax(x, dim=axis)
def _gelu(x):
    return torch.nn.functional.gelu(x, approximate="tanh")
def _silu(x):
    return torch.nn.functional.silu(x)
def _sigmoid(x):
    return torch.sigmoid(x)
def _layernorm(x, axis=-1, eps=1e-5):
    m = x.mean(dim=axis, keepdim=True)
    v = x.var(dim=axis, keepdim=True, unbiased=False)
    return (x - m) / torch.sqrt(v + eps)
def _scatter_add(tgt, idx, src, axis=0):
    return tgt.clone().index_add_(axis, idx, src)
def _segment_sum(src, seg, n):
    out = torch.zeros((n,) + src.shape[1:], dtype=src.dtype)
    return out.index_add_(0, seg, src)
def _pad(x, pw):
    flat = tuple(v for pair in reversed(pw) for v in pair)
    return torch.nn.functional.pad(x, flat)

kernel_name = 'concat_heads__linear_attn_block__linear_kernel_hedgehog__prompt'

def setup_inputs():

    _w = (lambda a: (lambda t: t.to(torch.bfloat16) if t.is_floating_point() else t)(torch.as_tensor(a)))
    def _A_setup():
        B, S, D = 1, 2048, 576
        return {
            "x": _w((lambda *s: torch.randn(*s, dtype=torch.bfloat16) * 0.05)(B, S, D)),
            "wqkv": _w((lambda *s: torch.randn(*s, dtype=torch.bfloat16) * 0.8)(D, 3 * D)),
            "wo": _w((lambda *s: torch.randn(*s, dtype=torch.bfloat16) * 0.2)(D, D)),
        }
    _A_in = _A_setup()

    def _B_setup():
        B, S, D, H = 1, 2048, 576, 32
        Dh = D // H
        return {
            "x": _w((lambda *s: torch.randn(*s, dtype=torch.bfloat16) * 0.4)(B, S, D)),
            "wqkv": _w((lambda *s: torch.randn(*s, dtype=torch.bfloat16) * 0.4)(D, 3 * D)),
            "w_phi": _w((lambda *s: torch.randn(*s, dtype=torch.bfloat16) * 0.4)(H, Dh, Dh) * (Dh ** -0.5)),
            "wo": _w((lambda *s: torch.randn(*s, dtype=torch.bfloat16) * 0.05)(D, D)),
        }
    _B_in = _B_setup()

    return {
        "A_x": _A_in["x"],
        "A_wqkv": _A_in["wqkv"],
        "A_wo": _A_in["wo"],
        "B_x": _B_in["x"],
        "B_wqkv": _B_in["wqkv"],
        "B_w_phi": _B_in["w_phi"],
        "B_wo": _B_in["wo"],
    }

def reference(A_x, A_wqkv, A_wo, B_x, B_wqkv, B_w_phi, B_wo):
    def _A_ref(x, wqkv, wo):
        B, S, D = x.shape
        H = 32; Dh = D // H
        qkv = (lambda x, *d: x.permute(*d))((x @ wqkv).reshape(B, S, 3, H, Dh), 2, 0, 3, 1, 4)
        q, k, v = qkv[0], qkv[1], qkv[2]
        phi = lambda t: torch.where(t > 0, t + 1, torch.exp(t)) + 1e-6
        pq, pk = phi(q), phi(k)
        kv = torch.einsum("bhsd,bhse->bhde", pk, v)
        z = torch.einsum("bhsd->bhd", pk)
        num = torch.einsum("bhqd,bhde->bhqe", pq, kv)
        den = torch.einsum("bhqd,bhd->bhq", pq, z)[..., None] + 1e-6
        o = num / den
        return (lambda x, *d: x.permute(*d))(o, 0, 2, 1, 3).reshape(B, S, D) @ wo

    def _B_ref(x, wqkv, w_phi, wo):
        B, S, D = x.shape
        H = 32; Dh = D // H
        qkv = (lambda x, *d: x.permute(*d))((x @ wqkv).reshape(B, S, 3, H, Dh), 2, 0, 3, 1, 4)
        q, k, v = qkv[0], qkv[1], qkv[2]
        pq = torch.einsum("bhsd,hdf->bhsf", q, w_phi)
        pk = torch.einsum("bhsd,hdf->bhsf", k, w_phi)
        phi_q = torch.concatenate([_softmax(pq, axis=-1), _softmax(-pq, axis=-1)], axis=-1)
        phi_k = torch.concatenate([_softmax(pk, axis=-1), _softmax(-pk, axis=-1)], axis=-1)
        kv = torch.einsum("bhsf,bhsd->bhfd", phi_k, v)
        z  = torch.einsum("bhsf->bhf", phi_k)
        num = torch.einsum("bhqf,bhfd->bhqd", phi_q, kv)
        den = torch.einsum("bhqf,bhf->bhq", phi_q, z)[..., None] + 1e-6
        o = num / den
        return (lambda x, *d: x.permute(*d))(o, 0, 2, 1, 3).reshape(B, S, D) @ wo

    a = _A_ref(A_x, A_wqkv, A_wo)
    b = _B_ref(B_x, B_wqkv, B_w_phi, B_wo)
    return torch.concatenate([a, b], axis=-1)
```

```asm
; @launch grid=(256,1,1) block=(256,1,1) lds=163840
.amdgcn_target "amdgcn-amd-amdhsa--gfx950"
.text
.globl concat_heads__linear_attn_block__linear_kernel_hedgehog__prompt_kernel
.p2align 12
.p2align 8
.type concat_heads__linear_attn_block__linear_kernel_hedgehog__prompt_kernel,@function
.set CODE_SPAN, (L_last - concat_heads__linear_attn_block__linear_kernel_hedgehog__prompt_kernel - 1024) & 0xffffff80
.set HEAD_LINES, ((L_tailB - concat_heads__linear_attn_block__linear_kernel_hedgehog__prompt_kernel) >> 7) + 8
.set A_SHIFT, (L_tailA - L_tailB - 3072) & 0xffffff80
concat_heads__linear_attn_block__linear_kernel_hedgehog__prompt_kernel:
  s_load_dwordx2 s[48:49], s[0:1], 40
  s_load_dwordx2 s[36:37], s[0:1], 72
  s_add_u32 s62, s2, 1
  s_and_b32 s62, s62, 6
  s_cselect_b32 s62, 0, 7
  s_xor_b32 s2, s2, s62
  s_bfe_u32 s52, s2, 65538
  s_cselect_b32 s62, 0, 24
  s_load_dwordx4 s[4:7], s[0:1], s62
  s_cselect_b32 s64, 16, 48
  s_cmp_ge_u32 s2, 256
  s_cbranch_scc1 L_end
  v_readfirstlane_b32 s55, v0
  v_lshrrev_b32 v5, 5, v0
  v_and_b32 v0, 63, v0
  s_and_b32 s62, s2, 3
  s_lshr_b32 s63, s2, 6
  s_bfe_u32 s54, s2, 196611
  s_lshr_b32 s55, s55, 6
  s_lshl2_add_u32 s53, s62, s63
  s_add_u32 s63, s54, s63
  s_lshl1_add_u32 s63, s63, 131072
  s_bfe_u32 s63, 9586980, s63
  s_min_u32 s62, s62, 2
  s_mul_i32 s63, s63, 3
  s_add_u32 s67, s63, s62
  s_lshl2_add_u32 s66, s53, s55
  s_mul_i32 s57, s66, 288
  s_add_u32 s57, s57, s67
  s_lshl_b32 s57, s57, 7
  s_lshl_b32 s60, s55, 12
  s_mov_b32 m0, s60
  s_movk_i32 s59, 1152
  v_lshrrev_b32 v1, 3, v0
  v_mul_u32_u24 v1, s59, v1
  v_lshrrev_b32 v47, 4, v0
  v_and_b32 v2, 7, v0
  v_xor_b32 v2, v2, v47
  v_lshl_add_u32 v10, v2, 4, v1
  v_xor_b32 v11, 64, v10
  v_add_u32 v12, 16384, v10
  v_add_u32 v13, 24576, v11
  v_add_u32 v11, 8192, v11
  s_mov_b32 s26, 2359296
  s_mov_b32 s27, 131072
  s_getpc_b64 s[82:83]
  s_and_b32 s62, s2, 248
  v_add_lshl_u32 v2, v5, s62, 7
  s_cmp_ge_u32 s62, HEAD_LINES
  s_cselect_b32 s63, s52, 0
  s_mul_i32 s63, s63, A_SHIFT
  v_add_u32 v2, s63, v2
  v_min_u32 v2, CODE_SPAN, v2
  global_load_dword v255, v2, s[82:83]
  s_mov_b32 s30, 1990656
  s_mov_b32 s31, 131072
  s_mul_i32 s80, s55, 4608
  s_add_u32 s61, s80, 49152
  s_mul_i32 s47, s54, 144
  s_lshl2_add_u32 s62, s67, s55
  s_mul_i32 s58, s62, 55296
  s_add_u32 s58, s58, s47
  s_add_u32 s58, s58, s59
  s_movk_i32 s44, 3456
  s_movk_i32 s45, -144
  v_lshlrev_b32 v46, 4, v0
  v_mul_u32_u24 v49, 7282, v0
  v_lshrrev_b32 v2, 16, v49
  v_lshrrev_b32 v64, 17, v49
  v_and_b32 v70, 1, v2
  v_mad_i32_i24 v76, v2, s45, v46
  v_mad_u32_u24 v3, v64, s44, v76
  v_mad_u32_u24 v14, v70, s59, v3
  v_add_u32 v1, 233024, v49
  v_lshrrev_b32 v2, 16, v1
  v_lshrrev_b32 v65, 17, v1
  v_and_b32 v71, 1, v2
  v_mad_i32_i24 v77, v2, s45, v46
  v_mad_u32_u24 v3, v65, s44, v77
  v_mad_u32_u24 v15, v71, s59, v3
  s_waitcnt lgkmcnt(0)
  s_mov_b64 s[24:25], s[4:5]
  buffer_load_dwordx4 v10, s[24:27], s57 offen offset:0 lds
  buffer_load_dwordx4 v11, s[24:27], s57 offen offset:1024 lds
  buffer_load_dwordx4 v12, s[24:27], s57 offen offset:2048 lds
  buffer_load_dwordx4 v13, s[24:27], s57 offen offset:3072 lds
  s_mov_b64 s[28:29], s[6:7]
  s_add_u32 m0, s61, 0
  s_mov_b32 exec_hi, 0
  buffer_load_dwordx4 v14, s[28:31], s58 offen lds
  s_mov_b32 exec_hi, -1
  buffer_load_dwordx4 v15, s[28:31], s58 offen offset:512 lds
  v_add_u32 v1, 699072, v49
  v_lshrrev_b32 v2, 16, v1
  v_lshrrev_b32 v66, 17, v1
  v_and_b32 v72, 1, v2
  v_mad_i32_i24 v78, v2, s45, v46
  v_lshrrev_b32 v3, 1, v66
  v_and_b32 v3, 4, v3
  v_xor_b32 v66, v66, v3
  v_mad_u32_u24 v3, v66, s44, v78
  v_mad_u32_u24 v16, v72, s59, v3
  buffer_load_dwordx4 v16, s[28:31], s58 offen offset:1536 lds
  v_add_u32 v1, 1165120, v49
  v_lshrrev_b32 v2, 16, v1
  v_lshrrev_b32 v67, 17, v1
  v_and_b32 v73, 1, v2
  v_mad_i32_i24 v79, v2, s45, v46
  v_xor_b32 v67, 4, v67
  v_mad_u32_u24 v3, v67, s44, v79
  v_mad_u32_u24 v17, v73, s59, v3
  buffer_load_dwordx4 v17, s[28:31], s58 offen offset:2560 lds
  v_add_u32 v1, 1631168, v49
  v_lshrrev_b32 v2, 16, v1
  v_lshrrev_b32 v68, 17, v1
  v_and_b32 v74, 1, v2
  v_mad_i32_i24 v80, v2, s45, v46
  v_xor_b32 v68, 4, v68
  v_mad_u32_u24 v3, v68, s44, v80
  v_mad_u32_u24 v18, v74, s59, v3
  buffer_load_dwordx4 v18, s[28:31], s58 offen offset:3584 lds
  s_load_dwordx2 s[32:33], s[0:1], s64
  s_load_dwordx2 s[40:41], s[0:1], 56
  s_load_dwordx2 s[88:89], s[0:1], 48
  s_add_u32 s57, s57, 128
  s_add_u32 s58, s58, 221184
  s_cmp_eq_u32 s67, 8
  s_cselect_b32 s62, 1152, 0
  s_cselect_b32 s63, 1990656, 0
  s_sub_u32 s57, s57, s62
  s_sub_u32 s58, s58, s63
  s_mov_b32 s62, 3670016
  s_load_dword s95, s[36:37], s62
  s_mov_b32 s34, 663552
  s_mov_b32 s35, 131072
  s_mov_b32 s50, 20736
  s_mov_b32 s51, 131072
  s_mov_b32 s42, 4718592
  s_mov_b32 s43, 131072
  s_mov_b32 s38, 10485760
  s_mov_b32 s39, 131072
  v_lshlrev_b32 v54, 2, v0
  s_lshl2_add_u32 s64, s54, s55
  s_mul_i32 s64, s64, 648
  s_lshl3_add_u32 s46, s52, s54
  s_lshl_b32 s92, s46, 14
  s_add_u32 s92, s92, 3145728
  s_sub_u32 s62, 2, s52
  s_min_u32 s63, s55, s62
  s_mul_i32 s65, s53, s62
  s_add_u32 s65, s65, s53
  s_add_u32 s69, s63, s65
  s_lshl_b32 s63, s69, 8
  s_add_u32 s73, s92, s63
  s_cmp_gt_u32 s55, s62
  s_cselect_b32 s73, 2147483632, s73
  s_lshl3_add_u32 s62, s52, 0
  s_and_b32 s63, s69, 7
  s_or_b32 s62, s62, s63
  s_cmp_eq_u32 s62, 15
  s_cselect_b32 s73, 2147483632, s73
  s_subb_u32 s69, s69, 0
  v_and_b32 v48, 15, v0
  v_and_b32 v8, 1, v47
  v_lshlrev_b32 v1, 2, v47
  v_lshl_add_u32 v1, v48, 4, v1
  v_lshl_or_b32 v53, v8, 30, v1
  s_mul_i32 s62, s66, 73728
  s_xor_b32 s63, s52, 1
  s_mul_i32 s50, s63, 20736
  s_mul_i32 s63, s63, 1152
  s_add_u32 s94, s62, s63
  s_lshl_b32 s62, s52, 6
  s_add_u32 s62, s62, s66
  s_lshl_b32 s70, s62, 7
  s_add_u32 s70, s70, 3735552
  v_mov_b32 v91, 0
  v_lshrrev_b32 v1, 1, v48
  v_xor_b32 v1, v1, v47
  v_lshl_add_u32 v2, v48, 7, s60
  v_lshl_add_u32 v19, v1, 4, v2
  v_xor_b32 v20, 64, v19
  v_bfe_u32 v251, v0, 2, 2
  v_and_b32 v252, 3, v0
  v_lshl_add_u32 v2, v47, 3, v251
  v_lshl_add_u32 v3, v8, 2, v2
  v_xor_b32 v4, 4, v3
  s_movk_i32 s62, 288
  v_mov_b32 v5, 49152
  v_mad_u32_u24 v3, v3, s62, v5
  v_mad_u32_u24 v4, v4, s62, v5
  v_mul_u32_u24 v1, 40, v252
  v_lshrrev_b32 v2, 1, v252
  v_add_u32 v21, v3, v1
  v_add_u32 v22, v4, v1
  v_lshlrev_b32 v7, 5, v2
  v_sub_u32 v7, v1, v7
  v_add3_u32 v23, v3, v7, 24
  v_add3_u32 v24, v4, v7, 24
  v_mul_u32_u24 v7, 72, v2
  v_add3_u32 v25, v3, v7, 32
  v_add3_u32 v26, v4, v7, 32
  v_lshl_add_u32 v27, v252, 3, v3
  v_lshl_add_u32 v28, v252, 3, v4
  v_and_b32 v7, 1, v252
  v_mul_u32_u24 v7, 144, v7
  v_add_u32 v29, v25, v7
  v_add_u32_e64 v30, v26, v7
  s_mov_b32 s62, 109440
  v_mad_u32_u24 v31, v70, s62, v14
  v_mad_u32_u24 v32, v71, s62, v15
  v_mad_u32_u24 v33, v72, s62, v16
  v_mad_u32_u24 v34, v73, s62, v17
  v_mad_u32_u24 v35, v74, s62, v18
  v_mov_b32 v84, 0
  v_mov_b32 v85, 0
  v_mov_b32 v86, 0
  v_mov_b32 v87, 0
  s_mul_i32 s63, s55, 384
  s_add_u32 s63, s63, 159744
  v_min_u32 v1, 368, v46
  v_add_u32 v1, s63, v1
  ds_write_b128 v1, v[84:87]
  s_mul_i32 s62, s55, 960
  s_add_u32 s62, s62, 104448
  v_lshrrev_b32 v1, 16, v49
  v_add_u32 v1, v1, v0
  v_lshl_add_u32 v248, v1, 2, s62
  v_add_u32 v1, 466048, v49
  v_lshrrev_b32 v1, 16, v1
  v_add_u32 v1, v1, v0
  v_lshl_add_u32 v249, v1, 2, s62
  v_add_u32 v1, 932096, v49
  v_lshrrev_b32 v1, 16, v1
  v_add_u32 v1, v1, v0
  v_lshl_add_u32 v250, v1, 2, s62
  v_cmp_eq_u32 vcc, v252, v47
  v_mul_u32_u24 v1, 40, v251
  v_mul_u32_u24 v2, 1040, v47
  v_mov_b32 v4, 159744
  v_add3_u32 v2, v2, v1, v4
  v_add_u32 v3, 4294912000, v2
  v_cndmask_b32 v243, v4, v3, vcc
  v_lshrrev_b32 v5, 1, v47
  v_mul_u32_u24 v5, 640, v5
  v_sub_u32 v3, v3, v5
  v_add_u32 v3, 480, v3
  v_cndmask_b32 v253, v4, v3, vcc
  v_mul_u32_u24 v2, 1920, v47
  v_add_u32 v2, v2, v1
  v_add_u32 v3, 61440, v2
  v_cndmask_b32 v50, v4, v3, vcc
  v_mul_u32_u24 v2, 960, v47
  v_mul_u32_u24 v5, 640, v8
  v_sub_u32 v2, v2, v5
  v_add_u32 v2, v2, v1
  v_add_u32 v2, 105088, v2
  v_cndmask_b32 v2, v4, v2, vcc
  v_cmp_gt_u32 vcc, 2, v251
  s_mul_i32 s68, s46, 196608
  s_lshl_b32 s69, s69, 12
  v_cndmask_b32 v254, v4, v2, vcc
  s_add_u32 s69, s69, s68
  buffer_load_dword v240, v54, s[48:51], s64 offen offset:0
  buffer_load_dword v241, v54, s[48:51], s64 offen offset:256
  buffer_load_dword v242, v54, s[48:51], s64 offen offset:512
  buffer_load_dword v255, v91, s[36:39], s70 offen sc1
  s_mov_b32 s48, s47
  s_add_u32 m0, s60, 16384
  s_nop 0
  buffer_load_dwordx4 v10, s[24:27], s57 offen offset:0 lds
  buffer_load_dwordx4 v11, s[24:27], s57 offen offset:1024 lds
  buffer_load_dwordx4 v12, s[24:27], s57 offen offset:2048 lds
  buffer_load_dwordx4 v13, s[24:27], s57 offen offset:3072 lds
  s_add_u32 m0, s61, 18432
  s_mov_b32 exec_hi, 0
  buffer_load_dwordx4 v14, s[28:31], s58 offen lds
  s_mov_b32 exec_hi, -1
  buffer_load_dwordx4 v15, s[28:31], s58 offen offset:512 lds
  buffer_load_dwordx4 v16, s[28:31], s58 offen offset:1536 lds
  buffer_load_dwordx4 v17, s[28:31], s58 offen offset:2560 lds
  buffer_load_dwordx4 v18, s[28:31], s58 offen offset:3584 lds
  s_add_u32 s57, s57, 128
  s_add_u32 s58, s58, 221184
  s_cmp_eq_u32 s67, 7
  s_cselect_b32 s62, 1152, 0
  s_cselect_b32 s63, 1990656, 0
  s_sub_u32 s57, s57, s62
  s_sub_u32 s58, s58, s63
  s_waitcnt vmcnt(13) lgkmcnt(0)
  s_barrier
  s_nop 0
  ds_read_b128 a[0:3], v19 offset:0
  ds_read_b128 a[4:7], v19 offset:2048
  ds_read_b64_tr_b16 v[144:145], v21 offset:0
  ds_read_b64_tr_b16 v[146:147], v22 offset:0
  ds_read_b64_tr_b16 v[148:149], v21 offset:8
  ds_read_b64_tr_b16 v[150:151], v22 offset:8
  ds_read_b64_tr_b16 v[152:153], v21 offset:16
  ds_read_b64_tr_b16 v[154:155], v22 offset:16
  ds_read_b64_tr_b16 v[156:157], v23 offset:0
  ds_read_b64_tr_b16 v[158:159], v24 offset:0
  s_and_b32 s44, s55, 1
  s_lshr_b32 s45, s55, 1
  s_mul_i32 s46, s44, 55296
  s_add_u32 s46, s46, s48
  s_add_u32 s50, s46, 1990656
  s_add_u32 s47, s45, s67
  s_add_u32 s56, s47, 7
  s_lshr_b32 s56, s56, 4
  s_waitcnt lgkmcnt(4)
  v_mfma_f32_16x16x32_bf16 v[64:67], v[144:147], a[0:3], 0
  ds_read_b64_tr_b16 v[160:161], v29 offset:0
  s_add_u32 m0, s60, 32768
  v_mfma_f32_16x16x32_bf16 v[84:87], v[144:147], a[4:7], 0
  ds_read_b64_tr_b16 v[162:163], v30 offset:0
  buffer_load_dwordx4 v10, s[24:27], s57 offen offset:0 lds
  s_mul_i32 s56, s56, 9
  s_sub_u32 s47, s47, s56
  v_mfma_f32_16x16x32_bf16 v[68:71], v[148:151], a[0:3], 0
  ds_read_b64_tr_b16 v[164:165], v27 offset:144
  buffer_load_dwordx4 v11, s[24:27], s57 offen offset:1024 lds
  v_mfma_f32_16x16x32_bf16 v[88:91], v[148:151], a[4:7], 0
  ds_read_b64_tr_b16 v[166:167], v28 offset:144
  s_mul_i32 s47, s47, 221184
  s_waitcnt lgkmcnt(4)
  v_mfma_f32_16x16x32_bf16 v[72:75], v[152:155], a[0:3], 0
  ds_read_b64_tr_b16 v[168:169], v27 offset:184
  buffer_load_dwordx4 v12, s[24:27], s57 offen offset:2048 lds
  v_mfma_f32_16x16x32_bf16 v[92:95], v[152:155], a[4:7], 0
  ds_read_b64_tr_b16 v[170:171], v28 offset:184
  buffer_load_dwordx4 v13, s[24:27], s57 offen offset:3072 lds
  s_add_u32 s56, s47, s46
  v_mfma_f32_16x16x32_bf16 v[76:79], v[156:159], a[0:3], 0
  ds_read_b64_tr_b16 v[172:173], v27 offset:216
  s_add_u32 m0, s61, 36864
  s_mov_b32 exec_hi, 0
  buffer_load_dwordx4 v14, s[28:31], s58 offen lds
  s_mov_b32 exec_hi, -1
  v_mfma_f32_16x16x32_bf16 v[96:99], v[156:159], a[4:7], 0
  ds_read_b64_tr_b16 v[174:175], v28 offset:216
  s_mul_i32 s93, s44, 41472
  s_waitcnt lgkmcnt(4)
  v_mfma_f32_16x16x32_bf16 v[80:83], v[160:163], a[0:3], 0
  ds_read_b64_tr_b16 v[144:145], v27 offset:256
  buffer_load_dwordx4 v15, s[28:31], s58 offen offset:512 lds
  v_mfma_f32_16x16x32_bf16 v[100:103], v[160:163], a[4:7], 0
  ds_read_b64_tr_b16 v[146:147], v28 offset:256
  s_lshl_b32 s46, s54, 7
  v_mfma_f32_16x16x32_bf16 v[104:107], a[0:3], v[164:167], 0
  ds_read_b128 a[8:11], v20 offset:0
  ds_read_b128 a[12:15], v20 offset:2048
  v_mfma_f32_16x16x32_bf16 v[124:127], a[4:7], v[164:167], 0
  ds_read_b64_tr_b16 v[148:149], v21 offset:9216
  ds_read_b64_tr_b16 v[150:151], v22 offset:9216
  s_add_u32 s93, s93, s46
  s_waitcnt lgkmcnt(6)
  v_mfma_f32_16x16x32_bf16 v[108:111], a[0:3], v[168:171], 0
  ds_read_b64_tr_b16 v[152:153], v21 offset:9224
  buffer_load_dwordx4 v16, s[28:31], s58 offen offset:1536 lds
  v_mfma_f32_16x16x32_bf16 v[128:131], a[4:7], v[168:171], 0
  ds_read_b64_tr_b16 v[154:155], v22 offset:9224
  buffer_load_dwordx4 v17, s[28:31], s58 offen offset:2560 lds
  s_lshl_b32 s46, s54, 2
  v_mfma_f32_16x16x32_bf16 v[112:115], a[0:3], v[172:175], 0
  ds_read_b64_tr_b16 v[156:157], v21 offset:9232
  buffer_load_dwordx4 v18, s[28:31], s58 offen offset:3584 lds
  v_mfma_f32_16x16x32_bf16 v[132:135], a[4:7], v[172:175], 0
  ds_read_b64_tr_b16 v[158:159], v22 offset:9232
  s_add_u32 s46, s46, 4
  s_waitcnt lgkmcnt(4)
  v_mfma_f32_16x16x32_bf16 v[116:119], a[0:3], v[144:147], 0
  ds_read_b64_tr_b16 v[160:161], v23 offset:9216
  ds_read_b64_tr_b16 v[162:163], v24 offset:9216
  v_mfma_f32_16x16x32_bf16 v[136:139], a[4:7], v[144:147], 0
  ds_read_b64_tr_b16 v[164:165], v29 offset:9216
  ds_read_b64_tr_b16 v[166:167], v30 offset:9216
  s_bfm_b64 s[46:47], s46, 0
  v_mfma_f32_16x16x32_bf16 v[64:67], v[148:151], a[8:11], v[64:67]
  ds_read_b64_tr_b16 v[168:169], v27 offset:9360
  ds_read_b64_tr_b16 v[170:171], v28 offset:9360
  v_mfma_f32_16x16x32_bf16 v[84:87], v[148:151], a[12:15], v[84:87]
  ds_read_b64_tr_b16 v[172:173], v27 offset:9400
  ds_read_b64_tr_b16 v[174:175], v28 offset:9400
  s_andn2_b32 s78, 1985229328, s46
  s_waitcnt lgkmcnt(8)
  v_mfma_f32_16x16x32_bf16 v[68:71], v[152:155], a[8:11], v[68:71]
  ds_read_b64_tr_b16 v[144:145], v27 offset:9432
  ds_read_b64_tr_b16 v[146:147], v28 offset:9432
  v_mfma_f32_16x16x32_bf16 v[88:91], v[152:155], a[12:15], v[88:91]
  ds_read_b64_tr_b16 v[148:149], v27 offset:9472
  ds_read_b64_tr_b16 v[150:151], v28 offset:9472
  s_add_u32 s57, s57, 128
  s_and_b32 s46, 1698898176, s46
  v_mfma_f32_16x16x32_bf16 v[72:75], v[156:159], a[8:11], v[72:75]
  s_add_u32 s58, s58, 221184
  s_cmp_eq_u32 s67, 6
  s_cselect_b32 s62, 1152, 0
  s_cselect_b32 s63, 1990656, 0
  v_mfma_f32_16x16x32_bf16 v[92:95], v[156:159], a[12:15], v[92:95]
  s_sub_u32 s57, s57, s62
  s_or_b32 s78, s78, s46
  s_waitcnt lgkmcnt(8)
  v_mfma_f32_16x16x32_bf16 v[76:79], v[160:163], a[8:11], v[76:79]
  s_sub_u32 s58, s58, s63
  s_or_b32 s78, s78, s54
  v_mfma_f32_16x16x32_bf16 v[96:99], v[160:163], a[12:15], v[96:99]
  s_lshl_b32 s46, s45, 2
  s_lshr_b32 s51, s78, s46
  v_mfma_f32_16x16x32_bf16 v[80:83], v[164:167], a[8:11], v[80:83]
  s_mul_i32 s79, s55, 5120
  s_mov_b32 s74, 1069066811
  v_mfma_f32_16x16x32_bf16 v[100:103], v[164:167], a[12:15], v[100:103]
  s_lshl2_add_u32 s72, s52, s55
  s_mov_b64 exec, 0
  s_cmp_eq_u32 s72, 0
  s_cbranch_scc1 L_thB00
  s_cmp_eq_u32 s72, 1
  s_cbranch_scc1 L_thB01
  s_cmp_eq_u32 s72, 2
  s_cbranch_scc1 L_thB02
  s_cmp_eq_u32 s72, 3
  s_cbranch_scc1 L_thB03
  s_cmp_eq_u32 s72, 4
  s_cbranch_scc1 L_thA00
  s_cmp_eq_u32 s72, 5
  s_cbranch_scc1 L_thA01
  s_cmp_eq_u32 s72, 6
  s_cbranch_scc1 L_thA02
  s_branch L_thA03
L_tret0:
  s_mov_b64 exec, -1
  s_waitcnt vmcnt(9) lgkmcnt(0)
  s_barrier
  v_mfma_f32_16x16x32_bf16 v[104:107], a[8:11], v[168:171], v[104:107]
  ds_read_b128 a[16:19], v19 offset:16384
  ds_read_b128 a[20:23], v19 offset:18432
  v_mfma_f32_16x16x32_bf16 v[124:127], a[12:15], v[168:171], v[124:127]
  ds_read_b64_tr_b16 v[152:153], v21 offset:18432
  ds_read_b64_tr_b16 v[154:155], v22 offset:18432
  v_mfma_f32_16x16x32_bf16 v[108:111], a[8:11], v[172:175], v[108:111]
  ds_read_b64_tr_b16 v[156:157], v21 offset:18440
  s_add_u32 m0, s60, 0
  v_mfma_f32_16x16x32_bf16 v[128:131], a[12:15], v[172:175], v[128:131]
  ds_read_b64_tr_b16 v[158:159], v22 offset:18440
  buffer_load_dwordx4 v10, s[24:27], s57 offen offset:0 lds
  v_mfma_f32_16x16x32_bf16 v[112:115], a[8:11], v[144:147], v[112:115]
  ds_read_b64_tr_b16 v[160:161], v21 offset:18448
  buffer_load_dwordx4 v11, s[24:27], s57 offen offset:1024 lds
  v_mfma_f32_16x16x32_bf16 v[132:135], a[12:15], v[144:147], v[132:135]
  ds_read_b64_tr_b16 v[162:163], v22 offset:18448
  s_mov_b32 s75, 1069066811
  v_mfma_f32_16x16x32_bf16 v[116:119], a[8:11], v[148:151], v[116:119]
  ds_read_b64_tr_b16 v[164:165], v23 offset:18432
  buffer_load_dwordx4 v12, s[24:27], s57 offen offset:2048 lds
  v_mfma_f32_16x16x32_bf16 v[136:139], a[12:15], v[148:151], v[136:139]
  ds_read_b64_tr_b16 v[166:167], v24 offset:18432
  s_waitcnt lgkmcnt(4)
  v_mfma_f32_16x16x32_bf16 v[64:67], v[152:155], a[16:19], v[64:67]
  ds_read_b64_tr_b16 v[168:169], v29 offset:18432
  buffer_load_dwordx4 v13, s[24:27], s57 offen offset:3072 lds
  v_mfma_f32_16x16x32_bf16 v[84:87], v[152:155], a[20:23], v[84:87]
  ds_read_b64_tr_b16 v[170:171], v30 offset:18432
  s_mov_b32 s76, 897988541
  v_mfma_f32_16x16x32_bf16 v[68:71], v[156:159], a[16:19], v[68:71]
  ds_read_b64_tr_b16 v[172:173], v27 offset:18576
  s_add_u32 m0, s61, 0
  s_mov_b32 exec_hi, 0
  buffer_load_dwordx4 v14, s[28:31], s58 offen lds
  s_mov_b32 exec_hi, -1
  v_mfma_f32_16x16x32_bf16 v[88:91], v[156:159], a[20:23], v[88:91]
  ds_read_b64_tr_b16 v[174:175], v28 offset:18576
  s_mov_b32 s77, 897988541
  s_waitcnt lgkmcnt(4)
  v_mfma_f32_16x16x32_bf16 v[72:75], v[160:163], a[16:19], v[72:75]
  ds_read_b64_tr_b16 v[144:145], v27 offset:18616
  buffer_load_dwordx4 v15, s[28:31], s58 offen offset:512 lds
  v_mfma_f32_16x16x32_bf16 v[92:95], v[160:163], a[20:23], v[92:95]
  ds_read_b64_tr_b16 v[146:147], v28 offset:18616
  s_add_u32 s95, s95, 17
  v_mfma_f32_16x16x32_bf16 v[76:79], v[164:167], a[16:19], v[76:79]
  ds_read_b64_tr_b16 v[148:149], v27 offset:18648
  buffer_load_dwordx4 v16, s[28:31], s58 offen offset:1536 lds
  v_mfma_f32_16x16x32_bf16 v[96:99], v[164:167], a[20:23], v[96:99]
  ds_read_b64_tr_b16 v[150:151], v28 offset:18648
  ds_write_b32 v248, v240 offset:0
  s_waitcnt lgkmcnt(5)
  v_mfma_f32_16x16x32_bf16 v[80:83], v[168:171], a[16:19], v[80:83]
  ds_read_b64_tr_b16 v[152:153], v27 offset:18688
  buffer_load_dwordx4 v17, s[28:31], s58 offen offset:2560 lds
  v_mfma_f32_16x16x32_bf16 v[100:103], v[168:171], a[20:23], v[100:103]
  ds_read_b64_tr_b16 v[154:155], v28 offset:18688
  s_lshl3_add_u32 s64, s66, s54
  v_mfma_f32_16x16x32_bf16 v[104:107], a[16:19], v[172:175], v[104:107]
  ds_read_b128 a[24:27], v20 offset:16384
  ds_read_b128 a[28:31], v20 offset:18432
  v_mfma_f32_16x16x32_bf16 v[124:127], a[20:23], v[172:175], v[124:127]
  ds_read_b64_tr_b16 v[156:157], v21 offset:27648
  ds_read_b64_tr_b16 v[158:159], v22 offset:27648
  ds_write_b32 v249, v241 offset:256
  s_waitcnt lgkmcnt(8)
  v_mfma_f32_16x16x32_bf16 v[108:111], a[16:19], v[144:147], v[108:111]
  ds_read_b64_tr_b16 v[160:161], v21 offset:27656
  s_mul_i32 s64, s64, 81
  v_mfma_f32_16x16x32_bf16 v[128:131], a[20:23], v[144:147], v[128:131]
  ds_read_b64_tr_b16 v[162:163], v22 offset:27656
  buffer_load_dwordx4 v18, s[28:31], s58 offen offset:3584 lds
  v_mfma_f32_16x16x32_bf16 v[112:115], a[16:19], v[148:151], v[112:115]
  ds_read_b64_tr_b16 v[164:165], v21 offset:27664
  s_lshr_b32 s64, s64, 3
  v_mfma_f32_16x16x32_bf16 v[132:135], a[20:23], v[148:151], v[132:135]
  ds_read_b64_tr_b16 v[166:167], v22 offset:27664
  ds_write_b32 v250, v242 offset:512
  s_waitcnt lgkmcnt(6)
  v_mfma_f32_16x16x32_bf16 v[116:119], a[16:19], v[152:155], v[116:119]
  ds_read_b64_tr_b16 v[168:169], v23 offset:27648
  ds_read_b64_tr_b16 v[170:171], v24 offset:27648
  v_mfma_f32_16x16x32_bf16 v[136:139], a[20:23], v[152:155], v[136:139]
  ds_read_b64_tr_b16 v[172:173], v29 offset:27648
  ds_read_b64_tr_b16 v[174:175], v30 offset:27648
L_tp0:
  s_cbranch_execz L_tret0
  v_mfma_f32_16x16x32_bf16 v[64:67], v[156:159], a[24:27], v[64:67]
  ds_read_b64_tr_b16 v[144:145], v27 offset:27792
  ds_read_b64_tr_b16 v[146:147], v28 offset:27792
  v_mfma_f32_16x16x32_bf16 v[84:87], v[156:159], a[28:31], v[84:87]
  ds_read_b64_tr_b16 v[148:149], v27 offset:27832
  ds_read_b64_tr_b16 v[150:151], v28 offset:27832
  s_add_u32 s57, s57, 128
  v_min_u32 v6, 10, v0
  v_add_u32 v6, s64, v6
  s_and_b32 s82, s95, 255
  s_waitcnt lgkmcnt(9)
  v_mfma_f32_16x16x32_bf16 v[68:71], v[160:163], a[24:27], v[68:71]
  ds_read_b64_tr_b16 v[152:153], v27 offset:27864
  ds_read_b64_tr_b16 v[154:155], v28 offset:27864
  v_mfma_f32_16x16x32_bf16 v[88:91], v[160:163], a[28:31], v[88:91]
  ds_read_b64_tr_b16 v[156:157], v27 offset:27904
  ds_read_b64_tr_b16 v[158:159], v28 offset:27904
  s_add_u32 s58, s58, 221184
  v_lshlrev_b32 v6, 7, v6
  s_mov_b32 s83, 4294967040
  v_mfma_f32_16x16x32_bf16 v[72:75], v[164:167], a[24:27], v[72:75]
  s_cmp_eq_u32 s67, 5
  s_cselect_b32 s62, 1152, 0
  s_cselect_b32 s63, 1990656, 0
  s_mov_b32 s90, 663552
  v_mfma_f32_16x16x32_bf16 v[92:95], v[164:167], a[28:31], v[92:95]
  s_mov_b32 s91, 131072
  s_getreg_b32 s44, hwreg(HW_REG_XCC_ID, 0, 4)
  s_waitcnt lgkmcnt(8)
  v_mfma_f32_16x16x32_bf16 v[76:79], v[168:171], a[24:27], v[76:79]
  s_sub_u32 s57, s57, s62
  s_cmp_eq_u32 s52, 0
  s_cbranch_scc1 L_skip_apo
  buffer_load_dword v255, v6, s[88:91], 0 offen
  buffer_load_dword v255, v6, s[32:35], 0 offen
L_skip_apo:
  v_mfma_f32_16x16x32_bf16 v[96:99], v[168:171], a[28:31], v[96:99]
  s_sub_u32 s58, s58, s63
  s_and_b32 s49, s95, 4294967280
  v_mfma_f32_16x16x32_bf16 v[80:83], v[172:175], a[24:27], v[80:83]
  s_or_b32 s49, s49, s44
  v_mov_b32 v244, -1
  v_mfma_f32_16x16x32_bf16 v[100:103], v[172:175], a[28:31], v[100:103]
  s_lshl2_add_u32 s72, s52, s55
  s_mov_b64 exec, 0
  s_cmp_eq_u32 s72, 0
  s_cbranch_scc1 L_thB10
  s_cmp_eq_u32 s72, 1
  s_cbranch_scc1 L_thB11
  s_cmp_eq_u32 s72, 2
  s_cbranch_scc1 L_thB12
  s_cmp_eq_u32 s72, 3
  s_cbranch_scc1 L_thB13
  s_cmp_eq_u32 s72, 4
  s_cbranch_scc1 L_thA10
  s_cmp_eq_u32 s72, 5
  s_cbranch_scc1 L_thA11
  s_cmp_eq_u32 s72, 6
  s_cbranch_scc1 L_thA12
  s_branch L_thA13
L_tret1:
  s_mov_b64 exec, -1
  s_waitcnt vmcnt(9) lgkmcnt(0)
  s_barrier
  v_mfma_f32_16x16x32_bf16 v[104:107], a[24:27], v[144:147], v[104:107]
  ds_read_b128 a[32:35], v19 offset:32768
  ds_read_b128 a[36:39], v19 offset:34816
  v_mfma_f32_16x16x32_bf16 v[124:127], a[28:31], v[144:147], v[124:127]
  ds_read_b64_tr_b16 v[160:161], v21 offset:36864
  ds_read_b64_tr_b16 v[162:163], v22 offset:36864
  v_mfma_f32_16x16x32_bf16 v[108:111], a[24:27], v[148:151], v[108:111]
  ds_read_b64_tr_b16 v[164:165], v21 offset:36872
  s_add_u32 m0, s60, 16384
  v_mfma_f32_16x16x32_bf16 v[128:131], a[28:31], v[148:151], v[128:131]
  ds_read_b64_tr_b16 v[166:167], v22 offset:36872
  buffer_load_dwordx4 v10, s[24:27], s57 offen offset:0 lds
  v_mov_b32 v245, -1
  v_mfma_f32_16x16x32_bf16 v[112:115], a[24:27], v[152:155], v[112:115]
  ds_read_b64_tr_b16 v[168:169], v21 offset:36880
  buffer_load_dwordx4 v11, s[24:27], s57 offen offset:1024 lds
  v_mfma_f32_16x16x32_bf16 v[132:135], a[28:31], v[152:155], v[132:135]
  ds_read_b64_tr_b16 v[170:171], v22 offset:36880
  v_mov_b32 v246, -1
  v_mfma_f32_16x16x32_bf16 v[116:119], a[24:27], v[156:159], v[116:119]
  ds_read_b64_tr_b16 v[172:173], v23 offset:36864
  buffer_load_dwordx4 v12, s[24:27], s57 offen offset:2048 lds
  v_mfma_f32_16x16x32_bf16 v[136:139], a[28:31], v[156:159], v[136:139]
  ds_read_b64_tr_b16 v[174:175], v24 offset:36864
  v_mov_b32 v247, -1
  s_waitcnt lgkmcnt(4)
  v_mfma_f32_16x16x32_bf16 v[64:67], v[160:163], a[32:35], v[64:67]
  ds_read_b64_tr_b16 v[144:145], v29 offset:36864
  buffer_load_dwordx4 v13, s[24:27], s57 offen offset:3072 lds
  v_mfma_f32_16x16x32_bf16 v[84:87], v[160:163], a[36:39], v[84:87]
  ds_read_b64_tr_b16 v[146:147], v30 offset:36864
  s_sub_u32 s46, 3, s52
  v_mfma_f32_16x16x32_bf16 v[68:71], v[164:167], a[32:35], v[68:71]
  ds_read_b64_tr_b16 v[148:149], v27 offset:37008
  s_add_u32 m0, s61, 18432
  s_mov_b32 exec_hi, 0
  buffer_load_dwordx4 v14, s[28:31], s58 offen lds
  s_mov_b32 exec_hi, -1
  v_mfma_f32_16x16x32_bf16 v[88:91], v[164:167], a[36:39], v[88:91]
  ds_read_b64_tr_b16 v[150:151], v28 offset:37008
  s_waitcnt lgkmcnt(4)
  v_mfma_f32_16x16x32_bf16 v[72:75], v[168:171], a[32:35], v[72:75]
  ds_read_b64_tr_b16 v[152:153], v27 offset:37048
  buffer_load_dwordx4 v15, s[28:31], s58 offen offset:512 lds
  v_mfma_f32_16x16x32_bf16 v[92:95], v[168:171], a[36:39], v[92:95]
  ds_read_b64_tr_b16 v[154:155], v28 offset:37048
  ds_read_b64_tr_b16 a[144:145], v243 offset:0
  ds_read_b64_tr_b16 a[146:147], v243 offset:160
  v_mfma_f32_16x16x32_bf16 v[76:79], v[172:175], a[32:35], v[76:79]
  ds_read_b64_tr_b16 v[156:157], v27 offset:37080
  buffer_load_dwordx4 v16, s[28:31], s58 offen offset:1536 lds
  v_mfma_f32_16x16x32_bf16 v[96:99], v[172:175], a[36:39], v[96:99]
  ds_read_b64_tr_b16 v[158:159], v28 offset:37080
  ds_read_b64_tr_b16 a[148:149], v243 offset:320
  s_waitcnt lgkmcnt(7)
  v_mfma_f32_16x16x32_bf16 v[80:83], v[144:147], a[32:35], v[80:83]
  ds_read_b64_tr_b16 v[160:161], v27 offset:37120
  buffer_load_dwordx4 v17, s[28:31], s58 offen offset:2560 lds
  v_mfma_f32_16x16x32_bf16 v[100:103], v[144:147], a[36:39], v[100:103]
  ds_read_b64_tr_b16 v[162:163], v28 offset:37120
  ds_read_b64_tr_b16 a[150:151], v253 offset:0
  v_mfma_f32_16x16x32_bf16 v[104:107], a[32:35], v[148:151], v[104:107]
  ds_read_b128 a[40:43], v20 offset:32768
  ds_read_b128 a[44:47], v20 offset:34816
  v_mfma_f32_16x16x32_bf16 v[124:127], a[36:39], v[148:151], v[124:127]
  ds_read_b64_tr_b16 v[164:165], v21 offset:46080
  ds_read_b64_tr_b16 v[166:167], v22 offset:46080
  ds_read_b64_tr_b16 a[152:153], v254 offset:0
  s_waitcnt lgkmcnt(9)
  v_mfma_f32_16x16x32_bf16 v[108:111], a[32:35], v[152:155], v[108:111]
  ds_read_b64_tr_b16 v[168:169], v21 offset:46088
  buffer_load_dwordx4 v18, s[28:31], s58 offen offset:3584 lds
  v_mfma_f32_16x16x32_bf16 v[128:131], a[36:39], v[152:155], v[128:131]
  ds_read_b64_tr_b16 v[170:171], v22 offset:46088
  s_add_u32 s57, s57, 128
  ds_read_b64_tr_b16 a[156:157], v243 offset:8
  v_mfma_f32_16x16x32_bf16 v[112:115], a[32:35], v[156:159], v[112:115]
  ds_read_b64_tr_b16 v[172:173], v21 offset:46096
  s_add_u32 s58, s58, 221184
  v_mfma_f32_16x16x32_bf16 v[132:135], a[36:39], v[156:159], v[132:135]
  ds_read_b64_tr_b16 v[174:175], v22 offset:46096
  ds_read_b64_tr_b16 a[158:159], v243 offset:168
  s_waitcnt lgkmcnt(7)
  v_mfma_f32_16x16x32_bf16 v[116:119], a[32:35], v[160:163], v[116:119]
  ds_read_b64_tr_b16 v[144:145], v23 offset:46080
  ds_read_b64_tr_b16 v[146:147], v24 offset:46080
  v_mfma_f32_16x16x32_bf16 v[136:139], a[36:39], v[160:163], v[136:139]
  ds_read_b64_tr_b16 v[148:149], v29 offset:46080
  ds_read_b64_tr_b16 v[150:151], v30 offset:46080
  ds_read_b64_tr_b16 a[160:161], v243 offset:328
  v_mfma_f32_16x16x32_bf16 v[64:67], v[164:167], a[40:43], v[64:67]
  ds_read_b64_tr_b16 v[152:153], v27 offset:46224
  ds_read_b64_tr_b16 v[154:155], v28 offset:46224
  v_mfma_f32_16x16x32_bf16 v[84:87], v[164:167], a[44:47], v[84:87]
  ds_read_b64_tr_b16 v[156:157], v27 offset:46264
  ds_read_b64_tr_b16 v[158:159], v28 offset:46264
  ds_read_b64_tr_b16 a[162:163], v253 offset:8
  ds_read_b64_tr_b16 a[164:165], v254 offset:8
  s_waitcnt lgkmcnt(12)
  v_mfma_f32_16x16x32_bf16 v[68:71], v[168:171], a[40:43], v[68:71]
  ds_read_b64_tr_b16 v[160:161], v27 offset:46296
  ds_read_b64_tr_b16 v[162:163], v28 offset:46296
  v_mfma_f32_16x16x32_bf16 v[88:91], v[168:171], a[44:47], v[88:91]
  ds_read_b64_tr_b16 v[164:165], v27 offset:46336
  ds_read_b64_tr_b16 v[166:167], v28 offset:46336
  ds_read_b64_tr_b16 a[168:169], v243 offset:16
  v_mfma_f32_16x16x32_bf16 v[72:75], v[172:175], a[40:43], v[72:75]
  s_cmp_eq_u32 s67, 4
  s_cselect_b32 s62, 1152, 0
  s_cselect_b32 s63, 1990656, 0
  s_sub_u32 s57, s57, s62
  v_mfma_f32_16x16x32_bf16 v[92:95], v[172:175], a[44:47], v[92:95]
  s_sub_u32 s58, s58, s63
  ds_read_b64_tr_b16 a[170:171], v243 offset:176
  s_waitcnt lgkmcnt(13)
  v_mfma_f32_16x16x32_bf16 v[76:79], v[144:147], a[40:43], v[76:79]
  ds_read_b64_tr_b16 a[172:173], v243 offset:336
  ds_read_b64_tr_b16 a[174:175], v253 offset:16
  v_mfma_f32_16x16x32_bf16 v[96:99], v[144:147], a[44:47], v[96:99]
  ds_read_b64_tr_b16 a[176:177], v254 offset:16
  ds_read_b64_tr_b16 a[180:181], v243 offset:24
  v_mfma_f32_16x16x32_bf16 v[80:83], v[148:151], a[40:43], v[80:83]
  ds_read_b64_tr_b16 a[182:183], v243 offset:184
  ds_read_b64_tr_b16 a[184:185], v243 offset:344
  v_mfma_f32_16x16x32_bf16 v[100:103], v[148:151], a[44:47], v[100:103]
  s_waitcnt vmcnt(9) lgkmcnt(0)
  s_barrier
  v_mfma_f32_16x16x32_bf16 v[104:107], a[40:43], v[152:155], v[104:107]
  ds_read_b128 a[48:51], v19 offset:0
  ds_read_b128 a[52:55], v19 offset:2048
  v_mfma_f32_16x16x32_bf16 v[124:127], a[44:47], v[152:155], v[124:127]
  ds_read_b64_tr_b16 v[168:169], v21 offset:0
  ds_read_b64_tr_b16 v[170:171], v22 offset:0
  v_mfma_f32_16x16x32_bf16 v[108:111], a[40:43], v[156:159], v[108:111]
  ds_read_b64_tr_b16 v[172:173], v21 offset:8
  s_add_u32 m0, s60, 32768
  v_mfma_f32_16x16x32_bf16 v[128:131], a[44:47], v[156:159], v[128:131]
  ds_read_b64_tr_b16 v[174:175], v22 offset:8
  buffer_load_dwordx4 v10, s[24:27], s57 offen offset:0 lds
  v_mfma_f32_16x16x32_bf16 v[112:115], a[40:43], v[160:163], v[112:115]
  ds_read_b64_tr_b16 v[144:145], v21 offset:16
  buffer_load_dwordx4 v11, s[24:27], s57 offen offset:1024 lds
  v_mfma_f32_16x16x32_bf16 v[132:135], a[44:47], v[160:163], v[132:135]
  ds_read_b64_tr_b16 v[146:147], v22 offset:16
  ds_read_b64_tr_b16 a[186:187], v253 offset:24
  v_mfma_f32_16x16x32_bf16 v[116:119], a[40:43], v[164:167], v[116:119]
  ds_read_b64_tr_b16 v[148:149], v23 offset:0
  buffer_load_dwordx4 v12, s[24:27], s57 offen offset:2048 lds
  v_mfma_f32_16x16x32_bf16 v[136:139], a[44:47], v[164:167], v[136:139]
  ds_read_b64_tr_b16 v[150:151], v24 offset:0
  s_waitcnt lgkmcnt(5)
  v_mfma_f32_16x16x32_bf16 v[64:67], v[168:171], a[48:51], v[64:67]
  ds_read_b64_tr_b16 v[152:153], v29 offset:0
  buffer_load_dwordx4 v13, s[24:27], s57 offen offset:3072 lds
  v_mfma_f32_16x16x32_bf16 v[84:87], v[168:171], a[52:55], v[84:87]
  ds_read_b64_tr_b16 v[154:155], v30 offset:0
  ds_read_b64_tr_b16 a[188:189], v254 offset:24
  v_mfma_f32_16x16x32_bf16 v[68:71], v[172:175], a[48:51], v[68:71]
  ds_read_b64_tr_b16 v[156:157], v27 offset:144
  s_add_u32 m0, s61, 36864
  s_mov_b32 exec_hi, 0
  buffer_load_dwordx4 v14, s[28:31], s58 offen lds
  s_mov_b32 exec_hi, -1
  v_mfma_f32_16x16x32_bf16 v[88:91], v[172:175], a[52:55], v[88:91]
  ds_read_b64_tr_b16 v[158:159], v28 offset:144
  ds_read_b64_tr_b16 a[192:193], v243 offset:32
  s_waitcnt lgkmcnt(6)
  v_mfma_f32_16x16x32_bf16 v[72:75], v[144:147], a[48:51], v[72:75]
  ds_read_b64_tr_b16 v[160:161], v27 offset:184
  buffer_load_dwordx4 v15, s[28:31], s58 offen offset:512 lds
  v_mfma_f32_16x16x32_bf16 v[92:95], v[144:147], a[52:55], v[92:95]
  ds_read_b64_tr_b16 v[162:163], v28 offset:184
  ds_read_b64_tr_b16 a[194:195], v243 offset:192
  v_mfma_f32_16x16x32_bf16 v[76:79], v[148:151], a[48:51], v[76:79]
  ds_read_b64_tr_b16 v[164:165], v27 offset:216
  buffer_load_dwordx4 v16, s[28:31], s58 offen offset:1536 lds
  v_mfma_f32_16x16x32_bf16 v[96:99], v[148:151], a[52:55], v[96:99]
  ds_read_b64_tr_b16 v[166:167], v28 offset:216
  ds_read_b64_tr_b16 a[196:197], v243 offset:352
  s_waitcnt lgkmcnt(7)
  v_mfma_f32_16x16x32_bf16 v[80:83], v[152:155], a[48:51], v[80:83]
  ds_read_b64_tr_b16 v[168:169], v27 offset:256
  buffer_load_dwordx4 v17, s[28:31], s58 offen offset:2560 lds
  v_mfma_f32_16x16x32_bf16 v[100:103], v[152:155], a[52:55], v[100:103]
  ds_read_b64_tr_b16 v[170:171], v28 offset:256
  ds_read_b64_tr_b16 a[198:199], v253 offset:32
  v_mfma_f32_16x16x32_bf16 v[104:107], a[48:51], v[156:159], v[104:107]
  ds_read_b128 a[56:59], v20 offset:0
  ds_read_b128 a[60:63], v20 offset:2048
  v_mfma_f32_16x16x32_bf16 v[124:127], a[52:55], v[156:159], v[124:127]
  ds_read_b64_tr_b16 v[172:173], v21 offset:9216
  ds_read_b64_tr_b16 v[174:175], v22 offset:9216
  ds_read_b64_tr_b16 a[200:201], v254 offset:32
  s_waitcnt lgkmcnt(9)
  v_mfma_f32_16x16x32_bf16 v[108:111], a[48:51], v[160:163], v[108:111]
  ds_read_b64_tr_b16 v[144:145], v21 offset:9224
  buffer_load_dwordx4 v18, s[28:31], s58 offen offset:3584 lds
  v_mfma_f32_16x16x32_bf16 v[128:131], a[52:55], v[160:163], v[128:131]
  ds_read_b64_tr_b16 v[146:147], v22 offset:9224
  s_add_u32 s57, s57, 128
  s_mul_i32 s46, s46, s55
  s_lshl_b32 s45, s46, 14
  s_add_u32 s68, s68, s45
  v_mfma_f32_16x16x32_bf16 v[112:115], a[48:51], v[164:167], v[112:115]
  ds_read_b64_tr_b16 v[148:149], v21 offset:9232
  s_add_u32 s58, s58, 221184
  v_mfma_f32_16x16x32_bf16 v[132:135], a[52:55], v[164:167], v[132:135]
  ds_read_b64_tr_b16 v[150:151], v22 offset:9232
  s_lshl_b32 s45, s53, 8
  s_add_u32 s68, s68, s45
  s_waitcnt lgkmcnt(5)
  v_mfma_f32_16x16x32_bf16 v[116:119], a[48:51], v[168:171], v[116:119]
  ds_read_b64_tr_b16 v[152:153], v23 offset:9216
  ds_read_b64_tr_b16 v[154:155], v24 offset:9216
  v_mfma_f32_16x16x32_bf16 v[136:139], a[52:55], v[168:171], v[136:139]
  ds_read_b64_tr_b16 v[156:157], v29 offset:9216
  ds_read_b64_tr_b16 v[158:159], v30 offset:9216
  s_lshl_b32 s45, s46, 10
  s_add_u32 s92, s92, s45
  s_lshr_b32 s45, s55, 1
  v_mfma_f32_16x16x32_bf16 v[64:67], v[172:175], a[56:59], v[64:67]
  ds_read_b64_tr_b16 v[160:161], v27 offset:9360
  ds_read_b64_tr_b16 v[162:163], v28 offset:9360
  v_mfma_f32_16x16x32_bf16 v[84:87], v[172:175], a[60:63], v[84:87]
  ds_read_b64_tr_b16 v[164:165], v27 offset:9400
  ds_read_b64_tr_b16 v[166:167], v28 offset:9400
  s_mul_i32 s21, s45, 1073741824
  s_mul_i32 s20, s45, 100000
  s_waitcnt lgkmcnt(8)
  v_mfma_f32_16x16x32_bf16 v[68:71], v[144:147], a[56:59], v[68:71]
  ds_read_b64_tr_b16 v[168:169], v27 offset:9432
  ds_read_b64_tr_b16 v[170:171], v28 offset:9432
  v_mfma_f32_16x16x32_bf16 v[88:91], v[144:147], a[60:63], v[88:91]
  ds_read_b64_tr_b16 v[172:173], v27 offset:9472
  ds_read_b64_tr_b16 v[174:175], v28 offset:9472
  s_add_u32 s20, s20, s80
  s_lshl_b32 s44, s52, 6
  v_mfma_f32_16x16x32_bf16 v[72:75], v[148:151], a[56:59], v[72:75]
  s_cmp_eq_u32 s67, 3
  s_cselect_b32 s62, 1152, 0
  s_cselect_b32 s63, 1990656, 0
  s_sub_u32 s57, s57, s62
  v_mfma_f32_16x16x32_bf16 v[92:95], v[148:151], a[60:63], v[92:95]
  s_sub_u32 s58, s58, s63
  s_add_u32 s44, s44, s66
  s_mul_i32 s71, s44, 36864
  s_add_u32 s71, s71, 4194304
  s_waitcnt lgkmcnt(8)
  v_mfma_f32_16x16x32_bf16 v[76:79], v[152:155], a[56:59], v[76:79]
  s_lshl_b32 s44, s48, 5
  s_add_u32 s84, s44, s71
  v_mfma_f32_16x16x32_bf16 v[96:99], v[152:155], a[60:63], v[96:99]
  v_add_u32 v54, 4096, v54
  v_lshl_add_u32 v1, v47, 2, v251
  v_mfma_f32_16x16x32_bf16 v[80:83], v[156:159], a[56:59], v[80:83]
  v_mul_u32_u24 v1, 80, v1
  s_mul_i32 s44, s55, 10240
  v_mfma_f32_16x16x32_bf16 v[100:103], v[156:159], a[60:63], v[100:103]
  s_waitcnt vmcnt(9) lgkmcnt(0)
  s_barrier
  v_mfma_f32_16x16x32_bf16 v[104:107], a[56:59], v[160:163], v[104:107]
  ds_read_b128 a[64:67], v19 offset:16384
  ds_read_b128 a[68:71], v19 offset:18432
  v_mfma_f32_16x16x32_bf16 v[124:127], a[60:63], v[160:163], v[124:127]
  ds_read_b64_tr_b16 v[144:145], v21 offset:18432
  ds_read_b64_tr_b16 v[146:147], v22 offset:18432
  v_add_u32 v52, s44, v1
  v_mfma_f32_16x16x32_bf16 v[108:111], a[56:59], v[164:167], v[108:111]
  ds_read_b64_tr_b16 v[148:149], v21 offset:18440
  s_add_u32 m0, s60, 0
  v_mfma_f32_16x16x32_bf16 v[128:131], a[60:63], v[164:167], v[128:131]
  ds_read_b64_tr_b16 v[150:151], v22 offset:18440
  buffer_load_dwordx4 v10, s[24:27], s57 offen offset:0 lds
  v_lshl_add_u32 v51, v252, 3, v52
  v_mov_b32 v185, 0
  v_mfma_f32_16x16x32_bf16 v[112:115], a[56:59], v[168:171], v[112:115]
  ds_read_b64_tr_b16 v[152:153], v21 offset:18448
  buffer_load_dwordx4 v11, s[24:27], s57 offen offset:1024 lds
  v_mfma_f32_16x16x32_bf16 v[132:135], a[60:63], v[168:171], v[132:135]
  ds_read_b64_tr_b16 v[154:155], v22 offset:18448
  v_mov_b32 v187, 16256
  v_mov_b32 v219, 16256
  v_mfma_f32_16x16x32_bf16 v[116:119], a[56:59], v[172:175], v[116:119]
  ds_read_b64_tr_b16 v[156:157], v23 offset:18432
  buffer_load_dwordx4 v12, s[24:27], s57 offen offset:2048 lds
  v_mfma_f32_16x16x32_bf16 v[136:139], a[60:63], v[172:175], v[136:139]
  ds_read_b64_tr_b16 v[158:159], v24 offset:18432
  v_mov_b32 v197, 0
  v_mov_b32 v199, 16256
  v_mov_b32 v239, 16256
  s_waitcnt lgkmcnt(4)
  v_mfma_f32_16x16x32_bf16 v[64:67], v[144:147], a[64:67], v[64:67]
  ds_read_b64_tr_b16 v[160:161], v29 offset:18432
  buffer_load_dwordx4 v13, s[24:27], s57 offen offset:3072 lds
  v_mfma_f32_16x16x32_bf16 v[84:87], v[144:147], a[68:71], v[84:87]
  ds_read_b64_tr_b16 v[162:163], v30 offset:18432
  v_mul_u32_u24 v1, 10240, v47
  v_mul_u32_u24 v2, 80, v48
  v_mfma_f32_16x16x32_bf16 v[68:71], v[148:151], a[64:67], v[68:71]
  ds_read_b64_tr_b16 v[164:165], v27 offset:18576
  s_add_u32 m0, s61, 0
  s_mov_b32 exec_hi, 0
  buffer_load_dwordx4 v14, s[28:31], s58 offen lds
  s_mov_b32 exec_hi, -1
  v_mfma_f32_16x16x32_bf16 v[88:91], v[148:151], a[68:71], v[88:91]
  ds_read_b64_tr_b16 v[166:167], v28 offset:18576
  s_mul_i32 s44, s55, 2560
  v_add3_u32 v55, v1, v2, s44
  s_waitcnt lgkmcnt(4)
  v_mfma_f32_16x16x32_bf16 v[72:75], v[152:155], a[64:67], v[72:75]
  ds_read_b64_tr_b16 v[168:169], v27 offset:18616
  buffer_load_dwordx4 v15, s[28:31], s58 offen offset:512 lds
  v_mfma_f32_16x16x32_bf16 v[92:95], v[152:155], a[68:71], v[92:95]
  ds_read_b64_tr_b16 v[170:171], v28 offset:18616
  s_mul_i32 s44, s55, 5120
  s_add_u32 s44, s44, 40960
  v_add_u32 v56, s44, v46
  v_mfma_f32_16x16x32_bf16 v[76:79], v[156:159], a[64:67], v[76:79]
  ds_read_b64_tr_b16 v[172:173], v27 offset:18648
  buffer_load_dwordx4 v16, s[28:31], s58 offen offset:1536 lds
  v_mfma_f32_16x16x32_bf16 v[96:99], v[156:159], a[68:71], v[96:99]
  ds_read_b64_tr_b16 v[174:175], v28 offset:18648
  s_lshl_b32 s44, s55, 10
  s_add_u32 s44, s44, 40960
  s_waitcnt lgkmcnt(4)
  v_mfma_f32_16x16x32_bf16 v[80:83], v[160:163], a[64:67], v[80:83]
  ds_read_b64_tr_b16 v[144:145], v27 offset:18688
  buffer_load_dwordx4 v17, s[28:31], s58 offen offset:2560 lds
  v_mfma_f32_16x16x32_bf16 v[100:103], v[160:163], a[68:71], v[100:103]
  ds_read_b64_tr_b16 v[146:147], v28 offset:18688
  v_add_u32 v57, s44, v46
  v_lshlrev_b32 v1, 4, v48
  v_mfma_f32_16x16x32_bf16 v[104:107], a[64:67], v[164:167], v[104:107]
  ds_read_b128 a[72:75], v20 offset:16384
  ds_read_b128 a[76:79], v20 offset:18432
  v_mfma_f32_16x16x32_bf16 v[124:127], a[68:71], v[164:167], v[124:127]
  ds_read_b64_tr_b16 v[148:149], v21 offset:27648
  ds_read_b64_tr_b16 v[150:151], v22 offset:27648
  v_lshl_add_u32 v59, v47, 12, v1
  v_cmp_gt_u32 vcc, 4, v48
  v_mov_b32 v5, 2147483632
  s_waitcnt lgkmcnt(6)
  v_mfma_f32_16x16x32_bf16 v[108:111], a[64:67], v[168:171], v[108:111]
  ds_read_b64_tr_b16 v[152:153], v21 offset:27656
  buffer_load_dwordx4 v18, s[28:31], s58 offen offset:3584 lds
  v_mfma_f32_16x16x32_bf16 v[128:131], a[68:71], v[168:171], v[128:131]
  ds_read_b64_tr_b16 v[154:155], v22 offset:27656
  s_add_u32 s57, s57, 128
  v_lshl_add_u32 v1, v47, 2, v48
  v_lshlrev_b32 v1, 4, v1
  v_mfma_f32_16x16x32_bf16 v[112:115], a[64:67], v[172:175], v[112:115]
  ds_read_b64_tr_b16 v[156:157], v21 offset:27664
  s_add_u32 s58, s58, 221184
  v_mfma_f32_16x16x32_bf16 v[132:135], a[68:71], v[172:175], v[132:135]
  ds_read_b64_tr_b16 v[158:159], v22 offset:27664
  v_cndmask_b32 v60, v5, v1, vcc
  v_cmp_gt_u32 vcc, 16, v0
  s_waitcnt lgkmcnt(4)
  v_mfma_f32_16x16x32_bf16 v[116:119], a[64:67], v[144:147], v[116:119]
  ds_read_b64_tr_b16 v[160:161], v23 offset:27648
  ds_read_b64_tr_b16 v[162:163], v24 offset:27648
  v_mfma_f32_16x16x32_bf16 v[136:139], a[68:71], v[144:147], v[136:139]
  ds_read_b64_tr_b16 v[164:165], v29 offset:27648
  ds_read_b64_tr_b16 v[166:167], v30 offset:27648
  s_mul_i32 s45, s55, 1920
  s_add_u32 s45, s45, 61440
  v_cndmask_b32 v61, v5, v46, vcc
  v_mfma_f32_16x16x32_bf16 v[64:67], v[148:151], a[72:75], v[64:67]
  ds_read_b64_tr_b16 v[168:169], v27 offset:27792
  ds_read_b64_tr_b16 v[170:171], v28 offset:27792
  v_mfma_f32_16x16x32_bf16 v[84:87], v[148:151], a[76:79], v[84:87]
  ds_read_b64_tr_b16 v[172:173], v27 offset:27832
  ds_read_b64_tr_b16 v[174:175], v28 offset:27832
  v_mul_u32_u24 v2, 40, v48
  v_lshl_add_u32 v2, v47, 3, v2
  s_waitcnt lgkmcnt(8)
  v_mfma_f32_16x16x32_bf16 v[68:71], v[152:155], a[72:75], v[68:71]
  ds_read_b64_tr_b16 v[144:145], v27 offset:27864
  ds_read_b64_tr_b16 v[146:147], v28 offset:27864
  v_mfma_f32_16x16x32_bf16 v[88:91], v[152:155], a[76:79], v[88:91]
  ds_read_b64_tr_b16 v[148:149], v27 offset:27904
  ds_read_b64_tr_b16 v[150:151], v28 offset:27904
  v_add_u32 v62, s45, v2
  v_mul_u32_u24 v3, 40, v252
  v_mfma_f32_16x16x32_bf16 v[72:75], v[156:159], a[72:75], v[72:75]
  s_cmp_eq_u32 s67, 2
  s_cselect_b32 s62, 1152, 0
  s_cselect_b32 s63, 1990656, 0
  s_sub_u32 s57, s57, s62
  v_mfma_f32_16x16x32_bf16 v[92:95], v[156:159], a[76:79], v[92:95]
  s_sub_u32 s58, s58, s63
  v_lshrrev_b32 v4, 2, v0
  s_lshr_b32 s44, 1280, s52
  v_lshl_add_u32 v3, v4, 3, v3
  s_waitcnt lgkmcnt(8)
  v_mfma_f32_16x16x32_bf16 v[76:79], v[160:163], a[72:75], v[76:79]
  v_add_u32 v3, s44, v3
  v_mul_u32_u24 v4, 40, v0
  v_mfma_f32_16x16x32_bf16 v[96:99], v[160:163], a[76:79], v[96:99]
  v_add_u32 v4, 4294966688, v4
  v_cndmask_b32 v3, v4, v3, vcc
  v_mfma_f32_16x16x32_bf16 v[80:83], v[164:167], a[72:75], v[80:83]
  v_add_u32 v63, s45, v3
  v_accvgpr_write_b32 a154, 0
  v_mfma_f32_16x16x32_bf16 v[100:103], v[164:167], a[76:79], v[100:103]
  s_waitcnt vmcnt(9) lgkmcnt(0)
  s_barrier
  v_mfma_f32_16x16x32_bf16 v[104:107], a[72:75], v[168:171], v[104:107]
  ds_read_b128 a[80:83], v19 offset:32768
  ds_read_b128 a[84:87], v19 offset:34816
  v_mfma_f32_16x16x32_bf16 v[124:127], a[76:79], v[168:171], v[124:127]
  ds_read_b64_tr_b16 v[152:153], v21 offset:36864
  ds_read_b64_tr_b16 v[154:155], v22 offset:36864
  v_accvgpr_write_b32 a155, 0
  v_mfma_f32_16x16x32_bf16 v[108:111], a[72:75], v[172:175], v[108:111]
  ds_read_b64_tr_b16 v[156:157], v21 offset:36872
  s_add_u32 m0, s60, 16384
  v_mfma_f32_16x16x32_bf16 v[128:131], a[76:79], v[172:175], v[128:131]
  ds_read_b64_tr_b16 v[158:159], v22 offset:36872
  buffer_load_dwordx4 v10, s[24:27], s57 offen offset:0 lds
  v_accvgpr_write_b32 a166, 0
  v_accvgpr_write_b32 a167, 0
  v_mfma_f32_16x16x32_bf16 v[112:115], a[72:75], v[144:147], v[112:115]
  ds_read_b64_tr_b16 v[160:161], v21 offset:36880
  buffer_load_dwordx4 v11, s[24:27], s57 offen offset:1024 lds
  v_mfma_f32_16x16x32_bf16 v[132:135], a[76:79], v[144:147], v[132:135]
  ds_read_b64_tr_b16 v[162:163], v22 offset:36880
  v_accvgpr_write_b32 a178, 0
  v_accvgpr_write_b32 a179, 0
  v_mfma_f32_16x16x32_bf16 v[116:119], a[72:75], v[148:151], v[116:119]
  ds_read_b64_tr_b16 v[164:165], v23 offset:36864
  buffer_load_dwordx4 v12, s[24:27], s57 offen offset:2048 lds
  v_mfma_f32_16x16x32_bf16 v[136:139], a[76:79], v[148:151], v[136:139]
  ds_read_b64_tr_b16 v[166:167], v24 offset:36864
  v_accvgpr_write_b32 a190, 0
  v_accvgpr_write_b32 a191, 0
  v_accvgpr_write_b32 a202, 0
  s_waitcnt lgkmcnt(4)
  v_mfma_f32_16x16x32_bf16 v[64:67], v[152:155], a[80:83], v[64:67]
  ds_read_b64_tr_b16 v[168:169], v29 offset:36864
  buffer_load_dwordx4 v13, s[24:27], s57 offen offset:3072 lds
  v_mfma_f32_16x16x32_bf16 v[84:87], v[152:155], a[84:87], v[84:87]
  ds_read_b64_tr_b16 v[170:171], v30 offset:36864
  v_accvgpr_write_b32 a203, 0
  s_lshr_b32 s44, s54, 1
  v_mfma_f32_16x16x32_bf16 v[68:71], v[156:159], a[80:83], v[68:71]
  ds_read_b64_tr_b16 v[172:173], v27 offset:37008
  s_add_u32 m0, s61, 18432
  s_mov_b32 exec_hi, 0
  buffer_load_dwordx4 v14, s[28:31], s58 offen lds
  s_mov_b32 exec_hi, -1
  v_mfma_f32_16x16x32_bf16 v[88:91], v[156:159], a[84:87], v[88:91]
  ds_read_b64_tr_b16 v[174:175], v28 offset:37008
  s_lshl_b32 s44, s44, 5
  s_lshl_b32 s45, s54, 7
  s_waitcnt lgkmcnt(4)
  v_mfma_f32_16x16x32_bf16 v[72:75], v[160:163], a[80:83], v[72:75]
  ds_read_b64_tr_b16 v[144:145], v27 offset:37048
  buffer_load_dwordx4 v15, s[28:31], s58 offen offset:512 lds
  v_mfma_f32_16x16x32_bf16 v[92:95], v[160:163], a[84:87], v[92:95]
  ds_read_b64_tr_b16 v[146:147], v28 offset:37048
  s_sub_u32 s44, s44, s45
  s_add_u32 s44, s44, 896
  s_movk_i32 s45, -160
  v_mfma_f32_16x16x32_bf16 v[76:79], v[164:167], a[80:83], v[76:79]
  ds_read_b64_tr_b16 v[148:149], v27 offset:37080
  buffer_load_dwordx4 v16, s[28:31], s58 offen offset:1536 lds
  v_mfma_f32_16x16x32_bf16 v[96:99], v[164:167], a[84:87], v[96:99]
  ds_read_b64_tr_b16 v[150:151], v28 offset:37080
  s_movk_i32 s46, 72
  s_and_b32 s47, s55, 1
  s_waitcnt lgkmcnt(4)
  v_mfma_f32_16x16x32_bf16 v[80:83], v[168:171], a[80:83], v[80:83]
  ds_read_b64_tr_b16 v[152:153], v27 offset:37120
  buffer_load_dwordx4 v17, s[28:31], s58 offen offset:2560 lds
  v_mfma_f32_16x16x32_bf16 v[100:103], v[168:171], a[84:87], v[100:103]
  ds_read_b64_tr_b16 v[154:155], v28 offset:37120
  s_lshl_b32 s47, s47, 4
  s_lshr_b32 s47, s78, s47
  v_mfma_f32_16x16x32_bf16 v[104:107], a[80:83], v[172:175], v[104:107]
  ds_read_b128 a[88:91], v20 offset:32768
  ds_read_b128 a[92:95], v20 offset:34816
  v_mfma_f32_16x16x32_bf16 v[124:127], a[84:87], v[172:175], v[124:127]
  ds_read_b64_tr_b16 v[156:157], v21 offset:46080
  ds_read_b64_tr_b16 v[158:159], v22 offset:46080
  v_mul_u32_u24 v8, 6554, v0
  v_lshrrev_b32 v1, 16, v8
  v_mad_i32_i24 v2, v1, s45, v46
  s_waitcnt lgkmcnt(6)
  v_mfma_f32_16x16x32_bf16 v[108:111], a[80:83], v[144:147], v[108:111]
  ds_read_b64_tr_b16 v[160:161], v21 offset:46088
  buffer_load_dwordx4 v18, s[28:31], s58 offen offset:3584 lds
  v_mfma_f32_16x16x32_bf16 v[128:131], a[84:87], v[144:147], v[128:131]
  ds_read_b64_tr_b16 v[162:163], v22 offset:46088
  s_add_u32 s57, s57, 128
  v_lshrrev_b32 v4, 7, v2
  v_mad_u32_u24 v2, v4, s44, v2
  v_mfma_f32_16x16x32_bf16 v[112:115], a[80:83], v[148:151], v[112:115]
  ds_read_b64_tr_b16 v[164:165], v21 offset:46096
  s_add_u32 s58, s58, 221184
  v_mfma_f32_16x16x32_bf16 v[132:135], a[84:87], v[148:151], v[132:135]
  ds_read_b64_tr_b16 v[166:167], v22 offset:46096
  v_lshrrev_b32 v3, 3, v1
  v_and_b32 v4, 1, v3
  s_waitcnt lgkmcnt(4)
  v_mfma_f32_16x16x32_bf16 v[116:119], a[80:83], v[152:155], v[116:119]
  ds_read_b64_tr_b16 v[168:169], v23 offset:46080
  ds_read_b64_tr_b16 v[170:171], v24 offset:46080
  v_mfma_f32_16x16x32_bf16 v[136:139], a[84:87], v[152:155], v[136:139]
  ds_read_b64_tr_b16 v[172:173], v29 offset:46080
  ds_read_b64_tr_b16 v[174:175], v30 offset:46080
  v_lshlrev_b32 v5, 2, v4
  v_xor_b32 v1, v1, v5
  v_and_b32 v5, 4, v1
  v_mfma_f32_16x16x32_bf16 v[64:67], v[156:159], a[88:91], v[64:67]
  ds_read_b64_tr_b16 v[144:145], v27 offset:46224
  ds_read_b64_tr_b16 v[146:147], v28 offset:46224
  v_mfma_f32_16x16x32_bf16 v[84:87], v[156:159], a[92:95], v[84:87]
  ds_read_b64_tr_b16 v[148:149], v27 offset:46264
L_tp1:
  s_cbranch_execz L_tret0
  ds_read_b64_tr_b16 v[150:151], v28 offset:46264
  v_and_b32 v9, 7, v1
  v_lshl_add_u32 v5, v5, 2, v9
  s_waitcnt lgkmcnt(8)
  v_mfma_f32_16x16x32_bf16 v[68:71], v[160:163], a[88:91], v[68:71]
  ds_read_b64_tr_b16 v[152:153], v27 offset:46296
  ds_read_b64_tr_b16 v[154:155], v28 offset:46296
  v_mfma_f32_16x16x32_bf16 v[88:91], v[160:163], a[92:95], v[88:91]
  ds_read_b64_tr_b16 v[156:157], v27 offset:46336
  ds_read_b64_tr_b16 v[158:159], v28 offset:46336
  v_lshl_add_u32 v5, v3, 2, v5
  v_mad_u32_u24 v36, v5, s59, v2
  v_mfma_f32_16x16x32_bf16 v[72:75], v[164:167], a[88:91], v[72:75]
  s_cmp_eq_u32 s67, 1
  s_cselect_b32 s62, 1152, 0
  s_cselect_b32 s63, 1990656, 0
  s_sub_u32 s57, s57, s62
  v_mfma_f32_16x16x32_bf16 v[92:95], v[164:167], a[92:95], v[92:95]
  s_sub_u32 s58, s58, s63
  v_and_b32 v5, 6, v1
  v_lshlrev_b32 v5, 1, v5
  v_bfe_u32 v5, s47, v5, 4
  s_waitcnt lgkmcnt(8)
  v_mfma_f32_16x16x32_bf16 v[76:79], v[168:171], a[88:91], v[76:79]
  v_and_b32 v1, 1, v1
  v_mad_u32_u24 v1, v3, 18, v1
  v_mfma_f32_16x16x32_bf16 v[96:99], v[168:171], a[92:95], v[96:99]
  v_xor_b32 v4, 1, v4
  v_lshl_add_u32 v1, v4, 4, v1
  v_mfma_f32_16x16x32_bf16 v[80:83], v[172:175], a[88:91], v[80:83]
  v_mad_u32_u24 v1, v5, s46, v1
  v_mad_u32_u24 v41, v1, s59, v2
  v_mfma_f32_16x16x32_bf16 v[100:103], v[172:175], a[92:95], v[100:103]
  s_waitcnt vmcnt(9) lgkmcnt(0)
  s_barrier
  v_mfma_f32_16x16x32_bf16 v[104:107], a[88:91], v[144:147], v[104:107]
  ds_read_b128 a[96:99], v19 offset:0
  ds_read_b128 a[100:103], v19 offset:2048
  v_mfma_f32_16x16x32_bf16 v[124:127], a[92:95], v[144:147], v[124:127]
  ds_read_b64_tr_b16 v[160:161], v21 offset:0
  ds_read_b64_tr_b16 v[162:163], v22 offset:0
  v_add_u32 v1, 419456, v8
  v_mfma_f32_16x16x32_bf16 v[108:111], a[88:91], v[148:151], v[108:111]
  ds_read_b64_tr_b16 v[164:165], v21 offset:8
  s_add_u32 m0, s60, 32768
  v_mfma_f32_16x16x32_bf16 v[128:131], a[92:95], v[148:151], v[128:131]
  ds_read_b64_tr_b16 v[166:167], v22 offset:8
  buffer_load_dwordx4 v10, s[24:27], s57 offen offset:0 lds
  v_lshrrev_b32 v1, 16, v1
  v_mad_i32_i24 v2, v1, s45, v46
  v_mfma_f32_16x16x32_bf16 v[112:115], a[88:91], v[152:155], v[112:115]
  ds_read_b64_tr_b16 v[168:169], v21 offset:16
  v_add_u32 v3, 1024, v2
  v_mfma_f32_16x16x32_bf16 v[132:135], a[92:95], v[152:155], v[132:135]
  ds_read_b64_tr_b16 v[170:171], v22 offset:16
  v_lshrrev_b32 v4, 7, v3
  v_mfma_f32_16x16x32_bf16 v[116:119], a[88:91], v[156:159], v[116:119]
  ds_read_b64_tr_b16 v[172:173], v23 offset:0
  buffer_load_dwordx4 v11, s[24:27], s57 offen offset:1024 lds
  v_mfma_f32_16x16x32_bf16 v[136:139], a[92:95], v[156:159], v[136:139]
  ds_read_b64_tr_b16 v[174:175], v24 offset:0
  v_mad_u32_u24 v2, v4, s44, v2
  v_lshrrev_b32 v3, 3, v1
  v_and_b32 v4, 1, v3
  s_waitcnt lgkmcnt(4)
  v_mfma_f32_16x16x32_bf16 v[64:67], v[160:163], a[96:99], v[64:67]
  ds_read_b64_tr_b16 v[144:145], v29 offset:0
  buffer_load_dwordx4 v12, s[24:27], s57 offen offset:2048 lds
  v_mfma_f32_16x16x32_bf16 v[84:87], v[160:163], a[100:103], v[84:87]
  ds_read_b64_tr_b16 v[146:147], v30 offset:0
  v_lshlrev_b32 v5, 2, v4
  v_xor_b32 v1, v1, v5
  v_mfma_f32_16x16x32_bf16 v[68:71], v[164:167], a[96:99], v[68:71]
  ds_read_b64_tr_b16 v[148:149], v27 offset:144
  v_and_b32 v5, 4, v1
  v_mfma_f32_16x16x32_bf16 v[88:91], v[164:167], a[100:103], v[88:91]
  ds_read_b64_tr_b16 v[150:151], v28 offset:144
  v_and_b32 v9, 7, v1
  s_waitcnt lgkmcnt(4)
  v_mfma_f32_16x16x32_bf16 v[72:75], v[168:171], a[96:99], v[72:75]
  ds_read_b64_tr_b16 v[152:153], v27 offset:184
  buffer_load_dwordx4 v13, s[24:27], s57 offen offset:3072 lds
  v_mfma_f32_16x16x32_bf16 v[92:95], v[168:171], a[100:103], v[92:95]
  ds_read_b64_tr_b16 v[154:155], v28 offset:184
  v_lshl_add_u32 v5, v5, 2, v9
  v_lshl_add_u32 v5, v3, 2, v5
  v_mad_u32_u24 v37, v5, s59, v2
  v_mfma_f32_16x16x32_bf16 v[76:79], v[172:175], a[96:99], v[76:79]
  ds_read_b64_tr_b16 v[156:157], v27 offset:216
  s_add_u32 m0, s61, 36864
  s_mov_b32 exec_hi, 0
  buffer_load_dwordx4 v14, s[28:31], s58 offen lds
  s_mov_b32 exec_hi, -1
  v_mfma_f32_16x16x32_bf16 v[96:99], v[172:175], a[100:103], v[96:99]
  ds_read_b64_tr_b16 v[158:159], v28 offset:216
  v_and_b32 v5, 6, v1
  v_lshlrev_b32 v5, 1, v5
  s_waitcnt lgkmcnt(4)
  v_mfma_f32_16x16x32_bf16 v[80:83], v[144:147], a[96:99], v[80:83]
  ds_read_b64_tr_b16 v[160:161], v27 offset:256
  v_bfe_u32 v5, s47, v5, 4
  v_mfma_f32_16x16x32_bf16 v[100:103], v[144:147], a[100:103], v[100:103]
  ds_read_b64_tr_b16 v[162:163], v28 offset:256
  v_and_b32 v1, 1, v1
  v_mfma_f32_16x16x32_bf16 v[104:107], a[96:99], v[148:151], v[104:107]
  ds_read_b128 a[104:107], v20 offset:0
  ds_read_b128 a[108:111], v20 offset:2048
  v_mfma_f32_16x16x32_bf16 v[124:127], a[100:103], v[148:151], v[124:127]
  ds_read_b64_tr_b16 v[164:165], v21 offset:9216
  ds_read_b64_tr_b16 v[166:167], v22 offset:9216
  v_mad_u32_u24 v1, v3, 18, v1
  v_xor_b32 v4, 1, v4
  v_lshl_add_u32 v1, v4, 4, v1
  s_waitcnt lgkmcnt(6)
  v_mfma_f32_16x16x32_bf16 v[108:111], a[96:99], v[152:155], v[108:111]
  ds_read_b64_tr_b16 v[168:169], v21 offset:9224
  buffer_load_dwordx4 v15, s[28:31], s58 offen offset:512 lds
  v_mfma_f32_16x16x32_bf16 v[128:131], a[100:103], v[152:155], v[128:131]
  ds_read_b64_tr_b16 v[170:171], v22 offset:9224
  buffer_load_dwordx4 v16, s[28:31], s58 offen offset:1536 lds
  v_mad_u32_u24 v1, v5, s46, v1
  v_mad_u32_u24 v42, v1, s59, v2
  v_mfma_f32_16x16x32_bf16 v[112:115], a[96:99], v[156:159], v[112:115]
  ds_read_b64_tr_b16 v[172:173], v21 offset:9232
  v_add_u32 v1, 838912, v8
  v_mfma_f32_16x16x32_bf16 v[132:135], a[100:103], v[156:159], v[132:135]
  ds_read_b64_tr_b16 v[174:175], v22 offset:9232
  v_lshrrev_b32 v1, 16, v1
  s_waitcnt lgkmcnt(4)
  v_mfma_f32_16x16x32_bf16 v[116:119], a[96:99], v[160:163], v[116:119]
  ds_read_b64_tr_b16 v[144:145], v23 offset:9216
  ds_read_b64_tr_b16 v[146:147], v24 offset:9216
  v_mfma_f32_16x16x32_bf16 v[136:139], a[100:103], v[160:163], v[136:139]
  ds_read_b64_tr_b16 v[148:149], v29 offset:9216
  ds_read_b64_tr_b16 v[150:151], v30 offset:9216
  v_mad_i32_i24 v2, v1, s45, v46
  v_add_u32 v3, 2048, v2
  v_lshrrev_b32 v4, 7, v3
  v_mfma_f32_16x16x32_bf16 v[64:67], v[164:167], a[104:107], v[64:67]
  ds_read_b64_tr_b16 v[152:153], v27 offset:9360
  ds_read_b64_tr_b16 v[154:155], v28 offset:9360
  v_mfma_f32_16x16x32_bf16 v[84:87], v[164:167], a[108:111], v[84:87]
  ds_read_b64_tr_b16 v[156:157], v27 offset:9400
  ds_read_b64_tr_b16 v[158:159], v28 offset:9400
  v_mad_u32_u24 v2, v4, s44, v2
  v_lshrrev_b32 v3, 3, v1
  s_waitcnt lgkmcnt(8)
  v_mfma_f32_16x16x32_bf16 v[68:71], v[168:171], a[104:107], v[68:71]
  ds_read_b64_tr_b16 v[160:161], v27 offset:9432
  ds_read_b64_tr_b16 v[162:163], v28 offset:9432
  v_mfma_f32_16x16x32_bf16 v[88:91], v[168:171], a[108:111], v[88:91]
  ds_read_b64_tr_b16 v[164:165], v27 offset:9472
  ds_read_b64_tr_b16 v[166:167], v28 offset:9472
  v_and_b32 v4, 1, v3
  v_lshlrev_b32 v5, 2, v4
  v_mfma_f32_16x16x32_bf16 v[72:75], v[172:175], a[104:107], v[72:75]
  buffer_load_dwordx4 v17, s[28:31], s58 offen offset:2560 lds
  buffer_load_dwordx4 v18, s[28:31], s58 offen offset:3584 lds
  v_mfma_f32_16x16x32_bf16 v[92:95], v[172:175], a[108:111], v[92:95]
  v_xor_b32 v1, v1, v5
  v_and_b32 v5, 4, v1
  v_and_b32 v9, 7, v1
  s_waitcnt lgkmcnt(8)
  v_mfma_f32_16x16x32_bf16 v[76:79], v[144:147], a[104:107], v[76:79]
  v_lshl_add_u32 v5, v5, 2, v9
  v_lshl_add_u32 v5, v3, 2, v5
  v_mfma_f32_16x16x32_bf16 v[96:99], v[144:147], a[108:111], v[96:99]
  v_mad_u32_u24 v38, v5, s59, v2
  v_and_b32 v5, 6, v1
  v_mfma_f32_16x16x32_bf16 v[80:83], v[148:151], a[104:107], v[80:83]
  v_lshlrev_b32 v5, 1, v5
  v_bfe_u32 v5, s47, v5, 4
  v_mfma_f32_16x16x32_bf16 v[100:103], v[148:151], a[108:111], v[100:103]
  s_waitcnt vmcnt(9) lgkmcnt(0)
  s_barrier
  v_mfma_f32_16x16x32_bf16 v[104:107], a[104:107], v[152:155], v[104:107]
  ds_read_b128 a[112:115], v19 offset:16384
  ds_read_b128 a[116:119], v19 offset:18432
  v_mfma_f32_16x16x32_bf16 v[124:127], a[108:111], v[152:155], v[124:127]
  ds_read_b64_tr_b16 v[168:169], v21 offset:18432
  ds_read_b64_tr_b16 v[170:171], v22 offset:18432
  v_and_b32 v1, 1, v1
  v_mfma_f32_16x16x32_bf16 v[108:111], a[104:107], v[156:159], v[108:111]
  ds_read_b64_tr_b16 v[172:173], v21 offset:18440
  v_mad_u32_u24 v1, v3, 18, v1
  v_mfma_f32_16x16x32_bf16 v[128:131], a[108:111], v[156:159], v[128:131]
  ds_read_b64_tr_b16 v[174:175], v22 offset:18440
  v_xor_b32 v4, 1, v4
  v_mfma_f32_16x16x32_bf16 v[112:115], a[104:107], v[160:163], v[112:115]
  ds_read_b64_tr_b16 v[144:145], v21 offset:18448
  s_add_u32 m0, s80, 104448
  s_mov_b32 exec_hi, 0
  buffer_load_dwordx4 v31, s[28:31], s56 offen lds
  s_mov_b32 exec_hi, -1
  v_mfma_f32_16x16x32_bf16 v[132:135], a[108:111], v[160:163], v[132:135]
  ds_read_b64_tr_b16 v[146:147], v22 offset:18448
  v_lshl_add_u32 v1, v4, 4, v1
  v_mad_u32_u24 v1, v5, s46, v1
  v_mfma_f32_16x16x32_bf16 v[116:119], a[104:107], v[164:167], v[116:119]
  ds_read_b64_tr_b16 v[148:149], v23 offset:18432
  v_mad_u32_u24 v43, v1, s59, v2
  v_mfma_f32_16x16x32_bf16 v[136:139], a[108:111], v[164:167], v[136:139]
  ds_read_b64_tr_b16 v[150:151], v24 offset:18432
  v_add_u32 v1, 1258368, v8
  v_lshrrev_b32 v1, 16, v1
  s_waitcnt lgkmcnt(4)
  v_mfma_f32_16x16x32_bf16 v[64:67], v[168:171], a[112:115], v[64:67]
  ds_read_b64_tr_b16 v[152:153], v29 offset:18432
  buffer_load_dwordx4 v32, s[28:31], s56 offen offset:512 lds
  v_mfma_f32_16x16x32_bf16 v[84:87], v[168:171], a[116:119], v[84:87]
  ds_read_b64_tr_b16 v[154:155], v30 offset:18432
  v_mad_i32_i24 v2, v1, s45, v46
  v_add_u32 v3, 3072, v2
  v_mfma_f32_16x16x32_bf16 v[68:71], v[172:175], a[112:115], v[68:71]
  ds_read_b64_tr_b16 v[156:157], v27 offset:18576
  v_lshrrev_b32 v4, 7, v3
  v_mfma_f32_16x16x32_bf16 v[88:91], v[172:175], a[116:119], v[88:91]
  ds_read_b64_tr_b16 v[158:159], v28 offset:18576
  v_mad_u32_u24 v2, v4, s44, v2
  s_waitcnt lgkmcnt(4)
  v_mfma_f32_16x16x32_bf16 v[72:75], v[144:147], a[112:115], v[72:75]
  ds_read_b64_tr_b16 v[160:161], v27 offset:18616
  buffer_load_dwordx4 v33, s[28:31], s56 offen offset:1536 lds
  v_mfma_f32_16x16x32_bf16 v[92:95], v[144:147], a[116:119], v[92:95]
  ds_read_b64_tr_b16 v[162:163], v28 offset:18616
  v_lshrrev_b32 v3, 3, v1
  v_and_b32 v4, 1, v3
  v_lshlrev_b32 v5, 2, v4
  v_mfma_f32_16x16x32_bf16 v[76:79], v[148:151], a[112:115], v[76:79]
  ds_read_b64_tr_b16 v[164:165], v27 offset:18648
  v_xor_b32 v1, v1, v5
  v_mfma_f32_16x16x32_bf16 v[96:99], v[148:151], a[116:119], v[96:99]
  ds_read_b64_tr_b16 v[166:167], v28 offset:18648
  v_and_b32 v5, 4, v1
  s_waitcnt lgkmcnt(4)
  v_mfma_f32_16x16x32_bf16 v[80:83], v[152:155], a[112:115], v[80:83]
  ds_read_b64_tr_b16 v[168:169], v27 offset:18688
  buffer_load_dwordx4 v34, s[28:31], s56 offen offset:2560 lds
  v_mfma_f32_16x16x32_bf16 v[100:103], v[152:155], a[116:119], v[100:103]
  ds_read_b64_tr_b16 v[170:171], v28 offset:18688
  v_and_b32 v9, 7, v1
  v_lshl_add_u32 v5, v5, 2, v9
  v_mfma_f32_16x16x32_bf16 v[104:107], a[112:115], v[156:159], v[104:107]
  ds_read_b128 a[120:123], v20 offset:16384
  ds_read_b128 a[124:127], v20 offset:18432
  v_mfma_f32_16x16x32_bf16 v[124:127], a[116:119], v[156:159], v[124:127]
  ds_read_b64_tr_b16 v[172:173], v21 offset:27648
  ds_read_b64_tr_b16 v[174:175], v22 offset:27648
  v_lshl_add_u32 v5, v3, 2, v5
  v_mad_u32_u24 v39, v5, s59, v2
  v_and_b32 v5, 6, v1
  s_waitcnt lgkmcnt(6)
  v_mfma_f32_16x16x32_bf16 v[108:111], a[112:115], v[160:163], v[108:111]
  ds_read_b64_tr_b16 v[144:145], v21 offset:27656
  v_lshlrev_b32 v5, 1, v5
  v_mfma_f32_16x16x32_bf16 v[128:131], a[116:119], v[160:163], v[128:131]
  ds_read_b64_tr_b16 v[146:147], v22 offset:27656
  v_bfe_u32 v5, s47, v5, 4
  v_mfma_f32_16x16x32_bf16 v[112:115], a[112:115], v[164:167], v[112:115]
  ds_read_b64_tr_b16 v[148:149], v21 offset:27664
  buffer_load_dwordx4 v35, s[28:31], s56 offen offset:3584 lds
  v_mfma_f32_16x16x32_bf16 v[132:135], a[116:119], v[164:167], v[132:135]
  ds_read_b64_tr_b16 v[150:151], v22 offset:27664
  v_and_b32 v1, 1, v1
  v_mad_u32_u24 v1, v3, 18, v1
  s_waitcnt lgkmcnt(4)
  v_mfma_f32_16x16x32_bf16 v[116:119], a[112:115], v[168:171], v[116:119]
  ds_read_b64_tr_b16 v[152:153], v23 offset:27648
  ds_read_b64_tr_b16 v[154:155], v24 offset:27648
  v_mfma_f32_16x16x32_bf16 v[136:139], a[116:119], v[168:171], v[136:139]
  ds_read_b64_tr_b16 v[156:157], v29 offset:27648
  ds_read_b64_tr_b16 v[158:159], v30 offset:27648
  v_xor_b32 v4, 1, v4
  v_lshl_add_u32 v1, v4, 4, v1
  v_mad_u32_u24 v1, v5, s46, v1
  v_mfma_f32_16x16x32_bf16 v[64:67], v[172:175], a[120:123], v[64:67]
  ds_read_b64_tr_b16 v[160:161], v27 offset:27792
  ds_read_b64_tr_b16 v[162:163], v28 offset:27792
  v_mfma_f32_16x16x32_bf16 v[84:87], v[172:175], a[124:127], v[84:87]
  ds_read_b64_tr_b16 v[164:165], v27 offset:27832
  ds_read_b64_tr_b16 v[166:167], v28 offset:27832
  v_mad_u32_u24 v44, v1, s59, v2
  v_add_u32 v1, 1677824, v8
  s_waitcnt lgkmcnt(8)
  v_mfma_f32_16x16x32_bf16 v[68:71], v[144:147], a[120:123], v[68:71]
  ds_read_b64_tr_b16 v[168:169], v27 offset:27864
  ds_read_b64_tr_b16 v[170:171], v28 offset:27864
  v_mfma_f32_16x16x32_bf16 v[88:91], v[144:147], a[124:127], v[88:91]
  ds_read_b64_tr_b16 v[172:173], v27 offset:27904
  ds_read_b64_tr_b16 v[174:175], v28 offset:27904
  v_lshrrev_b32 v1, 16, v1
  v_mad_i32_i24 v2, v1, s45, v46
  v_mfma_f32_16x16x32_bf16 v[72:75], v[148:151], a[120:123], v[72:75]
  s_add_u32 s56, s56, 442368
  s_cmp_ge_u32 s56, s50
  s_cselect_b32 s62, 1990656, 0
  s_sub_u32 s56, s56, s62
  v_mfma_f32_16x16x32_bf16 v[92:95], v[148:151], a[124:127], v[92:95]
  v_add_u32 v3, 4096, v2
  v_lshrrev_b32 v4, 7, v3
  v_mad_u32_u24 v2, v4, s44, v3
  s_waitcnt lgkmcnt(8)
  v_mfma_f32_16x16x32_bf16 v[76:79], v[152:155], a[120:123], v[76:79]
  v_lshrrev_b32 v3, 3, v1
  v_and_b32 v4, 1, v3
  v_mfma_f32_16x16x32_bf16 v[96:99], v[152:155], a[124:127], v[96:99]
  v_lshlrev_b32 v5, 2, v4
  v_xor_b32 v1, v1, v5
  v_mfma_f32_16x16x32_bf16 v[80:83], v[156:159], a[120:123], v[80:83]
  v_and_b32 v5, 4, v1
  v_and_b32 v9, 7, v1
  v_mfma_f32_16x16x32_bf16 v[100:103], v[156:159], a[124:127], v[100:103]
  s_waitcnt vmcnt(5) lgkmcnt(0)
  s_barrier
  v_mfma_f32_16x16x32_bf16 v[104:107], a[120:123], v[160:163], v[104:107]
  ds_read_b128 a[128:131], v19 offset:32768
  ds_read_b128 a[132:135], v19 offset:34816
  v_mfma_f32_16x16x32_bf16 v[124:127], a[124:127], v[160:163], v[124:127]
  ds_read_b64_tr_b16 v[144:145], v21 offset:36864
  ds_read_b64_tr_b16 v[146:147], v22 offset:36864
  v_lshl_add_u32 v5, v5, 2, v9
  v_mfma_f32_16x16x32_bf16 v[108:111], a[120:123], v[164:167], v[108:111]
  ds_read_b64_tr_b16 v[148:149], v21 offset:36872
  s_add_u32 m0, s80, 122880
  s_mov_b32 exec_hi, 0
  buffer_load_dwordx4 v31, s[28:31], s56 offen lds
  s_mov_b32 exec_hi, -1
  v_mfma_f32_16x16x32_bf16 v[128:131], a[124:127], v[164:167], v[128:131]
  ds_read_b64_tr_b16 v[150:151], v22 offset:36872
  v_lshl_add_u32 v5, v3, 2, v5
  v_mad_u32_u24 v40, v5, s59, v2
  v_mfma_f32_16x16x32_bf16 v[112:115], a[120:123], v[168:171], v[112:115]
  ds_read_b64_tr_b16 v[152:153], v21 offset:36880
  buffer_load_dwordx4 v32, s[28:31], s56 offen offset:512 lds
  v_mfma_f32_16x16x32_bf16 v[132:135], a[124:127], v[168:171], v[132:135]
  ds_read_b64_tr_b16 v[154:155], v22 offset:36880
  v_and_b32 v5, 6, v1
  v_lshlrev_b32 v5, 1, v5
  v_mfma_f32_16x16x32_bf16 v[116:119], a[120:123], v[172:175], v[116:119]
  ds_read_b64_tr_b16 v[156:157], v23 offset:36864
  v_bfe_u32 v5, s47, v5, 4
  v_mfma_f32_16x16x32_bf16 v[136:139], a[124:127], v[172:175], v[136:139]
  ds_read_b64_tr_b16 v[158:159], v24 offset:36864
  v_and_b32 v1, 1, v1
  v_mad_u32_u24 v1, v3, 18, v1
  s_waitcnt lgkmcnt(4)
  v_mfma_f32_16x16x32_bf16 v[64:67], v[144:147], a[128:131], v[64:67]
  ds_read_b64_tr_b16 v[160:161], v29 offset:36864
  buffer_load_dwordx4 v33, s[28:31], s56 offen offset:1536 lds
  v_mfma_f32_16x16x32_bf16 v[84:87], v[144:147], a[132:135], v[84:87]
  ds_read_b64_tr_b16 v[162:163], v30 offset:36864
  v_xor_b32 v4, 1, v4
  v_lshl_add_u32 v1, v4, 4, v1
  v_mfma_f32_16x16x32_bf16 v[68:71], v[148:151], a[128:131], v[68:71]
  ds_read_b128 a[136:139], v20 offset:32768
  ds_read_b128 a[140:143], v20 offset:34816
  v_mfma_f32_16x16x32_bf16 v[88:91], v[148:151], a[132:135], v[88:91]
  ds_read_b64_tr_b16 v[164:165], v21 offset:46080
  ds_read_b64_tr_b16 v[166:167], v22 offset:46080
  v_mad_u32_u24 v1, v5, s46, v1
  v_mad_u32_u24 v45, v1, s59, v2
  s_waitcnt lgkmcnt(6)
  v_mfma_f32_16x16x32_bf16 v[72:75], v[152:155], a[128:131], v[72:75]
  ds_read_b64_tr_b16 v[168:169], v21 offset:46088
  buffer_load_dwordx4 v34, s[28:31], s56 offen offset:2560 lds
  v_mfma_f32_16x16x32_bf16 v[92:95], v[152:155], a[132:135], v[92:95]
  ds_read_b64_tr_b16 v[170:171], v22 offset:46088
  v_mfma_f32_16x16x32_bf16 v[76:79], v[156:159], a[128:131], v[76:79]
  ds_read_b64_tr_b16 v[172:173], v21 offset:46096
  v_mfma_f32_16x16x32_bf16 v[96:99], v[156:159], a[132:135], v[96:99]
  ds_read_b64_tr_b16 v[174:175], v22 offset:46096
  s_waitcnt lgkmcnt(4)
  v_mfma_f32_16x16x32_bf16 v[80:83], v[160:163], a[128:131], v[80:83]
  ds_read_b64_tr_b16 v[144:145], v23 offset:46080
  v_mfma_f32_16x16x32_bf16 v[100:103], v[160:163], a[132:135], v[100:103]
  ds_read_b64_tr_b16 v[146:147], v24 offset:46080
  v_mfma_f32_16x16x32_bf16 v[64:67], v[164:167], a[136:139], v[64:67]
  ds_read_b64_tr_b16 v[148:149], v29 offset:46080
  buffer_load_dwordx4 v35, s[28:31], s56 offen offset:3584 lds
  v_mfma_f32_16x16x32_bf16 v[84:87], v[164:167], a[140:143], v[84:87]
  ds_read_b64_tr_b16 v[150:151], v30 offset:46080
  s_waitcnt lgkmcnt(4)
  v_mfma_f32_16x16x32_bf16 v[68:71], v[168:171], a[136:139], v[68:71]
  ds_read_b64_tr_b16 v[152:153], v27 offset:37008
  v_mfma_f32_16x16x32_bf16 v[88:91], v[168:171], a[140:143], v[88:91]
  ds_read_b64_tr_b16 v[154:155], v28 offset:37008
  v_mfma_f32_16x16x32_bf16 v[72:75], v[172:175], a[136:139], v[72:75]
  ds_read_b64_tr_b16 v[156:157], v27 offset:37048
  s_add_u32 s56, s56, 442368
  s_cmp_ge_u32 s56, s50
  s_cselect_b32 s62, 1990656, 0
  v_mfma_f32_16x16x32_bf16 v[92:95], v[172:175], a[140:143], v[92:95]
  ds_read_b64_tr_b16 v[158:159], v28 offset:37048
  s_waitcnt lgkmcnt(4)
  v_mfma_f32_16x16x32_bf16 v[76:79], v[144:147], a[136:139], v[76:79]
  ds_read_b64_tr_b16 v[160:161], v27 offset:37080
  ds_read_b64_tr_b16 v[162:163], v28 offset:37080
  v_mfma_f32_16x16x32_bf16 v[96:99], v[144:147], a[140:143], v[96:99]
  ds_read_b64_tr_b16 v[164:165], v27 offset:37120
  ds_read_b64_tr_b16 v[166:167], v28 offset:37120
  v_mfma_f32_16x16x32_bf16 v[80:83], v[148:151], a[136:139], v[80:83]
  ds_read_b64_tr_b16 v[168:169], v27 offset:46224
  ds_read_b64_tr_b16 v[170:171], v28 offset:46224
  v_mfma_f32_16x16x32_bf16 v[100:103], v[148:151], a[140:143], v[100:103]
  ds_read_b64_tr_b16 v[172:173], v27 offset:46264
  ds_read_b64_tr_b16 v[174:175], v28 offset:46264
  s_waitcnt lgkmcnt(8)
  v_mfma_f32_16x16x32_bf16 v[104:107], a[128:131], v[152:155], v[104:107]
  ds_read_b64_tr_b16 v[144:145], v27 offset:46296
  ds_read_b64_tr_b16 v[146:147], v28 offset:46296
  v_mfma_f32_16x16x32_bf16 v[124:127], a[132:135], v[152:155], v[124:127]
  ds_read_b64_tr_b16 v[148:149], v27 offset:46336
  ds_read_b64_tr_b16 v[150:151], v28 offset:46336
  v_mfma_f32_16x16x32_bf16 v[108:111], a[128:131], v[156:159], v[108:111]
  s_sub_u32 s56, s56, s62
  v_cvt_pk_bf16_f32 v176, v64, v65
  v_mfma_f32_16x16x32_bf16 v[128:131], a[132:135], v[156:159], v[128:131]
  v_cvt_pk_bf16_f32 v177, v66, v67
  s_waitcnt lgkmcnt(8)
  v_mfma_f32_16x16x32_bf16 v[112:115], a[128:131], v[160:163], v[112:115]
  v_cvt_pk_bf16_f32 v178, v68, v69
  v_cvt_pk_bf16_f32 v179, v70, v71
  v_mfma_f32_16x16x32_bf16 v[132:135], a[132:135], v[160:163], v[132:135]
  v_cvt_pk_bf16_f32 v180, v72, v73
  v_cvt_pk_bf16_f32 v181, v74, v75
  v_mfma_f32_16x16x32_bf16 v[116:119], a[128:131], v[164:167], v[116:119]
  v_cvt_pk_bf16_f32 v182, v76, v77
  v_cvt_pk_bf16_f32 v183, v78, v79
  v_mfma_f32_16x16x32_bf16 v[136:139], a[132:135], v[164:167], v[136:139]
  s_waitcnt lgkmcnt(0)
  s_barrier
  v_mfma_f32_16x16x32_bf16 v[104:107], a[136:139], v[168:171], v[104:107]
  v_permlane16_swap_b32 v80, v82
  v_permlane16_swap_b32 v81, v83
  v_mfma_f32_16x16x32_bf16 v[124:127], a[140:143], v[168:171], v[124:127]
  v_cvt_pk_bf16_f32 v184, v80, v81
  v_cvt_pk_bf16_f32 v186, v82, v83
  v_mfma_f32_16x16x32_bf16 v[108:111], a[136:139], v[172:175], v[108:111]
  v_mov_b32 v218, v186
  v_cvt_pk_bf16_f32 v188, v84, v85
  v_mfma_f32_16x16x32_bf16 v[128:131], a[140:143], v[172:175], v[128:131]
  v_cvt_pk_bf16_f32 v189, v86, v87
  v_cvt_pk_bf16_f32 v190, v88, v89
  v_mfma_f32_16x16x32_bf16 v[112:115], a[136:139], v[144:147], v[112:115]
  v_cvt_pk_bf16_f32 v191, v90, v91
  v_cvt_pk_bf16_f32 v192, v92, v93
  v_mfma_f32_16x16x32_bf16 v[132:135], a[140:143], v[144:147], v[132:135]
  v_cvt_pk_bf16_f32 v193, v94, v95
  v_cvt_pk_bf16_f32 v194, v96, v97
  v_mfma_f32_16x16x32_bf16 v[116:119], a[136:139], v[148:151], v[116:119]
  v_cvt_pk_bf16_f32 v195, v98, v99
  v_permlane16_swap_b32 v100, v102
  v_mfma_f32_16x16x32_bf16 v[136:139], a[140:143], v[148:151], v[136:139]
  v_permlane16_swap_b32 v101, v103
  v_cvt_pk_bf16_f32 v196, v100, v101
  v_cvt_pk_bf16_f32 v198, v102, v103
  v_mov_b32 v238, v198
  s_cmp_lg_u32 s52, 0
  s_cbranch_scc1 L_tailA
L_tailB:
  v_mfma_f32_16x16x32_bf16 v[64:67], a[144:147], v[176:179], 0
  s_add_u32 m0, s80, 141312
  s_mov_b32 exec_hi, 0
  buffer_load_dwordx4 v31, s[28:31], s56 offen lds
  s_mov_b32 exec_hi, -1
  v_mfma_f32_16x16x32_bf16 v[68:71], a[156:159], v[176:179], 0
  v_cvt_pk_bf16_f32 v104, v104, v105
  v_cvt_pk_bf16_f32 v105, v106, v107
  v_mfma_f32_16x16x32_bf16 v[72:75], a[168:171], v[176:179], 0
  v_cvt_pk_bf16_f32 v106, v124, v125
  v_cvt_pk_bf16_f32 v107, v126, v127
  v_mfma_f32_16x16x32_bf16 v[76:79], a[180:183], v[176:179], 0
  v_cvt_pk_bf16_f32 v108, v108, v109
  v_cvt_pk_bf16_f32 v109, v110, v111
  v_mfma_f32_16x16x32_bf16 v[80:83], a[192:195], v[176:179], 0
  v_cvt_pk_bf16_f32 v110, v128, v129
  v_cvt_pk_bf16_f32 v111, v130, v131
  v_mfma_f32_16x16x32_bf16 v[64:67], a[148:151], v[180:183], v[64:67]
  buffer_load_dwordx4 v32, s[28:31], s56 offen offset:512 lds
  v_cvt_pk_bf16_f32 v112, v112, v113
  v_mfma_f32_16x16x32_bf16 v[68:71], a[160:163], v[180:183], v[68:71]
  ds_write_b128 v56, v[104:107] offset:0
  v_mfma_f32_16x16x32_bf16 v[72:75], a[172:175], v[180:183], v[72:75]
  v_cvt_pk_bf16_f32 v113, v114, v115
  v_cvt_pk_bf16_f32 v114, v132, v133
  v_mfma_f32_16x16x32_bf16 v[76:79], a[184:187], v[180:183], v[76:79]
  v_cvt_pk_bf16_f32 v115, v134, v135
  v_cvt_pk_bf16_f32 v116, v116, v117
  v_mfma_f32_16x16x32_bf16 v[80:83], a[196:199], v[180:183], v[80:83]
  ds_write_b128 v56, v[108:111] offset:1024
  v_mfma_f32_16x16x32_bf16 v[64:67], a[152:155], v[184:187], v[64:67]
  buffer_load_dwordx4 v33, s[28:31], s56 offen offset:1536 lds
  v_cvt_pk_bf16_f32 v117, v118, v119
  v_mfma_f32_16x16x32_bf16 v[68:71], a[164:167], v[184:187], v[68:71]
  v_cvt_pk_bf16_f32 v118, v136, v137
  v_cvt_pk_bf16_f32 v119, v138, v139
  v_mfma_f32_16x16x32_bf16 v[72:75], a[176:179], v[184:187], v[72:75]
  ds_write_b128 v56, v[112:115] offset:2048
  v_mfma_f32_16x16x32_bf16 v[76:79], a[188:191], v[184:187], v[76:79]
  v_mov_b32 v1, s82
  s_mov_b32 s72, 0
  v_mfma_f32_16x16x32_bf16 v[80:83], a[200:203], v[184:187], v[80:83]
  buffer_load_dwordx4 v34, s[28:31], s56 offen offset:2560 lds
  v_add_u32 v21, 55296, v21
  v_mfma_f32_16x16x32_bf16 v[84:87], a[144:147], v[188:191], 0
  v_add_u32 v22, 55296, v22
  v_add_u32 v23, 55296, v23
  v_mfma_f32_16x16x32_bf16 v[88:91], a[156:159], v[188:191], 0
  ds_write_b128 v56, v[116:119] offset:3072
  v_mfma_f32_16x16x32_bf16 v[92:95], a[168:171], v[188:191], 0
  v_add_u32 v24, 55296, v24
  v_add_u32 v25, 55296, v25
  v_mfma_f32_16x16x32_bf16 v[96:99], a[180:183], v[188:191], 0
  v_add_u32 v26, 55296, v26
  v_mfma_f32_16x16x32_bf16 v[100:103], a[192:195], v[188:191], 0
  v_mfma_f32_16x16x32_bf16 v[84:87], a[148:151], v[192:195], v[84:87]
  v_mfma_f32_16x16x32_bf16 v[88:91], a[160:163], v[192:195], v[88:91]
  v_mfma_f32_16x16x32_bf16 v[92:95], a[172:175], v[192:195], v[92:95]
  v_mfma_f32_16x16x32_bf16 v[96:99], a[184:187], v[192:195], v[96:99]
  v_mfma_f32_16x16x32_bf16 v[100:103], a[196:199], v[192:195], v[100:103]
  v_max3_f32 v162, v64, v65, v66
  v_max3_f32 v162, v162, v67, v68
  v_mfma_f32_16x16x32_bf16 v[84:87], a[152:155], v[196:199], v[84:87]
  v_max3_f32 v162, v162, v69, v70
  v_max3_f32 v162, v162, v71, v72
  v_mfma_f32_16x16x32_bf16 v[88:91], a[164:167], v[196:199], v[88:91]
  v_max3_f32 v162, v162, v73, v74
  v_max3_f32 v162, v162, v75, v76
  v_mfma_f32_16x16x32_bf16 v[92:95], a[176:179], v[196:199], v[92:95]
  v_max3_f32 v162, v162, v77, v78
  v_max3_f32 v162, v162, v79, v80
  v_mfma_f32_16x16x32_bf16 v[96:99], a[188:191], v[196:199], v[96:99]
  v_max_f32 v162, v162, v81
  v_mul_f32 v164, s74, v162
  v_mfma_f32_16x16x32_bf16 v[100:103], a[200:203], v[196:199], v[100:103]
  v_pk_fma_f32 v[64:65], v[64:65], s[74:75], v[164:165] op_sel:[0,0,0] op_sel_hi:[1,1,0] neg_lo:[0,0,1] neg_hi:[0,0,1]
  v_pk_fma_f32 v[66:67], v[66:67], s[74:75], v[164:165] op_sel:[0,0,0] op_sel_hi:[1,1,0] neg_lo:[0,0,1] neg_hi:[0,0,1]
  v_pk_fma_f32 v[68:69], v[68:69], s[74:75], v[164:165] op_sel:[0,0,0] op_sel_hi:[1,1,0] neg_lo:[0,0,1] neg_hi:[0,0,1]
  buffer_load_dwordx4 v35, s[28:31], s56 offen offset:3584 lds
  s_add_u32 s56, s56, 442368
  s_cmp_ge_u32 s56, s50
  s_cselect_b32 s62, 1990656, 0
  s_sub_u32 s56, s56, s62
  v_pk_fma_f32 v[70:71], v[70:71], s[74:75], v[164:165] op_sel:[0,0,0] op_sel_hi:[1,1,0] neg_lo:[0,0,1] neg_hi:[0,0,1]
  v_pk_fma_f32 v[72:73], v[72:73], s[74:75], v[164:165] op_sel:[0,0,0] op_sel_hi:[1,1,0] neg_lo:[0,0,1] neg_hi:[0,0,1]
  v_pk_fma_f32 v[74:75], v[74:75], s[74:75], v[164:165] op_sel:[0,0,0] op_sel_hi:[1,1,0] neg_lo:[0,0,1] neg_hi:[0,0,1]
  v_pk_fma_f32 v[76:77], v[76:77], s[74:75], v[164:165] op_sel:[0,0,0] op_sel_hi:[1,1,0] neg_lo:[0,0,1] neg_hi:[0,0,1]
  v_pk_fma_f32 v[78:79], v[78:79], s[74:75], v[164:165] op_sel:[0,0,0] op_sel_hi:[1,1,0] neg_lo:[0,0,1] neg_hi:[0,0,1]
  v_pk_fma_f32 v[80:81], v[80:81], s[74:75], v[164:165] op_sel:[0,0,0] op_sel_hi:[1,1,0] neg_lo:[0,0,1] neg_hi:[0,0,1]
  v_exp_f32 v64, v64
  v_exp_f32 v65, v65
  v_exp_f32 v66, v66
  v_exp_f32 v67, v67
  v_rcp_f32 v144, v64
  v_rcp_f32 v145, v65
  v_exp_f32 v68, v68
  v_exp_f32 v69, v69
  v_rcp_f32 v146, v66
  v_rcp_f32 v147, v67
  s_add_u32 m0, s80, 76800
  s_mov_b32 exec_hi, 0
  buffer_load_dwordx4 v31, s[28:31], s56 offen lds
  s_mov_b32 exec_hi, -1
  v_pk_add_f32 v[162:163], v[64:65], v[66:67]
  v_exp_f32 v70, v70
  v_exp_f32 v71, v71
  v_rcp_f32 v148, v68
  v_rcp_f32 v149, v69
  v_pk_add_f32 v[162:163], v[162:163], v[68:69]
  v_pk_add_f32 v[164:165], v[144:145], v[146:147]
  v_exp_f32 v72, v72
  v_exp_f32 v73, v73
  v_rcp_f32 v150, v70
  v_rcp_f32 v151, v71
  v_pk_add_f32 v[162:163], v[162:163], v[70:71]
  v_pk_add_f32 v[164:165], v[164:165], v[148:149]
  v_exp_f32 v74, v74
  v_exp_f32 v75, v75
  v_rcp_f32 v152, v72
  v_rcp_f32 v153, v73
  buffer_load_dwordx4 v32, s[28:31], s56 offen offset:512 lds
L_tp2:
  s_cbranch_execz L_tret0
  v_pk_add_f32 v[162:163], v[162:163], v[72:73]
  v_pk_add_f32 v[164:165], v[164:165], v[150:151]
  v_exp_f32 v76, v76
  v_exp_f32 v77, v77
  v_rcp_f32 v154, v74
  v_rcp_f32 v155, v75
  v_pk_add_f32 v[162:163], v[162:163], v[74:75]
  v_pk_add_f32 v[164:165], v[164:165], v[152:153]
  v_exp_f32 v78, v78
  v_exp_f32 v79, v79
  v_rcp_f32 v156, v76
  v_rcp_f32 v157, v77
  v_pk_add_f32 v[162:163], v[162:163], v[76:77]
  v_pk_add_f32 v[164:165], v[164:165], v[154:155]
  v_exp_f32 v80, v80
  v_exp_f32 v81, v81
  buffer_load_dwordx4 v33, s[28:31], s56 offen offset:1536 lds
  v_rcp_f32 v158, v78
  v_rcp_f32 v159, v79
  v_pk_add_f32 v[162:163], v[162:163], v[78:79]
  v_pk_add_f32 v[164:165], v[164:165], v[156:157]
  v_rcp_f32 v160, v80
  v_rcp_f32 v161, v81
  v_pk_add_f32 v[162:163], v[162:163], v[80:81]
  v_pk_add_f32 v[164:165], v[164:165], v[158:159]
  v_pk_add_f32 v[164:165], v[164:165], v[160:161]
  v_add_f32 v167, v164, v165
  v_cmp_ngt_f32 vcc, 1568669696, v167
  v_add_f32 v166, v162, v163
  v_rcp_f32 v167, v167
  v_rcp_f32 v166, v166
  s_cbranch_vccnz L_smxk0
L_smbk0:
  v_pk_mul_f32 v[64:65], v[64:65], v[166:167] op_sel:[0,0] op_sel_hi:[1,0]
  buffer_load_dwordx4 v34, s[28:31], s56 offen offset:2560 lds
  v_pk_mul_f32 v[66:67], v[66:67], v[166:167] op_sel:[0,0] op_sel_hi:[1,0]
  v_cvt_pk_bf16_f32 v200, v64, v65
  v_cvt_pk_bf16_f32 v201, v66, v67
  v_pk_mul_f32 v[68:69], v[68:69], v[166:167] op_sel:[0,0] op_sel_hi:[1,0]
  v_pk_mul_f32 v[70:71], v[70:71], v[166:167] op_sel:[0,0] op_sel_hi:[1,0]
  v_cvt_pk_bf16_f32 v202, v68, v69
  v_cvt_pk_bf16_f32 v203, v70, v71
  v_pk_mul_f32 v[72:73], v[72:73], v[166:167] op_sel:[0,0] op_sel_hi:[1,0]
  v_pk_mul_f32 v[74:75], v[74:75], v[166:167] op_sel:[0,0] op_sel_hi:[1,0]
  v_cvt_pk_bf16_f32 v204, v72, v73
  v_cvt_pk_bf16_f32 v205, v74, v75
  v_pk_mul_f32 v[76:77], v[76:77], v[166:167] op_sel:[0,0] op_sel_hi:[1,0]
  v_pk_mul_f32 v[78:79], v[78:79], v[166:167] op_sel:[0,0] op_sel_hi:[1,0]
  v_cvt_pk_bf16_f32 v206, v76, v77
  v_cvt_pk_bf16_f32 v207, v78, v79
  v_pk_mul_f32 v[80:81], v[80:81], v[166:167] op_sel:[0,0] op_sel_hi:[1,0]
  buffer_load_dwordx4 v35, s[28:31], s56 offen offset:3584 lds
  s_add_u32 s56, s56, 442368
  s_cmp_ge_u32 s56, s50
  s_cselect_b32 s62, 1990656, 0
  s_sub_u32 s56, s56, s62
  v_pk_mul_f32 v[144:145], v[144:145], v[166:167] op_sel:[0,1] op_sel_hi:[1,1]
  v_cvt_pk_bf16_f32 v208, v80, v81
  v_cvt_pk_bf16_f32 v209, v144, v145
  v_pk_mul_f32 v[146:147], v[146:147], v[166:167] op_sel:[0,1] op_sel_hi:[1,1]
  v_pk_mul_f32 v[148:149], v[148:149], v[166:167] op_sel:[0,1] op_sel_hi:[1,1]
  v_cvt_pk_bf16_f32 v210, v146, v147
  v_cvt_pk_bf16_f32 v211, v148, v149
  v_pk_mul_f32 v[150:151], v[150:151], v[166:167] op_sel:[0,1] op_sel_hi:[1,1]
  v_pk_mul_f32 v[152:153], v[152:153], v[166:167] op_sel:[0,1] op_sel_hi:[1,1]
  v_cvt_pk_bf16_f32 v212, v150, v151
  v_cvt_pk_bf16_f32 v213, v152, v153
  v_pk_mul_f32 v[154:155], v[154:155], v[166:167] op_sel:[0,1] op_sel_hi:[1,1]
  v_pk_mul_f32 v[156:157], v[156:157], v[166:167] op_sel:[0,1] op_sel_hi:[1,1]
  v_cvt_pk_bf16_f32 v214, v154, v155
  v_cvt_pk_bf16_f32 v215, v156, v157
  v_pk_mul_f32 v[158:159], v[158:159], v[166:167] op_sel:[0,1] op_sel_hi:[1,1]
  v_pk_mul_f32 v[160:161], v[160:161], v[166:167] op_sel:[0,1] op_sel_hi:[1,1]
  v_cvt_pk_bf16_f32 v216, v158, v159
  v_cvt_pk_bf16_f32 v217, v160, v161
  v_max3_f32 v162, v84, v85, v86
  buffer_store_dwordx4 v[244:247], v46, s[36:39], s84 offen offset:0 sc1
  v_max3_f32 v162, v162, v87, v88
  v_max3_f32 v162, v162, v89, v90
  ds_write_b128 v55, v[200:203] offset:0
  v_max3_f32 v162, v162, v91, v92
  v_max3_f32 v162, v162, v93, v94
  v_max3_f32 v162, v162, v95, v96
  buffer_store_dwordx4 v[244:247], v46, s[36:39], s84 offen offset:1024 sc1
  v_max3_f32 v162, v162, v97, v98
  v_max3_f32 v162, v162, v99, v100
  v_max_f32 v162, v162, v101
  v_mul_f32 v164, s74, v162
  v_pk_fma_f32 v[84:85], v[84:85], s[74:75], v[164:165] op_sel:[0,0,0] op_sel_hi:[1,1,0] neg_lo:[0,0,1] neg_hi:[0,0,1]
  v_pk_fma_f32 v[86:87], v[86:87], s[74:75], v[164:165] op_sel:[0,0,0] op_sel_hi:[1,1,0] neg_lo:[0,0,1] neg_hi:[0,0,1]
  v_pk_fma_f32 v[88:89], v[88:89], s[74:75], v[164:165] op_sel:[0,0,0] op_sel_hi:[1,1,0] neg_lo:[0,0,1] neg_hi:[0,0,1]
  buffer_store_dwordx4 v[244:247], v46, s[36:39], s84 offen offset:2048 sc1
  v_pk_fma_f32 v[90:91], v[90:91], s[74:75], v[164:165] op_sel:[0,0,0] op_sel_hi:[1,1,0] neg_lo:[0,0,1] neg_hi:[0,0,1]
  v_pk_fma_f32 v[92:93], v[92:93], s[74:75], v[164:165] op_sel:[0,0,0] op_sel_hi:[1,1,0] neg_lo:[0,0,1] neg_hi:[0,0,1]
  v_pk_fma_f32 v[94:95], v[94:95], s[74:75], v[164:165] op_sel:[0,0,0] op_sel_hi:[1,1,0] neg_lo:[0,0,1] neg_hi:[0,0,1]
  v_pk_fma_f32 v[96:97], v[96:97], s[74:75], v[164:165] op_sel:[0,0,0] op_sel_hi:[1,1,0] neg_lo:[0,0,1] neg_hi:[0,0,1]
  ds_write_b128 v55, v[204:207] offset:16
  v_pk_fma_f32 v[98:99], v[98:99], s[74:75], v[164:165] op_sel:[0,0,0] op_sel_hi:[1,1,0] neg_lo:[0,0,1] neg_hi:[0,0,1]
  v_pk_fma_f32 v[100:101], v[100:101], s[74:75], v[164:165] op_sel:[0,0,0] op_sel_hi:[1,1,0] neg_lo:[0,0,1] neg_hi:[0,0,1]
  buffer_store_dwordx4 v[244:247], v46, s[36:39], s84 offen offset:3072 sc1
  v_exp_f32 v84, v84
  v_exp_f32 v85, v85
  v_exp_f32 v86, v86
  v_exp_f32 v87, v87
  v_rcp_f32 v144, v84
  v_rcp_f32 v145, v85
  v_exp_f32 v88, v88
  buffer_store_dword v244, v54, s[36:39], s84 offen offset:0 sc1
  v_exp_f32 v89, v89
  v_rcp_f32 v146, v86
  v_rcp_f32 v147, v87
  v_pk_add_f32 v[162:163], v[84:85], v[86:87]
  v_exp_f32 v90, v90
  ds_write_b128 v55, v[208:211] offset:32
  v_exp_f32 v91, v91
  buffer_store_dword v244, v54, s[36:39], s84 offen offset:256 sc1
  v_rcp_f32 v148, v88
  v_rcp_f32 v149, v89
  v_pk_add_f32 v[162:163], v[162:163], v[88:89]
  v_pk_add_f32 v[164:165], v[144:145], v[146:147]
  v_exp_f32 v92, v92
  v_exp_f32 v93, v93
  v_rcp_f32 v150, v90
  s_add_u32 s56, s56, s21
  v_rcp_f32 v151, v91
  v_pk_add_f32 v[162:163], v[162:163], v[90:91]
  v_pk_add_f32 v[164:165], v[164:165], v[148:149]
  v_exp_f32 v94, v94
  v_exp_f32 v95, v95
  v_rcp_f32 v152, v92
  v_rcp_f32 v153, v93
  s_add_u32 m0, s20, 95232
  s_mov_b32 exec_hi, 0
  buffer_load_dwordx4 v31, s[28:31], s56 offen lds
  s_mov_b32 exec_hi, -1
  ds_write_b128 v55, v[212:215] offset:48
  v_pk_add_f32 v[162:163], v[162:163], v[92:93]
  v_pk_add_f32 v[164:165], v[164:165], v[150:151]
  v_exp_f32 v96, v96
  v_exp_f32 v97, v97
  v_rcp_f32 v154, v94
  v_rcp_f32 v155, v95
  buffer_load_dwordx4 v32, s[28:31], s56 offen offset:512 lds
  v_pk_add_f32 v[162:163], v[162:163], v[94:95]
  v_pk_add_f32 v[164:165], v[164:165], v[152:153]
  v_exp_f32 v98, v98
  v_exp_f32 v99, v99
  v_rcp_f32 v156, v96
  v_rcp_f32 v157, v97
  v_pk_add_f32 v[162:163], v[162:163], v[96:97]
  buffer_load_dwordx4 v33, s[28:31], s56 offen offset:1536 lds
  v_pk_add_f32 v[164:165], v[164:165], v[154:155]
  ds_write_b128 v55, v[216:219] offset:64
  v_exp_f32 v100, v100
  v_exp_f32 v101, v101
  v_rcp_f32 v158, v98
  v_rcp_f32 v159, v99
  v_pk_add_f32 v[162:163], v[162:163], v[98:99]
  buffer_load_dwordx4 v34, s[28:31], s56 offen offset:2560 lds
  v_pk_add_f32 v[164:165], v[164:165], v[156:157]
  v_rcp_f32 v160, v100
  v_rcp_f32 v161, v101
  v_pk_add_f32 v[162:163], v[162:163], v[100:101]
  v_pk_add_f32 v[164:165], v[164:165], v[158:159]
  v_pk_add_f32 v[164:165], v[164:165], v[160:161]
  v_add_f32 v167, v164, v165
  buffer_load_dwordx4 v35, s[28:31], s56 offen offset:3584 lds
  v_cmp_ngt_f32 vcc, 1568669696, v167
  v_add_f32 v166, v162, v163
  v_rcp_f32 v167, v167
  v_rcp_f32 v166, v166
  s_cbranch_vccnz L_smxk1
L_smbk1:
  v_pk_mul_f32 v[84:85], v[84:85], v[166:167] op_sel:[0,0] op_sel_hi:[1,0]
  v_pk_mul_f32 v[86:87], v[86:87], v[166:167] op_sel:[0,0] op_sel_hi:[1,0]
  v_cvt_pk_bf16_f32 v220, v84, v85
  v_cvt_pk_bf16_f32 v221, v86, v87
  v_pk_mul_f32 v[88:89], v[88:89], v[166:167] op_sel:[0,0] op_sel_hi:[1,0]
  v_pk_mul_f32 v[90:91], v[90:91], v[166:167] op_sel:[0,0] op_sel_hi:[1,0]
  v_cvt_pk_bf16_f32 v222, v88, v89
  v_cvt_pk_bf16_f32 v223, v90, v91
  ds_write_b128 v55, v[220:223] offset:1280
  v_pk_mul_f32 v[92:93], v[92:93], v[166:167] op_sel:[0,0] op_sel_hi:[1,0]
  v_pk_mul_f32 v[94:95], v[94:95], v[166:167] op_sel:[0,0] op_sel_hi:[1,0]
  v_cvt_pk_bf16_f32 v224, v92, v93
  v_cvt_pk_bf16_f32 v225, v94, v95
  v_pk_mul_f32 v[96:97], v[96:97], v[166:167] op_sel:[0,0] op_sel_hi:[1,0]
  v_pk_mul_f32 v[98:99], v[98:99], v[166:167] op_sel:[0,0] op_sel_hi:[1,0]
  v_cvt_pk_bf16_f32 v226, v96, v97
  v_cvt_pk_bf16_f32 v227, v98, v99
  ds_write_b128 v55, v[224:227] offset:1296
  v_pk_mul_f32 v[100:101], v[100:101], v[166:167] op_sel:[0,0] op_sel_hi:[1,0]
  v_pk_mul_f32 v[144:145], v[144:145], v[166:167] op_sel:[0,1] op_sel_hi:[1,1]
  v_cvt_pk_bf16_f32 v228, v100, v101
  v_cvt_pk_bf16_f32 v229, v144, v145
  v_pk_mul_f32 v[146:147], v[146:147], v[166:167] op_sel:[0,1] op_sel_hi:[1,1]
  v_pk_mul_f32 v[148:149], v[148:149], v[166:167] op_sel:[0,1] op_sel_hi:[1,1]
  v_cvt_pk_bf16_f32 v230, v146, v147
  v_cvt_pk_bf16_f32 v231, v148, v149
  ds_write_b128 v55, v[228:231] offset:1312
  v_pk_mul_f32 v[150:151], v[150:151], v[166:167] op_sel:[0,1] op_sel_hi:[1,1]
  v_pk_mul_f32 v[152:153], v[152:153], v[166:167] op_sel:[0,1] op_sel_hi:[1,1]
  v_cvt_pk_bf16_f32 v232, v150, v151
  v_cvt_pk_bf16_f32 v233, v152, v153
  v_pk_mul_f32 v[154:155], v[154:155], v[166:167] op_sel:[0,1] op_sel_hi:[1,1]
  v_pk_mul_f32 v[156:157], v[156:157], v[166:167] op_sel:[0,1] op_sel_hi:[1,1]
  v_cvt_pk_bf16_f32 v234, v154, v155
  v_cvt_pk_bf16_f32 v235, v156, v157
  ds_write_b128 v55, v[232:235] offset:1328
  v_pk_mul_f32 v[158:159], v[158:159], v[166:167] op_sel:[0,1] op_sel_hi:[1,1]
  v_pk_mul_f32 v[160:161], v[160:161], v[166:167] op_sel:[0,1] op_sel_hi:[1,1]
  v_cvt_pk_bf16_f32 v236, v158, v159
  v_cvt_pk_bf16_f32 v237, v160, v161
  ds_write_b128 v55, v[236:239] offset:1344
  s_waitcnt vmcnt(16) lgkmcnt(0)
  s_barrier
  ds_read_b128 a[204:207], v57 offset:0
  ds_read_b64_tr_b16 v[144:145], v51 offset:0
  ds_read_b64_tr_b16 v[146:147], v51 offset:1280
  ds_read_b64_tr_b16 a[208:209], v52 offset:72
  ds_read_b64_tr_b16 a[210:211], v52 offset:1352
  ds_read_b128 a[212:215], v57 offset:5120
  ds_read_b64_tr_b16 v[148:149], v51 offset:2560
  ds_read_b64_tr_b16 v[150:151], v51 offset:3840
  ds_read_b64_tr_b16 a[216:217], v52 offset:2632
  ds_read_b64_tr_b16 a[218:219], v52 offset:3912
  ds_read_b128 a[220:223], v57 offset:10240
  ds_read_b64_tr_b16 v[152:153], v51 offset:5120
  ds_read_b64_tr_b16 v[154:155], v51 offset:6400
  ds_read_b64_tr_b16 a[224:225], v52 offset:5192
  ds_read_b64_tr_b16 a[226:227], v52 offset:6472
  s_waitcnt lgkmcnt(10)
  v_mfma_f32_16x16x32_bf16 v[104:107], a[204:207], v[144:147], 0
  ds_read_b128 a[228:231], v57 offset:15360
  ds_read_b64_tr_b16 v[156:157], v51 offset:7680
  ds_read_b64_tr_b16 v[158:159], v51 offset:8960
  v_mfma_f32_16x16x32_bf16 v[116:119], a[208:211], v[144:147], 0
  ds_read_b64_tr_b16 a[232:233], v52 offset:7752
  ds_read_b64_tr_b16 a[234:235], v52 offset:9032
  s_waitcnt lgkmcnt(10)
  v_mfma_f32_16x16x32_bf16 v[104:107], a[212:215], v[148:151], v[104:107]
  ds_read_b64_tr_b16 v[160:161], v51 offset:32
  v_mfma_f32_16x16x32_bf16 v[116:119], a[216:219], v[148:151], v[116:119]
  ds_read_b64_tr_b16 v[162:163], v51 offset:1312
  s_waitcnt lgkmcnt(7)
  v_mfma_f32_16x16x32_bf16 v[104:107], a[220:223], v[152:155], v[104:107]
  ds_read_b64_tr_b16 v[164:165], v51 offset:2592
  v_mfma_f32_16x16x32_bf16 v[116:119], a[224:227], v[152:155], v[116:119]
  ds_read_b64_tr_b16 v[166:167], v51 offset:3872
  s_waitcnt lgkmcnt(4)
  v_mfma_f32_16x16x32_bf16 v[104:107], a[228:231], v[156:159], v[104:107]
  ds_read_b64_tr_b16 v[168:169], v51 offset:5152
  v_mfma_f32_16x16x32_bf16 v[116:119], a[232:235], v[156:159], v[116:119]
  ds_read_b64_tr_b16 v[170:171], v51 offset:6432
  s_waitcnt lgkmcnt(4)
  v_mfma_f32_16x16x32_bf16 v[108:111], a[204:207], v[160:163], 0
  ds_read_b64_tr_b16 v[172:173], v51 offset:7712
  v_mfma_f32_16x16x32_bf16 v[120:123], a[208:211], v[160:163], 0
  ds_read_b64_tr_b16 v[174:175], v51 offset:8992
  s_waitcnt lgkmcnt(4)
  v_mfma_f32_16x16x32_bf16 v[108:111], a[212:215], v[164:167], v[108:111]
  ds_read_b64_tr_b16 v[144:145], v52 offset:64
  v_and_or_b32 v104, v104, s83, v1
  v_mfma_f32_16x16x32_bf16 v[120:123], a[216:219], v[164:167], v[120:123]
  ds_read_b64_tr_b16 v[146:147], v52 offset:1344
  s_waitcnt lgkmcnt(4)
  v_mfma_f32_16x16x32_bf16 v[108:111], a[220:223], v[168:171], v[108:111]
  ds_read_b64_tr_b16 v[148:149], v52 offset:2624
  v_and_or_b32 v105, v105, s83, v1
  v_mfma_f32_16x16x32_bf16 v[120:123], a[224:227], v[168:171], v[120:123]
  ds_read_b64_tr_b16 v[150:151], v52 offset:3904
  s_waitcnt lgkmcnt(4)
  v_mfma_f32_16x16x32_bf16 v[108:111], a[228:231], v[172:175], v[108:111]
  ds_read_b64_tr_b16 v[152:153], v52 offset:5184
  v_and_or_b32 v106, v106, s83, v1
  v_mfma_f32_16x16x32_bf16 v[120:123], a[232:235], v[172:175], v[120:123]
  ds_read_b64_tr_b16 v[154:155], v52 offset:6464
  s_waitcnt lgkmcnt(4)
  v_mfma_f32_16x16x32_bf16 v[112:115], a[204:207], v[144:147], 0
  ds_read_b64_tr_b16 v[156:157], v52 offset:7744
  v_and_or_b32 v107, v107, s83, v1
  v_mfma_f32_16x16x32_bf16 v[124:127], a[208:211], v[144:147], 0
  ds_read_b64_tr_b16 v[158:159], v52 offset:9024
  s_waitcnt lgkmcnt(4)
  v_mfma_f32_16x16x32_bf16 v[112:115], a[212:215], v[148:151], v[112:115]
  buffer_store_dwordx4 v[104:107], v59, s[36:39], s68 offen sc1
  s_add_u32 s63, s68, 36864
  v_mfma_f32_16x16x32_bf16 v[124:127], a[216:219], v[148:151], v[124:127]
  v_and_or_b32 v116, v116, s83, v1
  v_and_or_b32 v117, v117, s83, v1
  s_waitcnt lgkmcnt(2)
  v_mfma_f32_16x16x32_bf16 v[112:115], a[220:223], v[152:155], v[112:115]
  v_and_or_b32 v118, v118, s83, v1
  v_and_or_b32 v119, v119, s83, v1
  v_mfma_f32_16x16x32_bf16 v[124:127], a[224:227], v[152:155], v[124:127]
  buffer_store_dwordx4 v[116:119], v61, s[36:39], s63 offen sc1
  s_waitcnt lgkmcnt(0)
  v_mfma_f32_16x16x32_bf16 v[112:115], a[228:231], v[156:159], v[112:115]
  s_add_u32 s63, s68, 16384
  v_and_or_b32 v108, v108, s83, v1
  v_mfma_f32_16x16x32_bf16 v[124:127], a[232:235], v[156:159], v[124:127]
  v_and_or_b32 v109, v109, s83, v1
  v_and_or_b32 v110, v110, s83, v1
  v_and_or_b32 v111, v111, s83, v1
  buffer_store_dwordx4 v[108:111], v59, s[36:39], s63 offen sc1
  s_add_u32 s63, s68, 40960
  v_and_or_b32 v120, v120, s83, v1
  v_and_or_b32 v121, v121, s83, v1
  v_and_or_b32 v122, v122, s83, v1
  v_and_or_b32 v123, v123, s83, v1
  buffer_store_dwordx4 v[120:123], v61, s[36:39], s63 offen sc1
  ds_read_b64_tr_b16 v[160:161], v21 offset:0
  ds_read_b64_tr_b16 v[162:163], v22 offset:0
  ds_read_b64_tr_b16 v[164:165], v21 offset:8
  ds_read_b64_tr_b16 v[166:167], v22 offset:8
  ds_read_b64_tr_b16 v[168:169], v21 offset:16
  ds_read_b64_tr_b16 v[170:171], v22 offset:16
  ds_read_b64_tr_b16 v[172:173], v23 offset:0
  ds_read_b64_tr_b16 v[174:175], v24 offset:0
  s_add_u32 s63, s68, 32768
  v_and_or_b32 v112, v112, s83, v1
  v_and_or_b32 v113, v113, s83, v1
  v_and_or_b32 v114, v114, s83, v1
  v_and_or_b32 v115, v115, s83, v1
  buffer_store_dwordx4 v[112:115], v60, s[36:39], s63 offen sc1
  s_add_u32 s63, s68, 45056
  v_and_or_b32 v124, v124, s83, v1
  v_and_or_b32 v125, v125, s83, v1
  v_and_or_b32 v126, v126, s83, v1
  v_and_or_b32 v127, v127, s83, v1
  buffer_store_dwordx4 v[124:127], v61, s[36:39], s63 offen sc1
  s_waitcnt lgkmcnt(4)
  v_mfma_f32_16x16x32_bf16 v[64:67], v[160:163], a[0:3], 0
  ds_read_b64_tr_b16 v[144:145], v25 offset:0
  v_mfma_f32_16x16x32_bf16 v[84:87], v[160:163], a[4:7], 0
  ds_read_b64_tr_b16 v[146:147], v26 offset:0
  s_barrier
  v_mfma_f32_16x16x32_bf16 v[68:71], v[164:167], a[0:3], 0
  ds_read_b64_tr_b16 v[148:149], v21 offset:144
  v_mfma_f32_16x16x32_bf16 v[88:91], v[164:167], a[4:7], 0
  ds_read_b64_tr_b16 v[150:151], v22 offset:144
  s_waitcnt lgkmcnt(4)
  v_mfma_f32_16x16x32_bf16 v[72:75], v[168:171], a[0:3], 0
  ds_read_b64_tr_b16 v[152:153], v21 offset:152
  v_mfma_f32_16x16x32_bf16 v[92:95], v[168:171], a[4:7], 0
  ds_read_b64_tr_b16 v[154:155], v22 offset:152
  v_mfma_f32_16x16x32_bf16 v[76:79], v[172:175], a[0:3], 0
  ds_read_b64_tr_b16 v[156:157], v21 offset:160
  s_bfe_u32 s81, s51, 262144
  s_mul_i32 s81, s81, 82944
  s_add_u32 s81, s81, s93
  s_add_u32 m0, s79, 0
  v_mfma_f32_16x16x32_bf16 v[96:99], v[172:175], a[4:7], 0
  ds_read_b64_tr_b16 v[158:159], v22 offset:160
  s_waitcnt lgkmcnt(4)
  v_mfma_f32_16x16x32_bf16 v[80:83], v[144:147], a[0:3], 0
  ds_read_b64_tr_b16 v[160:161], v23 offset:144
  v_mfma_f32_16x16x32_bf16 v[100:103], v[144:147], a[4:7], 0
  ds_read_b64_tr_b16 v[162:163], v24 offset:144
  v_mfma_f32_16x16x32_bf16 v[64:67], v[148:151], a[8:11], v[64:67]
  ds_read_b64_tr_b16 v[164:165], v25 offset:144
  v_mfma_f32_16x16x32_bf16 v[84:87], v[148:151], a[12:15], v[84:87]
  ds_read_b64_tr_b16 v[166:167], v26 offset:144
  s_waitcnt lgkmcnt(4)
  v_mfma_f32_16x16x32_bf16 v[68:71], v[152:155], a[8:11], v[68:71]
  ds_read_b64_tr_b16 v[168:169], v21 offset:9216
  buffer_load_dwordx4 v36, s[32:35], s81 offen offset:0 lds
  v_mfma_f32_16x16x32_bf16 v[88:91], v[152:155], a[12:15], v[88:91]
  ds_read_b64_tr_b16 v[170:171], v22 offset:9216
  v_mfma_f32_16x16x32_bf16 v[72:75], v[156:159], a[8:11], v[72:75]
  ds_read_b64_tr_b16 v[172:173], v21 offset:9224
  v_mfma_f32_16x16x32_bf16 v[92:95], v[156:159], a[12:15], v[92:95]
  ds_read_b64_tr_b16 v[174:175], v22 offset:9224
  s_waitcnt lgkmcnt(4)
  v_mfma_f32_16x16x32_bf16 v[76:79], v[160:163], a[8:11], v[76:79]
  ds_read_b64_tr_b16 v[144:145], v21 offset:9232
  v_mfma_f32_16x16x32_bf16 v[96:99], v[160:163], a[12:15], v[96:99]
  ds_read_b64_tr_b16 v[146:147], v22 offset:9232
  v_mfma_f32_16x16x32_bf16 v[80:83], v[164:167], a[8:11], v[80:83]
  ds_read_b64_tr_b16 v[148:149], v23 offset:9216
  buffer_load_dwordx4 v37, s[32:35], s81 offen offset:1024 lds
  v_mfma_f32_16x16x32_bf16 v[100:103], v[164:167], a[12:15], v[100:103]
  ds_read_b64_tr_b16 v[150:151], v24 offset:9216
  s_waitcnt lgkmcnt(4)
  v_mfma_f32_16x16x32_bf16 v[64:67], v[168:171], a[16:19], v[64:67]
  ds_read_b64_tr_b16 v[152:153], v25 offset:9216
  v_mfma_f32_16x16x32_bf16 v[84:87], v[168:171], a[20:23], v[84:87]
  ds_read_b64_tr_b16 v[154:155], v26 offset:9216
  v_mfma_f32_16x16x32_bf16 v[68:71], v[172:175], a[16:19], v[68:71]
  ds_read_b64_tr_b16 v[156:157], v21 offset:9360
  v_mfma_f32_16x16x32_bf16 v[88:91], v[172:175], a[20:23], v[88:91]
  ds_read_b64_tr_b16 v[158:159], v22 offset:9360
  s_waitcnt lgkmcnt(4)
  v_mfma_f32_16x16x32_bf16 v[72:75], v[144:147], a[16:19], v[72:75]
  ds_read_b64_tr_b16 v[160:161], v21 offset:9368
  buffer_load_dwordx4 v38, s[32:35], s81 offen offset:2048 lds
  v_mfma_f32_16x16x32_bf16 v[92:95], v[144:147], a[20:23], v[92:95]
  ds_read_b64_tr_b16 v[162:163], v22 offset:9368
  v_mfma_f32_16x16x32_bf16 v[76:79], v[148:151], a[16:19], v[76:79]
  ds_read_b64_tr_b16 v[164:165], v21 offset:9376
  v_mfma_f32_16x16x32_bf16 v[96:99], v[148:151], a[20:23], v[96:99]
  ds_read_b64_tr_b16 v[166:167], v22 offset:9376
  s_waitcnt lgkmcnt(4)
  v_mfma_f32_16x16x32_bf16 v[80:83], v[152:155], a[16:19], v[80:83]
  ds_read_b64_tr_b16 v[168:169], v23 offset:9360
  v_lshl_add_u32 v2, v47, 3, v251
  v_mfma_f32_16x16x32_bf16 v[100:103], v[152:155], a[20:23], v[100:103]
  ds_read_b64_tr_b16 v[170:171], v24 offset:9360
  v_mul_u32_u24 v2, 40, v2
  v_mfma_f32_16x16x32_bf16 v[64:67], v[156:159], a[24:27], v[64:67]
  ds_read_b64_tr_b16 v[172:173], v25 offset:9360
  v_add_u32 v2, 61440, v2
  v_mfma_f32_16x16x32_bf16 v[84:87], v[156:159], a[28:31], v[84:87]
  ds_read_b64_tr_b16 v[174:175], v26 offset:9360
  s_waitcnt lgkmcnt(4)
  v_mfma_f32_16x16x32_bf16 v[68:71], v[160:163], a[24:27], v[68:71]
  ds_read_b64_tr_b16 v[144:145], v21 offset:18432
  v_lshl_add_u32 v10, v252, 3, v2
  v_mfma_f32_16x16x32_bf16 v[88:91], v[160:163], a[28:31], v[88:91]
  ds_read_b64_tr_b16 v[146:147], v22 offset:18432
  buffer_load_dwordx4 v39, s[32:35], s81 offen offset:3072 lds
  s_add_u32 m0, s79, 4096
  v_mfma_f32_16x16x32_bf16 v[72:75], v[164:167], a[24:27], v[72:75]
  ds_read_b64_tr_b16 v[148:149], v21 offset:18440
  v_lshl_add_u32 v11, v252, 18, v2
  v_mfma_f32_16x16x32_bf16 v[92:95], v[164:167], a[28:31], v[92:95]
  ds_read_b64_tr_b16 v[150:151], v22 offset:18440
  s_waitcnt lgkmcnt(4)
  v_mfma_f32_16x16x32_bf16 v[76:79], v[168:171], a[24:27], v[76:79]
  ds_read_b64_tr_b16 v[152:153], v21 offset:18448
  v_xor_b32 v3, 1, v252
  v_mfma_f32_16x16x32_bf16 v[96:99], v[168:171], a[28:31], v[96:99]
  ds_read_b64_tr_b16 v[154:155], v22 offset:18448
  v_mfma_f32_16x16x32_bf16 v[80:83], v[172:175], a[24:27], v[80:83]
  ds_read_b64_tr_b16 v[156:157], v23 offset:18432
  v_lshl_add_u32 v12, v3, 18, v2
  v_mfma_f32_16x16x32_bf16 v[100:103], v[172:175], a[28:31], v[100:103]
  ds_read_b64_tr_b16 v[158:159], v24 offset:18432
  s_waitcnt lgkmcnt(4)
  v_mfma_f32_16x16x32_bf16 v[64:67], v[144:147], a[32:35], v[64:67]
  ds_read_b64_tr_b16 v[160:161], v25 offset:18432
  buffer_load_dwordx4 v40, s[32:35], s81 offen lds
  s_bfe_u32 s81, s51, 262152
  s_mul_i32 s81, s81, 82944
  s_add_u32 s81, s81, s93
  s_add_u32 m0, s79, 20480
  v_mfma_f32_16x16x32_bf16 v[84:87], v[144:147], a[36:39], v[84:87]
  ds_read_b64_tr_b16 v[162:163], v26 offset:18432
  v_xor_b32 v3, 2, v252
  v_mfma_f32_16x16x32_bf16 v[68:71], v[148:151], a[32:35], v[68:71]
  ds_read_b64_tr_b16 v[164:165], v21 offset:18576
  v_lshl_add_u32 v13, v3, 18, v2
  v_mfma_f32_16x16x32_bf16 v[88:91], v[148:151], a[36:39], v[88:91]
  ds_read_b64_tr_b16 v[166:167], v22 offset:18576
  s_waitcnt lgkmcnt(4)
  v_mfma_f32_16x16x32_bf16 v[72:75], v[152:155], a[32:35], v[72:75]
  ds_read_b64_tr_b16 v[168:169], v21 offset:18584
  v_xor_b32 v3, 3, v252
  v_mfma_f32_16x16x32_bf16 v[92:95], v[152:155], a[36:39], v[92:95]
  ds_read_b64_tr_b16 v[170:171], v22 offset:18584
  v_lshl_add_u32 v14, v3, 18, v2
  v_mfma_f32_16x16x32_bf16 v[76:79], v[156:159], a[32:35], v[76:79]
  ds_read_b64_tr_b16 v[172:173], v21 offset:18592
  buffer_load_dwordx4 v36, s[32:35], s81 offen offset:0 lds
  v_mfma_f32_16x16x32_bf16 v[96:99], v[156:159], a[36:39], v[96:99]
  ds_read_b64_tr_b16 v[174:175], v22 offset:18592
  s_waitcnt lgkmcnt(4)
  v_mfma_f32_16x16x32_bf16 v[80:83], v[160:163], a[32:35], v[80:83]
  ds_read_b64_tr_b16 v[144:145], v23 offset:18576
  v_mul_u32_u24 v2, 40, v251
  v_mfma_f32_16x16x32_bf16 v[100:103], v[160:163], a[36:39], v[100:103]
  ds_read_b64_tr_b16 v[146:147], v24 offset:18576
  v_lshl_add_u32 v2, v252, 3, v2
  v_mfma_f32_16x16x32_bf16 v[64:67], v[164:167], a[40:43], v[64:67]
  ds_read_b64_tr_b16 v[148:149], v25 offset:18576
  v_add_u32 v2, 62720, v2
  v_mfma_f32_16x16x32_bf16 v[84:87], v[164:167], a[44:47], v[84:87]
  ds_read_b64_tr_b16 v[150:151], v26 offset:18576
  s_waitcnt lgkmcnt(4)
  v_mfma_f32_16x16x32_bf16 v[68:71], v[168:171], a[40:43], v[68:71]
  ds_read_b64_tr_b16 v[152:153], v21 offset:27648
  buffer_load_dwordx4 v37, s[32:35], s81 offen offset:1024 lds
  v_mfma_f32_16x16x32_bf16 v[88:91], v[168:171], a[44:47], v[88:91]
  ds_read_b64_tr_b16 v[154:155], v22 offset:27648
  v_lshl_add_u32 v15, v47, 18, v2
  v_mfma_f32_16x16x32_bf16 v[72:75], v[172:175], a[40:43], v[72:75]
  ds_read_b64_tr_b16 v[156:157], v21 offset:27656
  v_xor_b32 v3, 1, v47
  v_mfma_f32_16x16x32_bf16 v[92:95], v[172:175], a[44:47], v[92:95]
  ds_read_b64_tr_b16 v[158:159], v22 offset:27656
  s_waitcnt lgkmcnt(4)
  v_mfma_f32_16x16x32_bf16 v[76:79], v[144:147], a[40:43], v[76:79]
  ds_read_b64_tr_b16 v[160:161], v21 offset:27664
  v_lshl_add_u32 v16, v3, 18, v2
  v_mfma_f32_16x16x32_bf16 v[96:99], v[144:147], a[44:47], v[96:99]
  ds_read_b64_tr_b16 v[162:163], v22 offset:27664
  v_xor_b32 v3, 2, v47
  v_mfma_f32_16x16x32_bf16 v[80:83], v[148:151], a[40:43], v[80:83]
  ds_read_b64_tr_b16 v[164:165], v23 offset:27648
  v_lshl_add_u32 v17, v3, 18, v2
  v_mfma_f32_16x16x32_bf16 v[100:103], v[148:151], a[44:47], v[100:103]
  ds_read_b64_tr_b16 v[166:167], v24 offset:27648
  s_waitcnt lgkmcnt(4)
  v_mfma_f32_16x16x32_bf16 v[64:67], v[152:155], a[48:51], v[64:67]
  ds_read_b64_tr_b16 v[168:169], v25 offset:27648
  buffer_load_dwordx4 v38, s[32:35], s81 offen offset:2048 lds
  v_mfma_f32_16x16x32_bf16 v[84:87], v[152:155], a[52:55], v[84:87]
  ds_read_b64_tr_b16 v[170:171], v26 offset:27648
  v_xor_b32 v3, 3, v47
  v_mfma_f32_16x16x32_bf16 v[68:71], v[156:159], a[48:51], v[68:71]
  ds_read_b64_tr_b16 v[172:173], v21 offset:27792
  v_lshl_add_u32 v18, v3, 18, v2
  v_mfma_f32_16x16x32_bf16 v[88:91], v[156:159], a[52:55], v[88:91]
  ds_read_b64_tr_b16 v[174:175], v22 offset:27792
  s_waitcnt lgkmcnt(4)
  v_mfma_f32_16x16x32_bf16 v[72:75], v[160:163], a[48:51], v[72:75]
  ds_read_b64_tr_b16 v[144:145], v21 offset:27800
  s_bfe_u32 s44, s78, 262148
  v_mfma_f32_16x16x32_bf16 v[92:95], v[160:163], a[52:55], v[92:95]
  ds_read_b64_tr_b16 v[146:147], v22 offset:27800
  s_mul_i32 s44, s44, 4608
  v_mfma_f32_16x16x32_bf16 v[76:79], v[164:167], a[48:51], v[76:79]
  ds_read_b64_tr_b16 v[148:149], v21 offset:27808
  buffer_load_dwordx4 v39, s[32:35], s81 offen offset:3072 lds
  s_add_u32 m0, s79, 24576
  v_mfma_f32_16x16x32_bf16 v[96:99], v[164:167], a[52:55], v[96:99]
  ds_read_b64_tr_b16 v[150:151], v22 offset:27808
  s_waitcnt lgkmcnt(4)
  v_mfma_f32_16x16x32_bf16 v[80:83], v[168:171], a[48:51], v[80:83]
  ds_read_b64_tr_b16 v[152:153], v23 offset:27792
  s_add_u32 s85, s44, s71
  v_mfma_f32_16x16x32_bf16 v[100:103], v[168:171], a[52:55], v[100:103]
  ds_read_b64_tr_b16 v[154:155], v24 offset:27792
  s_bfe_u32 s44, s78, 262152
  v_mfma_f32_16x16x32_bf16 v[64:67], v[172:175], a[56:59], v[64:67]
  ds_read_b64_tr_b16 v[156:157], v25 offset:27792
  s_mul_i32 s44, s44, 4608
  v_mfma_f32_16x16x32_bf16 v[84:87], v[172:175], a[60:63], v[84:87]
  ds_read_b64_tr_b16 v[158:159], v26 offset:27792
  s_waitcnt lgkmcnt(4)
  v_mfma_f32_16x16x32_bf16 v[68:71], v[144:147], a[56:59], v[68:71]
  ds_read_b64_tr_b16 v[160:161], v21 offset:36864
  buffer_load_dwordx4 v40, s[32:35], s81 offen lds
  s_bfe_u32 s81, s51, 262160
  s_mul_i32 s81, s81, 82944
  s_add_u32 s81, s81, s93
  s_add_u32 m0, s79, 40960
  v_mfma_f32_16x16x32_bf16 v[88:91], v[144:147], a[60:63], v[88:91]
  ds_read_b64_tr_b16 v[162:163], v22 offset:36864
  s_add_u32 s86, s44, s71
  v_mfma_f32_16x16x32_bf16 v[72:75], v[148:151], a[56:59], v[72:75]
  ds_read_b64_tr_b16 v[164:165], v21 offset:36872
  s_bfe_u32 s44, s78, 262156
  v_mfma_f32_16x16x32_bf16 v[92:95], v[148:151], a[60:63], v[92:95]
  ds_read_b64_tr_b16 v[166:167], v22 offset:36872
  s_waitcnt lgkmcnt(4)
  v_mfma_f32_16x16x32_bf16 v[76:79], v[152:155], a[56:59], v[76:79]
  ds_read_b64_tr_b16 v[168:169], v21 offset:36880
  s_mul_i32 s44, s44, 4608
  v_mfma_f32_16x16x32_bf16 v[96:99], v[152:155], a[60:63], v[96:99]
  ds_read_b64_tr_b16 v[170:171], v22 offset:36880
  s_add_u32 s87, s44, s71
  v_mfma_f32_16x16x32_bf16 v[80:83], v[156:159], a[56:59], v[80:83]
  ds_read_b64_tr_b16 v[172:173], v23 offset:36864
  buffer_load_dwordx4 v36, s[32:35], s81 offen offset:0 lds
  v_mfma_f32_16x16x32_bf16 v[100:103], v[156:159], a[60:63], v[100:103]
  ds_read_b64_tr_b16 v[174:175], v24 offset:36864
  s_waitcnt lgkmcnt(4)
  v_mfma_f32_16x16x32_bf16 v[64:67], v[160:163], a[64:67], v[64:67]
  ds_read_b64_tr_b16 v[144:145], v25 offset:36864
  s_bfe_u32 s44, s78, 262160
  v_mfma_f32_16x16x32_bf16 v[84:87], v[160:163], a[68:71], v[84:87]
  ds_read_b64_tr_b16 v[146:147], v26 offset:36864
L_tp3:
  s_cbranch_execz L_tret0
  s_mul_i32 s44, s44, 4608
  v_mfma_f32_16x16x32_bf16 v[68:71], v[164:167], a[64:67], v[68:71]
  ds_read_b64_tr_b16 v[148:149], v21 offset:37008
  s_add_u32 s88, s44, s71
  v_mfma_f32_16x16x32_bf16 v[88:91], v[164:167], a[68:71], v[88:91]
  ds_read_b64_tr_b16 v[150:151], v22 offset:37008
  s_waitcnt lgkmcnt(4)
  v_mfma_f32_16x16x32_bf16 v[72:75], v[168:171], a[64:67], v[72:75]
  ds_read_b64_tr_b16 v[152:153], v21 offset:37016
  s_bfe_u32 s44, s78, 262164
  v_mfma_f32_16x16x32_bf16 v[92:95], v[168:171], a[68:71], v[92:95]
  ds_read_b64_tr_b16 v[154:155], v22 offset:37016
  buffer_load_dwordx4 v37, s[32:35], s81 offen offset:1024 lds
  v_mfma_f32_16x16x32_bf16 v[76:79], v[172:175], a[64:67], v[76:79]
  ds_read_b64_tr_b16 v[156:157], v21 offset:37024
  s_mul_i32 s44, s44, 4608
  v_mfma_f32_16x16x32_bf16 v[96:99], v[172:175], a[68:71], v[96:99]
  ds_read_b64_tr_b16 v[158:159], v22 offset:37024
  s_waitcnt lgkmcnt(4)
  v_mfma_f32_16x16x32_bf16 v[80:83], v[144:147], a[64:67], v[80:83]
  ds_read_b64_tr_b16 v[160:161], v23 offset:37008
  s_add_u32 s89, s44, s71
  v_mfma_f32_16x16x32_bf16 v[100:103], v[144:147], a[68:71], v[100:103]
  ds_read_b64_tr_b16 v[162:163], v24 offset:37008
  s_bfe_u32 s44, s78, 262168
  v_mfma_f32_16x16x32_bf16 v[64:67], v[148:151], a[72:75], v[64:67]
  ds_read_b64_tr_b16 v[164:165], v25 offset:37008
  s_mul_i32 s44, s44, 4608
  v_mfma_f32_16x16x32_bf16 v[84:87], v[148:151], a[76:79], v[84:87]
  ds_read_b64_tr_b16 v[166:167], v26 offset:37008
  s_waitcnt lgkmcnt(4)
  v_mfma_f32_16x16x32_bf16 v[68:71], v[152:155], a[72:75], v[68:71]
  ds_read_b64_tr_b16 v[168:169], v21 offset:46080
  buffer_load_dwordx4 v38, s[32:35], s81 offen offset:2048 lds
  v_mfma_f32_16x16x32_bf16 v[88:91], v[152:155], a[76:79], v[88:91]
  ds_read_b64_tr_b16 v[170:171], v22 offset:46080
  s_add_u32 s90, s44, s71
  v_mfma_f32_16x16x32_bf16 v[72:75], v[156:159], a[72:75], v[72:75]
  ds_read_b64_tr_b16 v[172:173], v21 offset:46088
  s_bfe_u32 s44, s78, 262172
  v_mfma_f32_16x16x32_bf16 v[92:95], v[156:159], a[76:79], v[92:95]
  ds_read_b64_tr_b16 v[174:175], v22 offset:46088
  s_waitcnt lgkmcnt(4)
  v_mfma_f32_16x16x32_bf16 v[76:79], v[160:163], a[72:75], v[76:79]
  ds_read_b64_tr_b16 v[144:145], v21 offset:46096
  s_mul_i32 s44, s44, 4608
  v_mfma_f32_16x16x32_bf16 v[96:99], v[160:163], a[76:79], v[96:99]
  ds_read_b64_tr_b16 v[146:147], v22 offset:46096
  s_waitcnt vmcnt(24)
  v_mfma_f32_16x16x32_bf16 v[80:83], v[164:167], a[72:75], v[80:83]
  ds_read_b64_tr_b16 v[148:149], v23 offset:46080
  v_mov_b32 v8, s49
  v_mfma_f32_16x16x32_bf16 v[100:103], v[164:167], a[76:79], v[100:103]
  ds_read_b64_tr_b16 v[150:151], v24 offset:46080
  s_waitcnt lgkmcnt(4)
  v_mfma_f32_16x16x32_bf16 v[64:67], v[168:171], a[80:83], v[64:67]
  ds_read_b64_tr_b16 v[152:153], v25 offset:46080
  buffer_load_dwordx4 v39, s[32:35], s81 offen offset:3072 lds
  s_add_u32 m0, s79, 45056
  v_mfma_f32_16x16x32_bf16 v[84:87], v[168:171], a[84:87], v[84:87]
  ds_read_b64_tr_b16 v[154:155], v26 offset:46080
  s_add_u32 s91, s44, s71
  v_mfma_f32_16x16x32_bf16 v[68:71], v[172:175], a[80:83], v[68:71]
  ds_read_b64_tr_b16 v[156:157], v21 offset:46224
  s_lshl_b32 s63, s54, 2
  v_mfma_f32_16x16x32_bf16 v[88:91], v[172:175], a[84:87], v[88:91]
  ds_read_b64_tr_b16 v[158:159], v22 offset:46224
  s_waitcnt lgkmcnt(4)
  v_mfma_f32_16x16x32_bf16 v[72:75], v[144:147], a[80:83], v[72:75]
  ds_read_b64_tr_b16 v[160:161], v21 offset:46232
  v_mov_b32 v9, s63
  v_mfma_f32_16x16x32_bf16 v[92:95], v[144:147], a[84:87], v[92:95]
  ds_read_b64_tr_b16 v[162:163], v22 offset:46232
  s_waitcnt vmcnt(20)
  s_barrier
  v_mfma_f32_16x16x32_bf16 v[76:79], v[148:151], a[80:83], v[76:79]
  ds_read_b64_tr_b16 v[164:165], v21 offset:46240
  buffer_store_dword v8, v9, s[36:39], s70 offen sc1
  v_mfma_f32_16x16x32_bf16 v[96:99], v[148:151], a[84:87], v[96:99]
  ds_read_b64_tr_b16 v[166:167], v22 offset:46240
  s_waitcnt lgkmcnt(4)
  v_mfma_f32_16x16x32_bf16 v[80:83], v[152:155], a[80:83], v[80:83]
  ds_read_b64_tr_b16 v[168:169], v23 offset:46224
  buffer_load_dwordx4 v40, s[32:35], s81 offen lds
  s_bfe_u32 s81, s51, 262168
  s_mul_i32 s81, s81, 82944
  s_add_u32 s81, s81, s93
  s_add_u32 m0, s79, 104448
  v_mfma_f32_16x16x32_bf16 v[100:103], v[152:155], a[84:87], v[100:103]
  ds_read_b64_tr_b16 v[170:171], v24 offset:46224
  v_mfma_f32_16x16x32_bf16 v[64:67], v[156:159], a[88:91], v[64:67]
  ds_read_b64_tr_b16 v[172:173], v25 offset:46224
  v_mfma_f32_16x16x32_bf16 v[84:87], v[156:159], a[92:95], v[84:87]
  ds_read_b64_tr_b16 v[174:175], v26 offset:46224
  s_waitcnt lgkmcnt(4)
  v_mfma_f32_16x16x32_bf16 v[68:71], v[160:163], a[88:91], v[68:71]
  v_add_u32 v21, 4294939648, v21
  v_add_u32 v22, 4294939648, v22
  v_add_u32 v23, 4294939648, v23
  v_add_u32 v24, 4294939648, v24
  v_mfma_f32_16x16x32_bf16 v[88:91], v[160:163], a[92:95], v[88:91]
  v_add_u32 v25, 4294939648, v25
  v_add_u32 v26, 4294939648, v26
  ds_read_b64_tr_b16 v[144:145], v21 offset:0
  ds_read_b64_tr_b16 v[146:147], v22 offset:0
  v_mfma_f32_16x16x32_bf16 v[72:75], v[164:167], a[88:91], v[72:75]
  ds_read_b64_tr_b16 v[148:149], v21 offset:8
  buffer_load_dwordx4 v36, s[32:35], s81 offen offset:0 lds
  v_mfma_f32_16x16x32_bf16 v[92:95], v[164:167], a[92:95], v[92:95]
  ds_read_b64_tr_b16 v[150:151], v22 offset:8
  s_waitcnt lgkmcnt(4)
  v_mfma_f32_16x16x32_bf16 v[76:79], v[168:171], a[88:91], v[76:79]
  ds_read_b64_tr_b16 v[152:153], v21 offset:16
  v_mfma_f32_16x16x32_bf16 v[96:99], v[168:171], a[92:95], v[96:99]
  ds_read_b64_tr_b16 v[154:155], v22 offset:16
  v_mfma_f32_16x16x32_bf16 v[80:83], v[172:175], a[88:91], v[80:83]
  ds_read_b64_tr_b16 v[156:157], v23 offset:0
  buffer_load_dwordx4 v37, s[32:35], s81 offen offset:1024 lds
  v_mfma_f32_16x16x32_bf16 v[100:103], v[172:175], a[92:95], v[100:103]
  ds_read_b64_tr_b16 v[158:159], v24 offset:0
  s_waitcnt lgkmcnt(4)
  v_mfma_f32_16x16x32_bf16 v[64:67], v[144:147], a[96:99], v[64:67]
  ds_read_b64_tr_b16 v[160:161], v25 offset:0
  v_mfma_f32_16x16x32_bf16 v[84:87], v[144:147], a[100:103], v[84:87]
  ds_read_b64_tr_b16 v[162:163], v26 offset:0
  v_mfma_f32_16x16x32_bf16 v[68:71], v[148:151], a[96:99], v[68:71]
  ds_read_b64_tr_b16 v[164:165], v21 offset:144
  v_mfma_f32_16x16x32_bf16 v[88:91], v[148:151], a[100:103], v[88:91]
  ds_read_b64_tr_b16 v[166:167], v22 offset:144
  s_waitcnt lgkmcnt(4)
  v_mfma_f32_16x16x32_bf16 v[72:75], v[152:155], a[96:99], v[72:75]
  ds_read_b64_tr_b16 v[168:169], v21 offset:152
  buffer_load_dwordx4 v38, s[32:35], s81 offen offset:2048 lds
  v_mfma_f32_16x16x32_bf16 v[92:95], v[152:155], a[100:103], v[92:95]
  ds_read_b64_tr_b16 v[170:171], v22 offset:152
  v_mfma_f32_16x16x32_bf16 v[76:79], v[156:159], a[96:99], v[76:79]
  ds_read_b64_tr_b16 v[172:173], v21 offset:160
  v_mfma_f32_16x16x32_bf16 v[96:99], v[156:159], a[100:103], v[96:99]
  ds_read_b64_tr_b16 v[174:175], v22 offset:160
  s_waitcnt lgkmcnt(4)
  v_mfma_f32_16x16x32_bf16 v[80:83], v[160:163], a[96:99], v[80:83]
  ds_read_b64_tr_b16 v[144:145], v23 offset:144
  v_mfma_f32_16x16x32_bf16 v[100:103], v[160:163], a[100:103], v[100:103]
  ds_read_b64_tr_b16 v[146:147], v24 offset:144
  v_mfma_f32_16x16x32_bf16 v[64:67], v[164:167], a[104:107], v[64:67]
  ds_read_b64_tr_b16 v[148:149], v25 offset:144
  buffer_load_dwordx4 v39, s[32:35], s81 offen offset:3072 lds
  s_add_u32 m0, s79, 108544
  v_mfma_f32_16x16x32_bf16 v[84:87], v[164:167], a[108:111], v[84:87]
  ds_read_b64_tr_b16 v[150:151], v26 offset:144
  s_waitcnt lgkmcnt(4)
  v_mfma_f32_16x16x32_bf16 v[68:71], v[168:171], a[104:107], v[68:71]
  ds_read_b64_tr_b16 v[152:153], v21 offset:9216
  v_mfma_f32_16x16x32_bf16 v[88:91], v[168:171], a[108:111], v[88:91]
  ds_read_b64_tr_b16 v[154:155], v22 offset:9216
  v_mfma_f32_16x16x32_bf16 v[72:75], v[172:175], a[104:107], v[72:75]
  ds_read_b64_tr_b16 v[156:157], v21 offset:9224
  v_mfma_f32_16x16x32_bf16 v[92:95], v[172:175], a[108:111], v[92:95]
  ds_read_b64_tr_b16 v[158:159], v22 offset:9224
  s_waitcnt lgkmcnt(4)
  v_mfma_f32_16x16x32_bf16 v[76:79], v[144:147], a[104:107], v[76:79]
  ds_read_b64_tr_b16 v[160:161], v21 offset:9232
  v_mfma_f32_16x16x32_bf16 v[96:99], v[144:147], a[108:111], v[96:99]
  ds_read_b64_tr_b16 v[162:163], v22 offset:9232
  v_mfma_f32_16x16x32_bf16 v[80:83], v[148:151], a[104:107], v[80:83]
  ds_read_b64_tr_b16 v[164:165], v23 offset:9216
  buffer_load_dwordx4 v40, s[32:35], s81 offen lds
  s_lshl_b32 s81, s54, 7
  s_add_u32 s81, s81, s21
  s_sub_u32 s20, s20, s80
  s_add_u32 s20, s20, s79
  s_add_u32 m0, s20, 124928
  v_mfma_f32_16x16x32_bf16 v[100:103], v[148:151], a[108:111], v[100:103]
  ds_read_b64_tr_b16 v[166:167], v24 offset:9216
  s_waitcnt lgkmcnt(4)
  v_mfma_f32_16x16x32_bf16 v[64:67], v[152:155], a[112:115], v[64:67]
  ds_read_b64_tr_b16 v[168:169], v25 offset:9216
  v_mfma_f32_16x16x32_bf16 v[84:87], v[152:155], a[116:119], v[84:87]
  ds_read_b64_tr_b16 v[170:171], v26 offset:9216
  v_mfma_f32_16x16x32_bf16 v[68:71], v[156:159], a[112:115], v[68:71]
  ds_read_b64_tr_b16 v[172:173], v21 offset:9360
  v_mfma_f32_16x16x32_bf16 v[88:91], v[156:159], a[116:119], v[88:91]
  ds_read_b64_tr_b16 v[174:175], v22 offset:9360
  s_waitcnt lgkmcnt(4)
  v_mfma_f32_16x16x32_bf16 v[72:75], v[160:163], a[112:115], v[72:75]
  ds_read_b64_tr_b16 v[144:145], v21 offset:9368
  buffer_load_dwordx4 v41, s[32:35], s81 offen offset:0 lds
  v_mfma_f32_16x16x32_bf16 v[92:95], v[160:163], a[116:119], v[92:95]
  ds_read_b64_tr_b16 v[146:147], v22 offset:9368
  v_mfma_f32_16x16x32_bf16 v[76:79], v[164:167], a[112:115], v[76:79]
  ds_read_b64_tr_b16 v[148:149], v21 offset:9376
  v_mfma_f32_16x16x32_bf16 v[96:99], v[164:167], a[116:119], v[96:99]
  ds_read_b64_tr_b16 v[150:151], v22 offset:9376
  s_waitcnt lgkmcnt(4)
  v_mfma_f32_16x16x32_bf16 v[80:83], v[168:171], a[112:115], v[80:83]
  ds_read_b64_tr_b16 v[152:153], v23 offset:9360
  v_mfma_f32_16x16x32_bf16 v[100:103], v[168:171], a[116:119], v[100:103]
  ds_read_b64_tr_b16 v[154:155], v24 offset:9360
  v_mfma_f32_16x16x32_bf16 v[64:67], v[172:175], a[120:123], v[64:67]
  ds_read_b64_tr_b16 v[156:157], v25 offset:9360
  buffer_load_dwordx4 v42, s[32:35], s81 offen offset:1024 lds
  v_mfma_f32_16x16x32_bf16 v[84:87], v[172:175], a[124:127], v[84:87]
  ds_read_b64_tr_b16 v[158:159], v26 offset:9360
  s_waitcnt lgkmcnt(4)
  v_mfma_f32_16x16x32_bf16 v[68:71], v[144:147], a[120:123], v[68:71]
  ds_read_b64_tr_b16 v[160:161], v21 offset:18432
  v_mfma_f32_16x16x32_bf16 v[88:91], v[144:147], a[124:127], v[88:91]
  ds_read_b64_tr_b16 v[162:163], v22 offset:18432
  v_mfma_f32_16x16x32_bf16 v[72:75], v[148:151], a[120:123], v[72:75]
  ds_read_b64_tr_b16 v[164:165], v21 offset:18440
  v_mfma_f32_16x16x32_bf16 v[92:95], v[148:151], a[124:127], v[92:95]
  ds_read_b64_tr_b16 v[166:167], v22 offset:18440
  s_waitcnt lgkmcnt(4)
  v_mfma_f32_16x16x32_bf16 v[76:79], v[152:155], a[120:123], v[76:79]
  ds_read_b64_tr_b16 v[168:169], v21 offset:18448
  v_mfma_f32_16x16x32_bf16 v[96:99], v[152:155], a[124:127], v[96:99]
  ds_read_b64_tr_b16 v[170:171], v22 offset:18448
  v_mfma_f32_16x16x32_bf16 v[80:83], v[156:159], a[120:123], v[80:83]
  ds_read_b64_tr_b16 v[172:173], v23 offset:18432
  buffer_load_dwordx4 v43, s[32:35], s81 offen offset:2048 lds
  v_mfma_f32_16x16x32_bf16 v[100:103], v[156:159], a[124:127], v[100:103]
  ds_read_b64_tr_b16 v[174:175], v24 offset:18432
  s_waitcnt lgkmcnt(4)
  v_mfma_f32_16x16x32_bf16 v[64:67], v[160:163], a[128:131], v[64:67]
  ds_read_b64_tr_b16 v[144:145], v25 offset:18432
  v_mfma_f32_16x16x32_bf16 v[84:87], v[160:163], a[132:135], v[84:87]
  ds_read_b64_tr_b16 v[146:147], v26 offset:18432
  v_mfma_f32_16x16x32_bf16 v[68:71], v[164:167], a[128:131], v[68:71]
  ds_read_b64_tr_b16 v[148:149], v21 offset:18576
  v_mfma_f32_16x16x32_bf16 v[88:91], v[164:167], a[132:135], v[88:91]
  ds_read_b64_tr_b16 v[150:151], v22 offset:18576
  s_waitcnt lgkmcnt(4)
  v_mfma_f32_16x16x32_bf16 v[72:75], v[168:171], a[128:131], v[72:75]
  ds_read_b64_tr_b16 v[152:153], v21 offset:18584
  buffer_load_dwordx4 v44, s[32:35], s81 offen offset:3072 lds
  s_add_u32 m0, s20, 129024
  v_mfma_f32_16x16x32_bf16 v[92:95], v[168:171], a[132:135], v[92:95]
  ds_read_b64_tr_b16 v[154:155], v22 offset:18584
  v_mfma_f32_16x16x32_bf16 v[76:79], v[172:175], a[128:131], v[76:79]
  ds_read_b64_tr_b16 v[156:157], v21 offset:18592
  v_mfma_f32_16x16x32_bf16 v[96:99], v[172:175], a[132:135], v[96:99]
  ds_read_b64_tr_b16 v[158:159], v22 offset:18592
  s_waitcnt lgkmcnt(4)
  v_mfma_f32_16x16x32_bf16 v[80:83], v[144:147], a[128:131], v[80:83]
  ds_read_b64_tr_b16 v[160:161], v23 offset:18576
  v_mfma_f32_16x16x32_bf16 v[100:103], v[144:147], a[132:135], v[100:103]
  ds_read_b64_tr_b16 v[162:163], v24 offset:18576
  v_mfma_f32_16x16x32_bf16 v[64:67], v[148:151], a[136:139], v[64:67]
  ds_read_b64_tr_b16 v[164:165], v25 offset:18576
  buffer_load_dwordx4 v45, s[32:35], s81 offen lds
  v_mfma_f32_16x16x32_bf16 v[84:87], v[148:151], a[140:143], v[84:87]
  ds_read_b64_tr_b16 v[166:167], v26 offset:18576
  s_waitcnt lgkmcnt(4)
  v_mfma_f32_16x16x32_bf16 v[68:71], v[152:155], a[136:139], v[68:71]
  v_mfma_f32_16x16x32_bf16 v[88:91], v[152:155], a[140:143], v[88:91]
  v_mfma_f32_16x16x32_bf16 v[72:75], v[156:159], a[136:139], v[72:75]
  v_mfma_f32_16x16x32_bf16 v[92:95], v[156:159], a[140:143], v[92:95]
  s_waitcnt lgkmcnt(0)
  v_mfma_f32_16x16x32_bf16 v[76:79], v[160:163], a[136:139], v[76:79]
  v_mfma_f32_16x16x32_bf16 v[96:99], v[160:163], a[140:143], v[96:99]
  v_mfma_f32_16x16x32_bf16 v[80:83], v[164:167], a[136:139], v[80:83]
  v_mfma_f32_16x16x32_bf16 v[100:103], v[164:167], a[140:143], v[100:103]
  s_nop 0
  v_cvt_pk_bf16_f32 v176, v64, v65
  v_cvt_pk_bf16_f32 v177, v66, v67
  v_cvt_pk_bf16_f32 v178, v68, v69
  v_cvt_pk_bf16_f32 v179, v70, v71
  v_cvt_pk_bf16_f32 v180, v72, v73
  v_cvt_pk_bf16_f32 v181, v74, v75
  v_cvt_pk_bf16_f32 v182, v76, v77
  v_cvt_pk_bf16_f32 v183, v78, v79
  v_permlane16_swap_b32 v80, v82
  v_permlane16_swap_b32 v81, v83
  v_cvt_pk_bf16_f32 v184, v80, v81
  v_mfma_f32_16x16x32_bf16 v[64:67], a[144:147], v[176:179], 0
  v_cvt_pk_bf16_f32 v188, v84, v85
  v_cvt_pk_bf16_f32 v189, v86, v87
  v_mfma_f32_16x16x32_bf16 v[68:71], a[156:159], v[176:179], 0
  v_cvt_pk_bf16_f32 v190, v88, v89
  v_cvt_pk_bf16_f32 v191, v90, v91
  v_mfma_f32_16x16x32_bf16 v[72:75], a[168:171], v[176:179], 0
  v_cvt_pk_bf16_f32 v192, v92, v93
  v_cvt_pk_bf16_f32 v193, v94, v95
  v_mfma_f32_16x16x32_bf16 v[76:79], a[180:183], v[176:179], 0
  v_cvt_pk_bf16_f32 v194, v96, v97
  v_cvt_pk_bf16_f32 v195, v98, v99
  v_mfma_f32_16x16x32_bf16 v[80:83], a[192:195], v[176:179], 0
  v_permlane16_swap_b32 v100, v102
  v_permlane16_swap_b32 v101, v103
  v_mfma_f32_16x16x32_bf16 v[64:67], a[148:151], v[180:183], v[64:67]
  v_cvt_pk_bf16_f32 v196, v100, v101
  v_and_b32 v5, 7, v0
  v_mfma_f32_16x16x32_bf16 v[68:71], a[160:163], v[180:183], v[68:71]
  v_lshlrev_b32 v5, 2, v5
  v_and_b32 v1, 1, v47
  v_mfma_f32_16x16x32_bf16 v[72:75], a[172:175], v[180:183], v[72:75]
  v_lshl_add_u32 v2, v47, 3, v251
  v_lshl_add_u32 v2, v1, 2, v2
  v_mfma_f32_16x16x32_bf16 v[76:79], a[184:187], v[180:183], v[76:79]
  v_xor_b32 v3, 4, v2
  v_mul_u32_u24 v2, 160, v2
  v_mfma_f32_16x16x32_bf16 v[80:83], a[196:199], v[180:183], v[80:83]
  v_mul_u32_u24 v3, 160, v3
  v_lshl_add_u32 v21, v252, 3, v2
  v_mfma_f32_16x16x32_bf16 v[64:67], a[152:155], v[184:187], v[64:67]
  v_lshl_add_u32 v22, v252, 3, v3
  v_add_u32 v23, 104448, v21
  v_mfma_f32_16x16x32_bf16 v[68:71], a[164:167], v[184:187], v[68:71]
  v_add_u32 v24, 104448, v22
  v_accvgpr_write_b32 a34, 0
  v_mfma_f32_16x16x32_bf16 v[72:75], a[176:179], v[184:187], v[72:75]
  v_accvgpr_write_b32 a35, 0
  v_accvgpr_write_b32 a38, 0
  v_mfma_f32_16x16x32_bf16 v[76:79], a[188:191], v[184:187], v[76:79]
  v_accvgpr_write_b32 a39, 0
  v_accvgpr_write_b32 a42, 0
  v_mfma_f32_16x16x32_bf16 v[80:83], a[200:203], v[184:187], v[80:83]
  v_accvgpr_write_b32 a43, 0
  v_accvgpr_write_b32 a46, 0
  v_mfma_f32_16x16x32_bf16 v[84:87], a[144:147], v[188:191], 0
  v_accvgpr_write_b32 a47, 0
  v_accvgpr_write_b32 a50, 0
  v_mfma_f32_16x16x32_bf16 v[88:91], a[156:159], v[188:191], 0
  v_accvgpr_write_b32 a51, 0
  v_mfma_f32_16x16x32_bf16 v[92:95], a[168:171], v[188:191], 0
  v_mfma_f32_16x16x32_bf16 v[96:99], a[180:183], v[188:191], 0
  v_mfma_f32_16x16x32_bf16 v[100:103], a[192:195], v[188:191], 0
  v_mfma_f32_16x16x32_bf16 v[84:87], a[148:151], v[192:195], v[84:87]
  v_mfma_f32_16x16x32_bf16 v[88:91], a[160:163], v[192:195], v[88:91]
  v_mfma_f32_16x16x32_bf16 v[92:95], a[172:175], v[192:195], v[92:95]
  v_mfma_f32_16x16x32_bf16 v[96:99], a[184:187], v[192:195], v[96:99]
  v_mfma_f32_16x16x32_bf16 v[100:103], a[196:199], v[192:195], v[100:103]
  v_max3_f32 v162, v64, v65, v66
  v_max3_f32 v162, v162, v67, v68
  v_mfma_f32_16x16x32_bf16 v[84:87], a[152:155], v[196:199], v[84:87]
  v_max3_f32 v162, v162, v69, v70
  v_max3_f32 v162, v162, v71, v72
  v_mfma_f32_16x16x32_bf16 v[88:91], a[164:167], v[196:199], v[88:91]
  v_max3_f32 v162, v162, v73, v74
  v_max3_f32 v162, v162, v75, v76
  v_mfma_f32_16x16x32_bf16 v[92:95], a[176:179], v[196:199], v[92:95]
  v_max3_f32 v162, v162, v77, v78
  v_max3_f32 v162, v162, v79, v80
  v_mfma_f32_16x16x32_bf16 v[96:99], a[188:191], v[196:199], v[96:99]
  v_max_f32 v162, v162, v81
  v_mul_f32 v164, s74, v162
  v_mfma_f32_16x16x32_bf16 v[100:103], a[200:203], v[196:199], v[100:103]
  v_pk_fma_f32 v[64:65], v[64:65], s[74:75], v[164:165] op_sel:[0,0,0] op_sel_hi:[1,1,0] neg_lo:[0,0,1] neg_hi:[0,0,1]
  v_pk_fma_f32 v[66:67], v[66:67], s[74:75], v[164:165] op_sel:[0,0,0] op_sel_hi:[1,1,0] neg_lo:[0,0,1] neg_hi:[0,0,1]
  v_pk_fma_f32 v[68:69], v[68:69], s[74:75], v[164:165] op_sel:[0,0,0] op_sel_hi:[1,1,0] neg_lo:[0,0,1] neg_hi:[0,0,1]
  v_pk_fma_f32 v[70:71], v[70:71], s[74:75], v[164:165] op_sel:[0,0,0] op_sel_hi:[1,1,0] neg_lo:[0,0,1] neg_hi:[0,0,1]
  v_pk_fma_f32 v[72:73], v[72:73], s[74:75], v[164:165] op_sel:[0,0,0] op_sel_hi:[1,1,0] neg_lo:[0,0,1] neg_hi:[0,0,1]
  v_pk_fma_f32 v[74:75], v[74:75], s[74:75], v[164:165] op_sel:[0,0,0] op_sel_hi:[1,1,0] neg_lo:[0,0,1] neg_hi:[0,0,1]
  v_pk_fma_f32 v[76:77], v[76:77], s[74:75], v[164:165] op_sel:[0,0,0] op_sel_hi:[1,1,0] neg_lo:[0,0,1] neg_hi:[0,0,1]
  v_pk_fma_f32 v[78:79], v[78:79], s[74:75], v[164:165] op_sel:[0,0,0] op_sel_hi:[1,1,0] neg_lo:[0,0,1] neg_hi:[0,0,1]
  v_pk_fma_f32 v[80:81], v[80:81], s[74:75], v[164:165] op_sel:[0,0,0] op_sel_hi:[1,1,0] neg_lo:[0,0,1] neg_hi:[0,0,1]
  v_exp_f32 v64, v64
  v_exp_f32 v65, v65
  v_exp_f32 v66, v66
  v_exp_f32 v67, v67
  v_rcp_f32 v144, v64
  v_rcp_f32 v145, v65
  v_exp_f32 v68, v68
  v_exp_f32 v69, v69
  v_rcp_f32 v146, v66
  v_rcp_f32 v147, v67
  v_pk_add_f32 v[162:163], v[64:65], v[66:67]
  v_exp_f32 v70, v70
  v_exp_f32 v71, v71
  v_rcp_f32 v148, v68
  v_rcp_f32 v149, v69
  v_pk_add_f32 v[162:163], v[162:163], v[68:69]
  v_pk_add_f32 v[164:165], v[144:145], v[146:147]
  v_exp_f32 v72, v72
  v_exp_f32 v73, v73
  v_rcp_f32 v150, v70
  v_rcp_f32 v151, v71
  v_pk_add_f32 v[162:163], v[162:163], v[70:71]
  v_pk_add_f32 v[164:165], v[164:165], v[148:149]
  v_exp_f32 v74, v74
  v_exp_f32 v75, v75
  v_rcp_f32 v152, v72
  v_rcp_f32 v153, v73
  v_pk_add_f32 v[162:163], v[162:163], v[72:73]
  v_pk_add_f32 v[164:165], v[164:165], v[150:151]
  v_exp_f32 v76, v76
  v_exp_f32 v77, v77
  v_rcp_f32 v154, v74
  v_rcp_f32 v155, v75
  v_pk_add_f32 v[162:163], v[162:163], v[74:75]
  v_pk_add_f32 v[164:165], v[164:165], v[152:153]
  v_exp_f32 v78, v78
  v_exp_f32 v79, v79
  v_rcp_f32 v156, v76
  v_rcp_f32 v157, v77
  v_pk_add_f32 v[162:163], v[162:163], v[76:77]
  v_pk_add_f32 v[164:165], v[164:165], v[154:155]
  v_exp_f32 v80, v80
  v_exp_f32 v81, v81
  v_rcp_f32 v158, v78
  v_rcp_f32 v159, v79
  v_pk_add_f32 v[162:163], v[162:163], v[78:79]
  v_pk_add_f32 v[164:165], v[164:165], v[156:157]
  v_rcp_f32 v160, v80
  v_rcp_f32 v161, v81
  v_pk_add_f32 v[162:163], v[162:163], v[80:81]
  v_pk_add_f32 v[164:165], v[164:165], v[158:159]
  v_pk_add_f32 v[164:165], v[164:165], v[160:161]
  v_add_f32 v167, v164, v165
  v_cmp_ngt_f32 vcc, 1568669696, v167
  v_add_f32 v166, v162, v163
  v_rcp_f32 v167, v167
  v_rcp_f32 v166, v166
  s_cbranch_vccnz L_smxq0
L_smbq0:
  s_nop 0
  v_pk_mul_f32 v[64:65], v[64:65], v[166:167] op_sel:[0,0] op_sel_hi:[1,0]
  v_pk_mul_f32 v[66:67], v[66:67], v[166:167] op_sel:[0,0] op_sel_hi:[1,0]
  v_cvt_pk_bf16_f32 v200, v64, v65
  v_cvt_pk_bf16_f32 v201, v66, v67
  v_pk_mul_f32 v[68:69], v[68:69], v[166:167] op_sel:[0,0] op_sel_hi:[1,0]
  v_pk_mul_f32 v[70:71], v[70:71], v[166:167] op_sel:[0,0] op_sel_hi:[1,0]
  v_cvt_pk_bf16_f32 v202, v68, v69
  v_cvt_pk_bf16_f32 v203, v70, v71
  v_pk_mul_f32 v[72:73], v[72:73], v[166:167] op_sel:[0,0] op_sel_hi:[1,0]
  v_pk_mul_f32 v[74:75], v[74:75], v[166:167] op_sel:[0,0] op_sel_hi:[1,0]
  v_cvt_pk_bf16_f32 v204, v72, v73
  v_cvt_pk_bf16_f32 v205, v74, v75
  v_pk_mul_f32 v[76:77], v[76:77], v[166:167] op_sel:[0,0] op_sel_hi:[1,0]
  v_pk_mul_f32 v[78:79], v[78:79], v[166:167] op_sel:[0,0] op_sel_hi:[1,0]
  v_cvt_pk_bf16_f32 v206, v76, v77
  v_cvt_pk_bf16_f32 v207, v78, v79
  v_pk_mul_f32 v[80:81], v[80:81], v[166:167] op_sel:[0,0] op_sel_hi:[1,0]
  v_pk_mul_f32 v[144:145], v[144:145], v[166:167] op_sel:[0,1] op_sel_hi:[1,1]
  v_cvt_pk_bf16_f32 v208, v80, v81
  v_cvt_pk_bf16_f32 v209, v144, v145
  v_pk_mul_f32 v[146:147], v[146:147], v[166:167] op_sel:[0,1] op_sel_hi:[1,1]
  v_pk_mul_f32 v[148:149], v[148:149], v[166:167] op_sel:[0,1] op_sel_hi:[1,1]
  v_cvt_pk_bf16_f32 v210, v146, v147
  v_cvt_pk_bf16_f32 v211, v148, v149
  v_pk_mul_f32 v[150:151], v[150:151], v[166:167] op_sel:[0,1] op_sel_hi:[1,1]
  v_pk_mul_f32 v[152:153], v[152:153], v[166:167] op_sel:[0,1] op_sel_hi:[1,1]
  v_cvt_pk_bf16_f32 v212, v150, v151
  v_cvt_pk_bf16_f32 v213, v152, v153
  v_pk_mul_f32 v[154:155], v[154:155], v[166:167] op_sel:[0,1] op_sel_hi:[1,1]
  v_pk_mul_f32 v[156:157], v[156:157], v[166:167] op_sel:[0,1] op_sel_hi:[1,1]
  v_cvt_pk_bf16_f32 v214, v154, v155
  v_cvt_pk_bf16_f32 v215, v156, v157
  v_pk_mul_f32 v[158:159], v[158:159], v[166:167] op_sel:[0,1] op_sel_hi:[1,1]
  v_pk_mul_f32 v[160:161], v[160:161], v[166:167] op_sel:[0,1] op_sel_hi:[1,1]
  v_cvt_pk_bf16_f32 v216, v158, v159
  v_cvt_pk_bf16_f32 v217, v160, v161
  v_max3_f32 v162, v84, v85, v86
  v_max3_f32 v162, v162, v87, v88
  v_max3_f32 v162, v162, v89, v90
  v_max3_f32 v162, v162, v91, v92
  v_max3_f32 v162, v162, v93, v94
  v_max3_f32 v162, v162, v95, v96
  v_max3_f32 v162, v162, v97, v98
  v_max3_f32 v162, v162, v99, v100
  v_max_f32 v162, v162, v101
  v_mul_f32 v164, s74, v162
  v_pk_fma_f32 v[84:85], v[84:85], s[74:75], v[164:165] op_sel:[0,0,0] op_sel_hi:[1,1,0] neg_lo:[0,0,1] neg_hi:[0,0,1]
  v_pk_fma_f32 v[86:87], v[86:87], s[74:75], v[164:165] op_sel:[0,0,0] op_sel_hi:[1,1,0] neg_lo:[0,0,1] neg_hi:[0,0,1]
  v_pk_fma_f32 v[88:89], v[88:89], s[74:75], v[164:165] op_sel:[0,0,0] op_sel_hi:[1,1,0] neg_lo:[0,0,1] neg_hi:[0,0,1]
  v_pk_fma_f32 v[90:91], v[90:91], s[74:75], v[164:165] op_sel:[0,0,0] op_sel_hi:[1,1,0] neg_lo:[0,0,1] neg_hi:[0,0,1]
  v_pk_fma_f32 v[92:93], v[92:93], s[74:75], v[164:165] op_sel:[0,0,0] op_sel_hi:[1,1,0] neg_lo:[0,0,1] neg_hi:[0,0,1]
  v_pk_fma_f32 v[94:95], v[94:95], s[74:75], v[164:165] op_sel:[0,0,0] op_sel_hi:[1,1,0] neg_lo:[0,0,1] neg_hi:[0,0,1]
  v_pk_fma_f32 v[96:97], v[96:97], s[74:75], v[164:165] op_sel:[0,0,0] op_sel_hi:[1,1,0] neg_lo:[0,0,1] neg_hi:[0,0,1]
  v_pk_fma_f32 v[98:99], v[98:99], s[74:75], v[164:165] op_sel:[0,0,0] op_sel_hi:[1,1,0] neg_lo:[0,0,1] neg_hi:[0,0,1]
  v_pk_fma_f32 v[100:101], v[100:101], s[74:75], v[164:165] op_sel:[0,0,0] op_sel_hi:[1,1,0] neg_lo:[0,0,1] neg_hi:[0,0,1]
  v_exp_f32 v84, v84
  v_exp_f32 v85, v85
  v_exp_f32 v86, v86
  v_exp_f32 v87, v87
  v_rcp_f32 v144, v84
  v_rcp_f32 v145, v85
  v_exp_f32 v88, v88
  v_exp_f32 v89, v89
  v_rcp_f32 v146, v86
  v_rcp_f32 v147, v87
  v_pk_add_f32 v[162:163], v[84:85], v[86:87]
  v_exp_f32 v90, v90
  v_exp_f32 v91, v91
  buffer_load_dword v116, v5, s[36:39], s70 offen sc1
  v_rcp_f32 v148, v88
  v_rcp_f32 v149, v89
  v_pk_add_f32 v[162:163], v[162:163], v[88:89]
  buffer_load_dwordx4 v[104:107], v46, s[36:39], s92 offen offset:0 sc1
  v_pk_add_f32 v[164:165], v[144:145], v[146:147]
  v_exp_f32 v92, v92
  v_exp_f32 v93, v93
  buffer_load_dwordx4 v[108:111], v46, s[36:39], s92 offen offset:1024 sc1
  v_rcp_f32 v150, v90
  v_rcp_f32 v151, v91
  v_pk_add_f32 v[162:163], v[162:163], v[90:91]
  buffer_load_dwordx4 v[112:115], v46, s[36:39], s92 offen offset:2048 sc1
  v_pk_add_f32 v[164:165], v[164:165], v[148:149]
  v_exp_f32 v94, v94
  v_exp_f32 v95, v95
  v_rcp_f32 v152, v92
  v_rcp_f32 v153, v93
  v_pk_add_f32 v[162:163], v[162:163], v[92:93]
  v_pk_add_f32 v[164:165], v[164:165], v[150:151]
  v_exp_f32 v96, v96
  v_exp_f32 v97, v97
  v_rcp_f32 v154, v94
  v_rcp_f32 v155, v95
  v_pk_add_f32 v[162:163], v[162:163], v[94:95]
  v_pk_add_f32 v[164:165], v[164:165], v[152:153]
  v_exp_f32 v98, v98
  v_exp_f32 v99, v99
  v_rcp_f32 v156, v96
  v_rcp_f32 v157, v97
  v_pk_add_f32 v[162:163], v[162:163], v[96:97]
  v_pk_add_f32 v[164:165], v[164:165], v[154:155]
  v_exp_f32 v100, v100
  v_exp_f32 v101, v101
  v_rcp_f32 v158, v98
  v_rcp_f32 v159, v99
  v_pk_add_f32 v[162:163], v[162:163], v[98:99]
  v_pk_add_f32 v[164:165], v[164:165], v[156:157]
  v_rcp_f32 v160, v100
  v_rcp_f32 v161, v101
  v_pk_add_f32 v[162:163], v[162:163], v[100:101]
  v_pk_add_f32 v[164:165], v[164:165], v[158:159]
  v_pk_add_f32 v[164:165], v[164:165], v[160:161]
  v_add_f32 v167, v164, v165
  v_cmp_ngt_f32 vcc, 1568669696, v167
  v_add_f32 v166, v162, v163
  v_rcp_f32 v167, v167
  v_rcp_f32 v166, v166
  s_cbranch_vccnz L_smxq1
L_smbq1:
  s_nop 0
  v_pk_mul_f32 v[84:85], v[84:85], v[166:167] op_sel:[0,0] op_sel_hi:[1,0]
  v_pk_mul_f32 v[86:87], v[86:87], v[166:167] op_sel:[0,0] op_sel_hi:[1,0]
  v_cvt_pk_bf16_f32 v220, v84, v85
  v_cvt_pk_bf16_f32 v221, v86, v87
  v_pk_mul_f32 v[88:89], v[88:89], v[166:167] op_sel:[0,0] op_sel_hi:[1,0]
  v_pk_mul_f32 v[90:91], v[90:91], v[166:167] op_sel:[0,0] op_sel_hi:[1,0]
  v_cvt_pk_bf16_f32 v222, v88, v89
  v_cvt_pk_bf16_f32 v223, v90, v91
  v_pk_mul_f32 v[92:93], v[92:93], v[166:167] op_sel:[0,0] op_sel_hi:[1,0]
  v_pk_mul_f32 v[94:95], v[94:95], v[166:167] op_sel:[0,0] op_sel_hi:[1,0]
  v_cvt_pk_bf16_f32 v224, v92, v93
  v_cvt_pk_bf16_f32 v225, v94, v95
  v_pk_mul_f32 v[96:97], v[96:97], v[166:167] op_sel:[0,0] op_sel_hi:[1,0]
  v_pk_mul_f32 v[98:99], v[98:99], v[166:167] op_sel:[0,0] op_sel_hi:[1,0]
  v_cvt_pk_bf16_f32 v226, v96, v97
  v_cvt_pk_bf16_f32 v227, v98, v99
  v_pk_mul_f32 v[100:101], v[100:101], v[166:167] op_sel:[0,0] op_sel_hi:[1,0]
  v_pk_mul_f32 v[144:145], v[144:145], v[166:167] op_sel:[0,1] op_sel_hi:[1,1]
  v_cvt_pk_bf16_f32 v228, v100, v101
  v_cvt_pk_bf16_f32 v229, v144, v145
  v_pk_mul_f32 v[146:147], v[146:147], v[166:167] op_sel:[0,1] op_sel_hi:[1,1]
  v_pk_mul_f32 v[148:149], v[148:149], v[166:167] op_sel:[0,1] op_sel_hi:[1,1]
  v_cvt_pk_bf16_f32 v230, v146, v147
  v_cvt_pk_bf16_f32 v231, v148, v149
  v_pk_mul_f32 v[150:151], v[150:151], v[166:167] op_sel:[0,1] op_sel_hi:[1,1]
  v_pk_mul_f32 v[152:153], v[152:153], v[166:167] op_sel:[0,1] op_sel_hi:[1,1]
  v_cvt_pk_bf16_f32 v232, v150, v151
  v_cvt_pk_bf16_f32 v233, v152, v153
  v_pk_mul_f32 v[154:155], v[154:155], v[166:167] op_sel:[0,1] op_sel_hi:[1,1]
  v_pk_mul_f32 v[156:157], v[156:157], v[166:167] op_sel:[0,1] op_sel_hi:[1,1]
  v_cvt_pk_bf16_f32 v234, v154, v155
  v_cvt_pk_bf16_f32 v235, v156, v157
  v_pk_mul_f32 v[158:159], v[158:159], v[166:167] op_sel:[0,1] op_sel_hi:[1,1]
  v_pk_mul_f32 v[160:161], v[160:161], v[166:167] op_sel:[0,1] op_sel_hi:[1,1]
  v_cvt_pk_bf16_f32 v236, v158, v159
  v_cvt_pk_bf16_f32 v237, v160, v161
  v_permlane32_swap_b32 v200, v208
  v_permlane32_swap_b32 v204, v212
  v_permlane32_swap_b32 v201, v209
  v_permlane32_swap_b32 v205, v213
  v_permlane32_swap_b32 v202, v210
  v_permlane32_swap_b32 v206, v214
  v_permlane32_swap_b32 v203, v211
  v_permlane32_swap_b32 v207, v215
  v_permlane16_swap_b32 v200, v204
  v_permlane16_swap_b32 v208, v212
  v_permlane16_swap_b32 v201, v205
  v_permlane16_swap_b32 v209, v213
  v_permlane16_swap_b32 v202, v206
  v_permlane16_swap_b32 v210, v214
  v_permlane16_swap_b32 v203, v207
  v_permlane16_swap_b32 v211, v215
  v_permlane32_swap_b32 v220, v228
  v_permlane32_swap_b32 v224, v232
  v_permlane32_swap_b32 v221, v229
  v_permlane32_swap_b32 v225, v233
L_tp4:
  s_cbranch_execz L_tret1
  v_permlane32_swap_b32 v222, v230
  v_permlane32_swap_b32 v226, v234
  v_permlane32_swap_b32 v223, v231
  v_permlane32_swap_b32 v227, v235
  v_permlane16_swap_b32 v220, v224
  v_permlane16_swap_b32 v228, v232
  v_permlane16_swap_b32 v221, v225
  v_permlane16_swap_b32 v229, v233
  v_permlane16_swap_b32 v222, v226
  v_permlane16_swap_b32 v230, v234
  v_permlane16_swap_b32 v223, v227
  v_permlane16_swap_b32 v231, v235
  s_waitcnt vmcnt(0)
  ds_write2_b32 v62, v104, v106 offset0:0 offset1:1
  ds_write2_b32 v62, v108, v110 offset0:160 offset1:161
  ds_write2_b32 v63, v112, v114 offset0:0 offset1:1
  v_xor_b32 v7, s95, v105
  v_bitop3_b32 v7, v7, s95, v107 bitop3:0xf6
  v_bitop3_b32 v7, v7, s95, v109 bitop3:0xf6
  v_bitop3_b32 v7, v7, s95, v111 bitop3:0xf6
  v_bitop3_b32 v7, v7, s95, v113 bitop3:0xf6
  v_bitop3_b32 v7, v7, s95, v115 bitop3:0xf6
  v_cmp_ne_u32 vcc, 0, v7
  s_waitcnt lgkmcnt(0)
  s_cbranch_vccnz L_slow_agB
L_back_agB:
  s_barrier
  s_nop 0
  ds_read_b64_tr_b16 a[16:17], v11 offset:32
  ds_read_b64_tr_b16 a[18:19], v11 offset:192
  ds_read_b64_tr_b16 a[20:21], v12 offset:1952
  ds_read_b64_tr_b16 a[22:23], v12 offset:2112
  ds_read_b64_tr_b16 a[24:25], v13 offset:3872
  ds_read_b64_tr_b16 a[26:27], v13 offset:4032
  ds_read_b64_tr_b16 a[28:29], v14 offset:5792
  ds_read_b64_tr_b16 a[30:31], v14 offset:5952
  ds_read_b64_tr_b16 a[48:49], v50 offset:1312
  ds_read_b64_tr_b16 a[0:1], v10 offset:0
  ds_read_b64_tr_b16 a[2:3], v10 offset:160
  ds_read_b64_tr_b16 a[32:33], v15 offset:0
  s_waitcnt lgkmcnt(8)
  v_mfma_f32_16x16x32_bf16 v[80:83], a[16:19], v[200:203], 0
  ds_read_b64_tr_b16 a[4:5], v10 offset:1920
  v_xor_b32 v7, s49, v116
  v_mfma_f32_16x16x32_bf16 v[100:103], a[16:19], v[220:223], 0
  ds_read_b64_tr_b16 a[6:7], v10 offset:2080
  v_cmp_lt_u32 vcc, 15, v7
  v_mfma_f32_16x16x32_bf16 v[80:83], a[20:23], v[204:207], v[80:83]
  ds_read_b64_tr_b16 a[36:37], v16 offset:1920
  v_mfma_f32_16x16x32_bf16 v[100:103], a[20:23], v[224:227], v[100:103]
  s_waitcnt lgkmcnt(7)
  v_mfma_f32_16x16x32_bf16 v[80:83], a[24:27], v[208:211], v[80:83]
  ds_read_b64_tr_b16 a[8:9], v10 offset:3840
  s_cbranch_vccnz L_slow_rfB
L_back_rfB:
  v_mfma_f32_16x16x32_bf16 v[100:103], a[24:27], v[228:231], v[100:103]
  ds_read_b64_tr_b16 a[10:11], v10 offset:4000
  v_cmp_ne_u32 s[50:51], 0, v7
  v_mfma_f32_16x16x32_bf16 v[80:83], a[28:31], v[212:215], v[80:83]
  ds_read_b64_tr_b16 a[40:41], v17 offset:3840
  v_mfma_f32_16x16x32_bf16 v[100:103], a[28:31], v[232:235], v[100:103]
  s_waitcnt lgkmcnt(7)
  v_mfma_f32_16x16x32_bf16 v[80:83], a[48:51], v[216:219], v[80:83]
  ds_read_b64_tr_b16 a[12:13], v10 offset:5760
  v_mfma_f32_16x16x32_bf16 v[100:103], a[48:51], v[236:239], v[100:103]
  ds_read_b64_tr_b16 a[14:15], v10 offset:5920
  v_mfma_f32_16x16x32_bf16 v[64:67], a[0:3], v[200:203], 0
  ds_read_b64_tr_b16 a[44:45], v18 offset:5760
  v_mfma_f32_16x16x32_bf16 v[84:87], a[0:3], v[220:223], 0
  s_waitcnt lgkmcnt(7)
  v_mfma_f32_16x16x32_bf16 v[64:67], a[32:35], v[216:219], v[64:67]
  v_mfma_f32_16x16x32_bf16 v[84:87], a[32:35], v[236:239], v[84:87]
  v_mfma_f32_16x16x32_bf16 v[68:71], a[4:7], v[204:207], 0
  v_add_f32 v82, s76, v82
  v_add_f32 v102, s76, v102
  v_mfma_f32_16x16x32_bf16 v[88:91], a[4:7], v[224:227], 0
  v_rcp_f32 v82, v82
  s_waitcnt lgkmcnt(4)
  v_mfma_f32_16x16x32_bf16 v[68:71], a[36:39], v[216:219], v[68:71]
  v_rcp_f32 v102, v102
  v_mov_b32 v144, v82
  v_mfma_f32_16x16x32_bf16 v[88:91], a[36:39], v[236:239], v[88:91]
  v_mov_b32 v145, v82
  v_mov_b32 v148, v102
  v_mfma_f32_16x16x32_bf16 v[72:75], a[8:11], v[208:211], 0
  v_mov_b32 v149, v102
  v_permlane16_swap_b32 v144, v145
  v_mfma_f32_16x16x32_bf16 v[92:95], a[8:11], v[228:231], 0
  v_permlane16_swap_b32 v148, v149
  s_waitcnt lgkmcnt(1)
  v_mfma_f32_16x16x32_bf16 v[72:75], a[40:43], v[216:219], v[72:75]
  v_mov_b32 v146, v144
  v_mov_b32 v147, v145
  v_mfma_f32_16x16x32_bf16 v[92:95], a[40:43], v[236:239], v[92:95]
  v_mov_b32 v150, v148
  v_mov_b32 v151, v149
  v_permlane32_swap_b32 v144, v146
  v_permlane32_swap_b32 v145, v147
  v_permlane32_swap_b32 v148, v150
  v_permlane32_swap_b32 v149, v151
  s_nop 0
  v_pk_mul_f32 v[64:65], v[64:65], v[144:145] op_sel:[0,0] op_sel_hi:[1,0]
  v_pk_mul_f32 v[66:67], v[66:67], v[144:145] op_sel:[0,0] op_sel_hi:[1,0]
  v_pk_mul_f32 v[68:69], v[68:69], v[144:145] op_sel:[0,1] op_sel_hi:[1,1]
  v_pk_mul_f32 v[70:71], v[70:71], v[144:145] op_sel:[0,1] op_sel_hi:[1,1]
  v_cvt_pk_bf16_f32 v104, v64, v65
  v_cvt_pk_bf16_f32 v105, v66, v67
  v_cvt_pk_bf16_f32 v106, v68, v69
  v_cvt_pk_bf16_f32 v107, v70, v71
  buffer_store_dwordx4 v[104:107], v46, s[36:39], s84 offen offset:0
  v_pk_mul_f32 v[84:85], v[84:85], v[148:149] op_sel:[0,0] op_sel_hi:[1,0]
  v_pk_mul_f32 v[86:87], v[86:87], v[148:149] op_sel:[0,0] op_sel_hi:[1,0]
  v_pk_mul_f32 v[88:89], v[88:89], v[148:149] op_sel:[0,1] op_sel_hi:[1,1]
  v_pk_mul_f32 v[90:91], v[90:91], v[148:149] op_sel:[0,1] op_sel_hi:[1,1]
  v_cvt_pk_bf16_f32 v108, v84, v85
  v_cvt_pk_bf16_f32 v109, v86, v87
  v_cvt_pk_bf16_f32 v110, v88, v89
  v_cvt_pk_bf16_f32 v111, v90, v91
  buffer_store_dwordx4 v[108:111], v46, s[36:39], s84 offen offset:2048
  v_mfma_f32_16x16x32_bf16 v[76:79], a[12:15], v[212:215], 0
  v_mfma_f32_16x16x32_bf16 v[96:99], a[12:15], v[232:235], 0
  s_waitcnt lgkmcnt(0)
  v_mfma_f32_16x16x32_bf16 v[76:79], a[44:47], v[216:219], v[76:79]
  v_mfma_f32_16x16x32_bf16 v[96:99], a[44:47], v[236:239], v[96:99]
  v_pk_mul_f32 v[80:81], v[80:81], v[82:83] op_sel:[0,0] op_sel_hi:[1,0]
  v_cvt_pk_bf16_f32 v120, v80, v81
  buffer_store_dword v120, v54, s[36:39], s84 offen offset:0 sc1
  v_pk_mul_f32 v[100:101], v[100:101], v[102:103] op_sel:[0,0] op_sel_hi:[1,0]
  v_cvt_pk_bf16_f32 v124, v100, v101
  buffer_store_dword v124, v54, s[36:39], s84 offen offset:256 sc1
  s_nop 0
  v_pk_mul_f32 v[72:73], v[72:73], v[146:147] op_sel:[0,0] op_sel_hi:[1,0]
  v_pk_mul_f32 v[74:75], v[74:75], v[146:147] op_sel:[0,0] op_sel_hi:[1,0]
  v_pk_mul_f32 v[76:77], v[76:77], v[146:147] op_sel:[0,1] op_sel_hi:[1,1]
  v_pk_mul_f32 v[78:79], v[78:79], v[146:147] op_sel:[0,1] op_sel_hi:[1,1]
  v_cvt_pk_bf16_f32 v112, v72, v73
  v_cvt_pk_bf16_f32 v113, v74, v75
  v_cvt_pk_bf16_f32 v114, v76, v77
  v_cvt_pk_bf16_f32 v115, v78, v79
  buffer_store_dwordx4 v[112:115], v46, s[36:39], s84 offen offset:1024 sc1
  v_pk_mul_f32 v[92:93], v[92:93], v[150:151] op_sel:[0,0] op_sel_hi:[1,0]
  v_pk_mul_f32 v[94:95], v[94:95], v[150:151] op_sel:[0,0] op_sel_hi:[1,0]
  v_pk_mul_f32 v[96:97], v[96:97], v[150:151] op_sel:[0,1] op_sel_hi:[1,1]
  v_pk_mul_f32 v[98:99], v[98:99], v[150:151] op_sel:[0,1] op_sel_hi:[1,1]
  v_cvt_pk_bf16_f32 v116, v92, v93
  v_cvt_pk_bf16_f32 v117, v94, v95
  v_cvt_pk_bf16_f32 v118, v96, v97
  v_cvt_pk_bf16_f32 v119, v98, v99
  buffer_store_dwordx4 v[116:119], v46, s[36:39], s84 offen offset:3072 sc1
  s_cmp_lg_u64 s[50:51], 0
  s_cbranch_scc1 L_farB
L_nearB:
  s_and_b32 s63, s54, 1
  s_cbranch_scc0 L_noswB
  v_swap_b32 v104, v108
  v_swap_b32 v105, v109
  v_swap_b32 v106, v110
  v_swap_b32 v107, v111
  v_swap_b32 v112, v116
  v_swap_b32 v113, v117
  v_swap_b32 v114, v118
  v_swap_b32 v115, v119
  v_swap_b32 v120, v124
L_noswB:
  s_lshl_b32 s62, s63, 11
  s_lshl_b32 s63, s63, 8
  v_add_u32 v25, s62, v46
  v_xor_b32 v26, 2048, v25
  v_add_u32 v51, s63, v54
  v_xor_b32 v52, 256, v51
  s_mov_b32 s64, 0
L_redoB:
  ds_read_b64_tr_b16 v[144:145], v21 offset:0
  ds_read_b64_tr_b16 v[146:147], v22 offset:0
  ds_read_b64_tr_b16 v[148:149], v21 offset:32
  ds_read_b64_tr_b16 v[150:151], v22 offset:32
  ds_read_b64_tr_b16 v[152:153], v21 offset:64
  ds_read_b64_tr_b16 v[154:155], v22 offset:64
  ds_read_b64_tr_b16 v[156:157], v21 offset:96
  ds_read_b64_tr_b16 v[158:159], v22 offset:96
  s_waitcnt lgkmcnt(4)
  v_mfma_f32_16x16x32_bf16 v[64:67], v[144:147], v[104:107], 0
  ds_read_b64_tr_b16 v[160:161], v21 offset:128
  buffer_load_dwordx4 v[176:179], v26, s[36:39], s85 offen offset:0 sc1
  v_mfma_f32_16x16x32_bf16 v[84:87], v[144:147], v[108:111], 0
  ds_read_b64_tr_b16 v[162:163], v22 offset:128
  ds_read_b64_tr_b16 a[0:1], v21 offset:15360
  ds_read_b64_tr_b16 a[2:3], v22 offset:15360
  v_mfma_f32_16x16x32_bf16 v[68:71], v[148:151], v[104:107], 0
  ds_read_b64_tr_b16 v[164:165], v21 offset:5120
  ds_read_b64_tr_b16 a[4:5], v21 offset:15392
  ds_read_b64_tr_b16 a[6:7], v22 offset:15392
  v_mfma_f32_16x16x32_bf16 v[88:91], v[148:151], v[108:111], 0
  ds_read_b64_tr_b16 v[166:167], v22 offset:5120
  s_waitcnt lgkmcnt(8)
  v_mfma_f32_16x16x32_bf16 v[72:75], v[152:155], v[104:107], 0
  ds_read_b64_tr_b16 v[168:169], v21 offset:5152
  buffer_load_dwordx4 v[136:139], v25, s[36:39], s85 offen offset:0 sc1
  v_mfma_f32_16x16x32_bf16 v[92:95], v[152:155], v[108:111], 0
  ds_read_b64_tr_b16 v[170:171], v22 offset:5152
  ds_read_b64_tr_b16 a[8:9], v21 offset:15424
  ds_read_b64_tr_b16 a[10:11], v22 offset:15424
  v_mfma_f32_16x16x32_bf16 v[76:79], v[156:159], v[104:107], 0
  ds_read_b64_tr_b16 v[172:173], v21 offset:5184
  ds_read_b64_tr_b16 a[12:13], v21 offset:15456
  ds_read_b64_tr_b16 a[14:15], v22 offset:15456
  v_mfma_f32_16x16x32_bf16 v[96:99], v[156:159], v[108:111], 0
  ds_read_b64_tr_b16 v[174:175], v22 offset:5184
  s_waitcnt lgkmcnt(8)
  v_mfma_f32_16x16x32_bf16 v[80:83], v[160:163], v[104:107], 0
  ds_read_b64_tr_b16 v[144:145], v21 offset:5216
  buffer_load_dwordx4 v[192:195], v26, s[36:39], s86 offen offset:0 sc1
  ds_read_b64_tr_b16 v[146:147], v22 offset:5216
  v_mfma_f32_16x16x32_bf16 v[64:67], v[164:167], v[112:115], v[64:67]
  ds_read_b64_tr_b16 v[148:149], v21 offset:5248
  ds_read_b64_tr_b16 a[16:17], v21 offset:15488
  ds_read_b64_tr_b16 a[18:19], v22 offset:15488
  v_mfma_f32_16x16x32_bf16 v[84:87], v[164:167], v[116:119], v[84:87]
  ds_read_b64_tr_b16 v[150:151], v22 offset:5248
  s_waitcnt lgkmcnt(6)
  v_mfma_f32_16x16x32_bf16 v[68:71], v[168:171], v[112:115], v[68:71]
  ds_read_b64_tr_b16 v[152:153], v21 offset:10240
  buffer_load_dwordx4 v[184:187], v25, s[36:39], s86 offen offset:0 sc1
  v_mfma_f32_16x16x32_bf16 v[88:91], v[168:171], v[116:119], v[88:91]
  ds_read_b64_tr_b16 v[154:155], v22 offset:10240
  ds_read_b64_tr_b16 a[20:21], v21 offset:25600
  ds_read_b64_tr_b16 a[22:23], v22 offset:25600
  v_mfma_f32_16x16x32_bf16 v[72:75], v[172:175], v[112:115], v[72:75]
  ds_read_b64_tr_b16 v[156:157], v21 offset:10272
  ds_read_b64_tr_b16 a[24:25], v21 offset:25632
  ds_read_b64_tr_b16 a[26:27], v22 offset:25632
  v_mfma_f32_16x16x32_bf16 v[92:95], v[172:175], v[116:119], v[92:95]
  ds_read_b64_tr_b16 v[158:159], v22 offset:10272
  s_waitcnt lgkmcnt(8)
  v_mfma_f32_16x16x32_bf16 v[76:79], v[144:147], v[112:115], v[76:79]
  ds_read_b64_tr_b16 v[160:161], v21 offset:10304
  buffer_load_dwordx4 v[208:211], v26, s[36:39], s87 offen offset:0 sc1
  v_mfma_f32_16x16x32_bf16 v[96:99], v[144:147], v[116:119], v[96:99]
  ds_read_b64_tr_b16 v[162:163], v22 offset:10304
  ds_read_b64_tr_b16 a[28:29], v21 offset:25664
  ds_read_b64_tr_b16 a[30:31], v22 offset:25664
  v_mfma_f32_16x16x32_bf16 v[80:83], v[148:151], v[112:115], v[80:83]
  ds_read_b64_tr_b16 v[164:165], v21 offset:10336
  ds_read_b64_tr_b16 v[166:167], v22 offset:10336
  ds_read_b64_tr_b16 a[32:33], v21 offset:25696
  ds_read_b64_tr_b16 a[34:35], v22 offset:25696
  buffer_load_dwordx4 v[200:203], v25, s[36:39], s87 offen offset:0 sc1
  ds_read_b64_tr_b16 a[36:37], v21 offset:25728
  ds_read_b64_tr_b16 a[38:39], v22 offset:25728
  ds_read_b64_tr_b16 a[40:41], v21 offset:35840
  ds_read_b64_tr_b16 a[42:43], v22 offset:35840
  buffer_load_dwordx4 v[224:227], v26, s[36:39], s88 offen offset:0 sc1
  ds_read_b64_tr_b16 a[44:45], v21 offset:35872
  ds_read_b64_tr_b16 a[46:47], v22 offset:35872
  ds_read_b64_tr_b16 a[48:49], v21 offset:35904
  ds_read_b64_tr_b16 a[50:51], v22 offset:35904
  buffer_load_dwordx4 v[216:219], v25, s[36:39], s88 offen offset:0 sc1
  s_nop 0
  ds_read_b64_tr_b16 a[52:53], v21 offset:35936
  ds_read_b64_tr_b16 a[54:55], v22 offset:35936
  ds_read_b64_tr_b16 a[56:57], v21 offset:35968
  ds_read_b64_tr_b16 a[58:59], v22 offset:35968
  ds_read_b64_tr_b16 a[60:61], v21 offset:46080
  ds_read_b64_tr_b16 a[62:63], v22 offset:46080
  buffer_load_dwordx4 v[240:243], v26, s[36:39], s89 offen offset:0 sc1
  ds_read_b64_tr_b16 a[64:65], v21 offset:46112
  ds_read_b64_tr_b16 a[66:67], v22 offset:46112
  ds_read_b64_tr_b16 a[68:69], v21 offset:46144
  ds_read_b64_tr_b16 a[70:71], v22 offset:46144
  buffer_load_dwordx4 v[232:235], v25, s[36:39], s89 offen offset:0 sc1
  ds_read_b64_tr_b16 a[72:73], v21 offset:46176
  ds_read_b64_tr_b16 a[74:75], v22 offset:46176
  ds_read_b64_tr_b16 a[76:77], v21 offset:46208
  ds_read_b64_tr_b16 a[78:79], v22 offset:46208
  s_waitcnt vmcnt(8)
  v_max3_u32 v7, v179, v139, v179
  v_cmp_eq_u32 vcc, -1, v7
  s_cbranch_vccnz L_slow_oa1B
L_back_oa1B:
  s_waitcnt lgkmcnt(15)
  v_mfma_f32_16x16x32_bf16 v[64:67], v[152:155], v[136:139], v[64:67]
  ds_read_b64_tr_b16 v[168:169], v21 offset:10368
  buffer_load_dwordx4 v[12:15], v26, s[36:39], s90 offen offset:0 sc1
  v_mfma_f32_16x16x32_bf16 v[84:87], v[152:155], v[176:179], v[84:87]
  ds_read_b64_tr_b16 v[170:171], v22 offset:10368
  v_mfma_f32_16x16x32_bf16 v[68:71], v[156:159], v[136:139], v[68:71]
  ds_read_b64_tr_b16 v[172:173], v21 offset:20480
  v_mfma_f32_16x16x32_bf16 v[88:91], v[156:159], v[176:179], v[88:91]
  ds_read_b64_tr_b16 v[174:175], v22 offset:20480
  v_mfma_f32_16x16x32_bf16 v[72:75], v[160:163], v[136:139], v[72:75]
  ds_read_b64_tr_b16 v[144:145], v21 offset:20512
  ds_read_b64_tr_b16 a[80:81], v21 offset:56320
  v_mfma_f32_16x16x32_bf16 v[92:95], v[160:163], v[176:179], v[92:95]
  ds_read_b64_tr_b16 v[146:147], v22 offset:20512
  buffer_load_dwordx4 v[248:251], v25, s[36:39], s90 offen offset:0 sc1
  v_mfma_f32_16x16x32_bf16 v[76:79], v[164:167], v[136:139], v[76:79]
  ds_read_b64_tr_b16 v[148:149], v21 offset:20544
  s_waitcnt vmcnt(6)
  v_mfma_f32_16x16x32_bf16 v[96:99], v[164:167], v[176:179], v[96:99]
  ds_read_b64_tr_b16 v[150:151], v22 offset:20544
  s_waitcnt lgkmcnt(5)
  v_mfma_f32_16x16x32_bf16 v[80:83], v[168:171], v[136:139], v[80:83]
  ds_read_b64_tr_b16 v[152:153], v21 offset:20576
  v_max3_u32 v7, v195, v187, v211
  ds_read_b64_tr_b16 v[154:155], v22 offset:20576
  v_max_u32 v7, v7, v203
  v_cmp_eq_u32 vcc, -1, v7
  s_cbranch_vccnz L_slow_oa2B
L_back_oa2B:
  v_mfma_f32_16x16x32_bf16 v[64:67], v[172:175], v[184:187], v[64:67]
  ds_read_b64_tr_b16 v[156:157], v21 offset:20608
  ds_read_b64_tr_b16 a[82:83], v22 offset:56320
  v_mfma_f32_16x16x32_bf16 v[84:87], v[172:175], v[192:195], v[84:87]
  ds_read_b64_tr_b16 v[158:159], v22 offset:20608
  s_waitcnt lgkmcnt(5)
  v_mfma_f32_16x16x32_bf16 v[68:71], v[144:147], v[184:187], v[68:71]
  ds_read_b64_tr_b16 v[160:161], v21 offset:30720
  ds_read_b64_tr_b16 a[84:85], v21 offset:56352
  v_mfma_f32_16x16x32_bf16 v[88:91], v[144:147], v[192:195], v[88:91]
  ds_read_b64_tr_b16 v[162:163], v22 offset:30720
  buffer_load_dwordx4 v[36:39], v26, s[36:39], s91 offen offset:0 sc1
  v_mfma_f32_16x16x32_bf16 v[72:75], v[148:151], v[184:187], v[72:75]
  ds_read_b64_tr_b16 v[164:165], v21 offset:30752
  ds_read_b64_tr_b16 a[86:87], v22 offset:56352
  v_mfma_f32_16x16x32_bf16 v[92:95], v[148:151], v[192:195], v[92:95]
  ds_read_b64_tr_b16 v[166:167], v22 offset:30752
  s_waitcnt lgkmcnt(6)
  v_mfma_f32_16x16x32_bf16 v[76:79], v[152:155], v[184:187], v[76:79]
  ds_read_b64_tr_b16 v[168:169], v21 offset:30784
  ds_read_b64_tr_b16 a[88:89], v21 offset:56384
  v_mfma_f32_16x16x32_bf16 v[96:99], v[152:155], v[192:195], v[96:99]
  ds_read_b64_tr_b16 v[170:171], v22 offset:30784
  buffer_load_dwordx4 v[28:31], v25, s[36:39], s91 offen offset:0 sc1
  v_mfma_f32_16x16x32_bf16 v[80:83], v[156:159], v[184:187], v[80:83]
  ds_read_b64_tr_b16 v[172:173], v21 offset:30816
  ds_read_b64_tr_b16 a[90:91], v22 offset:56384
  ds_read_b64_tr_b16 v[174:175], v22 offset:30816
  s_waitcnt lgkmcnt(6)
  v_mfma_f32_16x16x32_bf16 v[64:67], v[160:163], v[200:203], v[64:67]
  ds_read_b64_tr_b16 v[144:145], v21 offset:30848
  ds_read_b64_tr_b16 a[92:93], v21 offset:56416
  v_mfma_f32_16x16x32_bf16 v[84:87], v[160:163], v[208:211], v[84:87]
  ds_read_b64_tr_b16 v[146:147], v22 offset:30848
  buffer_load_dword v121, v51, s[36:39], s85 offen sc1
  v_mfma_f32_16x16x32_bf16 v[68:71], v[164:167], v[200:203], v[68:71]
  ds_read_b64_tr_b16 v[148:149], v21 offset:40960
  buffer_load_dword v125, v52, s[36:39], s85 offen sc1
  v_mfma_f32_16x16x32_bf16 v[88:91], v[164:167], v[208:211], v[88:91]
  ds_read_b64_tr_b16 v[150:151], v22 offset:40960
  s_waitcnt lgkmcnt(5)
  v_mfma_f32_16x16x32_bf16 v[72:75], v[168:171], v[200:203], v[72:75]
  ds_read_b64_tr_b16 v[152:153], v21 offset:40992
  ds_read_b64_tr_b16 a[94:95], v22 offset:56416
  v_mfma_f32_16x16x32_bf16 v[92:95], v[168:171], v[208:211], v[92:95]
  ds_read_b64_tr_b16 v[154:155], v22 offset:40992
  buffer_load_dword v122, v51, s[36:39], s86 offen sc1
  v_mfma_f32_16x16x32_bf16 v[76:79], v[172:175], v[200:203], v[76:79]
  ds_read_b64_tr_b16 v[156:157], v21 offset:41024
  s_waitcnt vmcnt(7)
  v_mfma_f32_16x16x32_bf16 v[96:99], v[172:175], v[208:211], v[96:99]
  ds_read_b64_tr_b16 v[158:159], v22 offset:41024
  buffer_load_dword v126, v52, s[36:39], s86 offen sc1
  s_waitcnt lgkmcnt(5)
  v_mfma_f32_16x16x32_bf16 v[80:83], v[144:147], v[200:203], v[80:83]
  ds_read_b64_tr_b16 v[160:161], v21 offset:41056
  v_max3_u32 v7, v227, v219, v243
  ds_read_b64_tr_b16 v[162:163], v22 offset:41056
  v_max_u32 v7, v7, v235
  v_cmp_eq_u32 vcc, -1, v7
  ds_read_b64_tr_b16 a[96:97], v21 offset:56448
  buffer_load_dword v123, v51, s[36:39], s87 offen sc1
  buffer_load_dword v127, v52, s[36:39], s87 offen sc1
  s_cbranch_vccnz L_slow_oa4B
L_back_oa4B:
  v_mfma_f32_16x16x32_bf16 v[64:67], v[148:151], v[216:219], v[64:67]
  ds_read_b64_tr_b16 v[164:165], v21 offset:41088
  ds_read_b64_tr_b16 a[98:99], v22 offset:56448
  v_mfma_f32_16x16x32_bf16 v[84:87], v[148:151], v[224:227], v[84:87]
  ds_read_b64_tr_b16 v[166:167], v22 offset:41088
  buffer_load_dword v128, v51, s[36:39], s88 offen sc1
  buffer_load_dword v132, v52, s[36:39], s88 offen sc1
  s_waitcnt lgkmcnt(6)
  v_mfma_f32_16x16x32_bf16 v[68:71], v[152:155], v[216:219], v[68:71]
  ds_read_b64_tr_b16 v[168:169], v21 offset:51200
  ds_read_b64_tr_b16 a[100:101], v23 offset:5120
  v_mfma_f32_16x16x32_bf16 v[88:91], v[152:155], v[224:227], v[88:91]
  ds_read_b64_tr_b16 v[170:171], v22 offset:51200
  buffer_load_dword v129, v51, s[36:39], s89 offen sc1
  buffer_load_dword v133, v52, s[36:39], s89 offen sc1
  v_mfma_f32_16x16x32_bf16 v[72:75], v[156:159], v[216:219], v[72:75]
  ds_read_b64_tr_b16 v[172:173], v21 offset:51232
  ds_read_b64_tr_b16 a[102:103], v24 offset:5120
  v_mfma_f32_16x16x32_bf16 v[92:95], v[156:159], v[224:227], v[92:95]
  ds_read_b64_tr_b16 v[174:175], v22 offset:51232
  buffer_load_dword v130, v51, s[36:39], s90 offen sc1
  buffer_load_dword v134, v52, s[36:39], s90 offen sc1
  s_waitcnt lgkmcnt(6)
  v_mfma_f32_16x16x32_bf16 v[76:79], v[160:163], v[216:219], v[76:79]
  ds_read_b64_tr_b16 v[144:145], v21 offset:51264
  buffer_load_dword v131, v51, s[36:39], s91 offen sc1
  v_mfma_f32_16x16x32_bf16 v[96:99], v[160:163], v[224:227], v[96:99]
  ds_read_b64_tr_b16 v[146:147], v22 offset:51264
  buffer_load_dword v135, v52, s[36:39], s91 offen sc1
  v_mfma_f32_16x16x32_bf16 v[80:83], v[164:167], v[216:219], v[80:83]
  ds_read_b64_tr_b16 v[148:149], v21 offset:51296
  ds_read_b64_tr_b16 a[104:105], v23 offset:5152
  ds_read_b64_tr_b16 v[150:151], v22 offset:51296
  buffer_load_dwordx4 v[140:143], v25, s[36:39], s85 offen offset:1024 sc1
  s_waitcnt lgkmcnt(5)
  v_mfma_f32_16x16x32_bf16 v[64:67], v[168:171], v[232:235], v[64:67]
  ds_read_b64_tr_b16 v[152:153], v21 offset:51328
  ds_read_b64_tr_b16 a[106:107], v24 offset:5152
  v_mfma_f32_16x16x32_bf16 v[84:87], v[168:171], v[240:243], v[84:87]
  ds_read_b64_tr_b16 v[154:155], v22 offset:51328
  ds_read_b64_tr_b16 a[108:109], v23 offset:5184
  v_mfma_f32_16x16x32_bf16 v[68:71], v[172:175], v[232:235], v[68:71]
  ds_read_b64_tr_b16 v[156:157], v23 offset:0
  buffer_load_dwordx4 v[188:191], v25, s[36:39], s86 offen offset:1024 sc1
  v_mfma_f32_16x16x32_bf16 v[88:91], v[172:175], v[240:243], v[88:91]
  ds_read_b64_tr_b16 v[158:159], v24 offset:0
  s_waitcnt lgkmcnt(6)
  v_mfma_f32_16x16x32_bf16 v[72:75], v[144:147], v[232:235], v[72:75]
  ds_read_b64_tr_b16 v[160:161], v23 offset:32
  ds_read_b64_tr_b16 a[110:111], v24 offset:5184
  v_mfma_f32_16x16x32_bf16 v[92:95], v[144:147], v[240:243], v[92:95]
  ds_read_b64_tr_b16 v[162:163], v24 offset:32
  ds_read_b64_tr_b16 a[112:113], v23 offset:5216
  v_mfma_f32_16x16x32_bf16 v[76:79], v[148:151], v[232:235], v[76:79]
  ds_read_b64_tr_b16 v[164:165], v23 offset:64
  s_waitcnt vmcnt(16)
  v_mfma_f32_16x16x32_bf16 v[96:99], v[148:151], v[240:243], v[96:99]
  ds_read_b64_tr_b16 v[166:167], v24 offset:64
  buffer_load_dwordx4 v[204:207], v25, s[36:39], s87 offen offset:1024 sc1
  s_waitcnt lgkmcnt(6)
  v_mfma_f32_16x16x32_bf16 v[80:83], v[152:155], v[232:235], v[80:83]
  ds_read_b64_tr_b16 v[168:169], v23 offset:96
  v_max3_u32 v7, v15, v251, v39
  ds_read_b64_tr_b16 v[170:171], v24 offset:96
  v_max_u32 v7, v7, v31
  v_cmp_eq_u32 vcc, -1, v7
  ds_read_b64_tr_b16 a[114:115], v24 offset:5216
  s_cbranch_vccnz L_slow_oa6B
L_back_oa6B:
  v_mfma_f32_16x16x32_bf16 v[64:67], v[156:159], v[248:251], v[64:67]
  ds_read_b64_tr_b16 v[172:173], v23 offset:128
  buffer_load_dwordx4 v[220:223], v25, s[36:39], s88 offen offset:1024 sc1
  v_mfma_f32_16x16x32_bf16 v[84:87], v[156:159], v[12:15], v[84:87]
  ds_read_b64_tr_b16 v[174:175], v24 offset:128
  s_waitcnt lgkmcnt(5)
  v_mfma_f32_16x16x32_bf16 v[68:71], v[160:163], v[248:251], v[68:71]
  ds_read_b64_tr_b16 v[144:145], v23 offset:10240
  ds_read_b64_tr_b16 a[116:117], v23 offset:5248
  v_mfma_f32_16x16x32_bf16 v[88:91], v[160:163], v[12:15], v[88:91]
  ds_read_b64_tr_b16 v[146:147], v24 offset:10240
  ds_read_b64_tr_b16 a[118:119], v24 offset:5248
  v_mfma_f32_16x16x32_bf16 v[72:75], v[164:167], v[248:251], v[72:75]
  ds_read_b64_tr_b16 v[148:149], v23 offset:10272
  ds_read_b64_tr_b16 a[120:121], v23 offset:15360
  v_mfma_f32_16x16x32_bf16 v[92:95], v[164:167], v[12:15], v[92:95]
  ds_read_b64_tr_b16 v[150:151], v24 offset:10272
  s_waitcnt lgkmcnt(7)
  v_mfma_f32_16x16x32_bf16 v[76:79], v[168:171], v[248:251], v[76:79]
  ds_read_b64_tr_b16 v[152:153], v23 offset:10304
  buffer_load_dwordx4 v[236:239], v25, s[36:39], s89 offen offset:1024 sc1
  v_mfma_f32_16x16x32_bf16 v[96:99], v[168:171], v[12:15], v[96:99]
  ds_read_b64_tr_b16 v[154:155], v24 offset:10304
  ds_read_b64_tr_b16 a[122:123], v24 offset:15360
  v_mfma_f32_16x16x32_bf16 v[80:83], v[172:175], v[248:251], v[80:83]
  ds_read_b64_tr_b16 v[156:157], v23 offset:10336
  ds_read_b64_tr_b16 a[124:125], v23 offset:15392
  ds_read_b64_tr_b16 v[158:159], v24 offset:10336
  s_waitcnt lgkmcnt(6)
  v_mfma_f32_16x16x32_bf16 v[64:67], v[144:147], v[28:31], v[64:67]
  ds_read_b64_tr_b16 v[160:161], v23 offset:10368
  buffer_load_dwordx4 v[252:255], v25, s[36:39], s90 offen offset:1024 sc1
  v_mfma_f32_16x16x32_bf16 v[84:87], v[144:147], v[36:39], v[84:87]
  ds_read_b64_tr_b16 v[162:163], v24 offset:10368
  ds_read_b64_tr_b16 a[126:127], v24 offset:15392
  v_mfma_f32_16x16x32_bf16 v[68:71], v[148:151], v[28:31], v[68:71]
  ds_read_b64_tr_b16 v[164:165], v23 offset:20480
  buffer_load_dwordx4 v[32:35], v25, s[36:39], s91 offen offset:1024 sc1
  v_mfma_f32_16x16x32_bf16 v[88:91], v[148:151], v[36:39], v[88:91]
  ds_read_b64_tr_b16 v[166:167], v24 offset:20480
  s_waitcnt lgkmcnt(5)
  v_mfma_f32_16x16x32_bf16 v[72:75], v[152:155], v[28:31], v[72:75]
  ds_read_b64_tr_b16 v[168:169], v23 offset:20512
  s_waitcnt vmcnt(15)
  v_mfma_f32_16x16x32_bf16 v[92:95], v[152:155], v[36:39], v[92:95]
  ds_read_b64_tr_b16 v[170:171], v24 offset:20512
  v_max3_u32 v7, v121, v125, v122
  v_mfma_f32_16x16x32_bf16 v[76:79], v[156:159], v[28:31], v[76:79]
  ds_read_b64_tr_b16 v[172:173], v23 offset:20544
  v_max3_u32 v7, v7, v126, v123
  v_mfma_f32_16x16x32_bf16 v[96:99], v[156:159], v[36:39], v[96:99]
  ds_read_b64_tr_b16 v[174:175], v24 offset:20544
  ds_read_b64_tr_b16 a[128:129], v23 offset:15424
  s_waitcnt lgkmcnt(5)
  v_mfma_f32_16x16x32_bf16 v[80:83], v[160:163], v[28:31], v[80:83]
  ds_read_b64_tr_b16 v[144:145], v23 offset:20576
  v_max_u32 v7, v7, v127
  ds_read_b64_tr_b16 v[146:147], v24 offset:20576
  v_cmp_eq_u32 vcc, -1, v7
  ds_read_b64_tr_b16 a[130:131], v24 offset:15424
  buffer_load_dwordx4 v[180:183], v26, s[36:39], s85 offen offset:1024 sc1
  s_cbranch_vccnz L_slow_ol0B
L_back_ol0B:
  v_mfma_f32_16x16x32_bf16 v[64:67], v[164:167], v[120:123], v[64:67]
  ds_read_b64_tr_b16 v[148:149], v23 offset:20608
  ds_read_b64_tr_b16 a[132:133], v23 offset:15456
  v_mfma_f32_16x16x32_bf16 v[84:87], v[164:167], v[124:127], v[84:87]
  ds_read_b64_tr_b16 v[150:151], v24 offset:20608
  s_waitcnt lgkmcnt(7)
  v_mfma_f32_16x16x32_bf16 v[68:71], v[168:171], v[120:123], v[68:71]
  ds_read_b64_tr_b16 v[152:153], v23 offset:25600
  ds_read_b64_tr_b16 a[134:135], v24 offset:15456
  v_mfma_f32_16x16x32_bf16 v[88:91], v[168:171], v[124:127], v[88:91]
  ds_read_b64_tr_b16 v[154:155], v24 offset:25600
  ds_read_b64_tr_b16 a[136:137], v23 offset:15488
  v_mfma_f32_16x16x32_bf16 v[72:75], v[172:175], v[120:123], v[72:75]
  ds_read_b64_tr_b16 v[156:157], v23 offset:25632
  s_waitcnt vmcnt(8)
  v_mfma_f32_16x16x32_bf16 v[92:95], v[172:175], v[124:127], v[92:95]
  ds_read_b64_tr_b16 v[158:159], v24 offset:25632
  buffer_load_dwordx4 v[196:199], v26, s[36:39], s86 offen offset:1024 sc1
  s_waitcnt lgkmcnt(6)
  v_mfma_f32_16x16x32_bf16 v[76:79], v[144:147], v[120:123], v[76:79]
  ds_read_b64_tr_b16 v[160:161], v23 offset:25664
  v_max3_u32 v7, v128, v132, v129
  v_mfma_f32_16x16x32_bf16 v[96:99], v[144:147], v[124:127], v[96:99]
  ds_read_b64_tr_b16 v[162:163], v24 offset:25664
  v_max3_u32 v7, v7, v133, v130
  ds_read_b64_tr_b16 a[138:139], v24 offset:15488
  v_mfma_f32_16x16x32_bf16 v[80:83], v[148:151], v[120:123], v[80:83]
  ds_read_b64_tr_b16 v[164:165], v23 offset:25696
  v_max3_u32 v7, v7, v134, v131
  ds_read_b64_tr_b16 v[166:167], v24 offset:25696
  v_max_u32 v7, v7, v135
  v_cmp_eq_u32 vcc, -1, v7
  buffer_load_dwordx4 v[212:215], v26, s[36:39], s87 offen offset:1024 sc1
  s_cbranch_vccnz L_slow_ol1B
L_back_ol1B:
  s_waitcnt lgkmcnt(5)
  v_mfma_f32_16x16x32_bf16 v[64:67], v[152:155], v[128:131], v[64:67]
  ds_read_b64_tr_b16 v[168:169], v23 offset:25728
  buffer_load_dwordx4 v[228:231], v26, s[36:39], s88 offen offset:1024 sc1
  v_mfma_f32_16x16x32_bf16 v[84:87], v[152:155], v[132:135], v[84:87]
  ds_read_b64_tr_b16 v[170:171], v24 offset:25728
  buffer_load_dwordx4 v[244:247], v26, s[36:39], s89 offen offset:1024 sc1
  v_mfma_f32_16x16x32_bf16 v[68:71], v[156:159], v[128:131], v[68:71]
  v_mfma_f32_16x16x32_bf16 v[88:91], v[156:159], v[132:135], v[88:91]
  s_waitcnt lgkmcnt(2)
  v_mfma_f32_16x16x32_bf16 v[72:75], v[160:163], v[128:131], v[72:75]
  v_mfma_f32_16x16x32_bf16 v[92:95], v[160:163], v[132:135], v[92:95]
  v_mfma_f32_16x16x32_bf16 v[76:79], v[164:167], v[128:131], v[76:79]
  s_waitcnt vmcnt(10)
  v_max3_u32 v7, v143, v191, v143
  v_mfma_f32_16x16x32_bf16 v[96:99], v[164:167], v[132:135], v[96:99]
  v_cmp_eq_u32 vcc, -1, v7
  s_waitcnt lgkmcnt(0)
  v_mfma_f32_16x16x32_bf16 v[80:83], v[168:171], v[128:131], v[80:83]
  buffer_load_dwordx4 v[16:19], v26, s[36:39], s90 offen offset:1024 sc1
  s_waitcnt lgkmcnt(0)
  s_cbranch_vccnz L_slow_or00B
L_back_or00B:
  v_mfma_f32_16x16x32_bf16 v[64:67], a[0:3], v[140:143], v[64:67]
  buffer_load_dwordx4 v[40:43], v26, s[36:39], s91 offen offset:1024 sc1
  s_add_u32 s62, s79, 76800
  v_mfma_f32_16x16x32_bf16 v[68:71], a[4:7], v[140:143], v[68:71]
  v_mul_u32_u24 v1, 144, v48
  v_lshl_add_u32 v1, v47, 3, v1
  v_mfma_f32_16x16x32_bf16 v[72:75], a[8:11], v[140:143], v[72:75]
  v_add_u32 v55, s62, v1
  v_lshlrev_b32 v1, 5, v48
  v_mfma_f32_16x16x32_bf16 v[76:79], a[12:15], v[140:143], v[76:79]
  v_lshl_add_u32 v1, v47, 3, v1
  v_mfma_f32_16x16x32_bf16 v[80:83], a[16:19], v[140:143], v[80:83]
  v_add_u32 v56, s62, v1
  v_lshrrev_b32 v1, 3, v0
  v_mfma_f32_16x16x32_bf16 v[64:67], a[20:23], v[188:191], v[64:67]
  v_lshl_add_u32 v2, v1, 4, v46
  v_mfma_f32_16x16x32_bf16 v[68:71], a[24:27], v[188:191], v[68:71]
  s_waitcnt vmcnt(7)
  v_max3_u32 v7, v207, v223, v239
  v_mfma_f32_16x16x32_bf16 v[72:75], a[28:31], v[188:191], v[72:75]
  v_max3_u32 v7, v7, v255, v35
  v_cmp_eq_u32 vcc, -1, v7
  v_mfma_f32_16x16x32_bf16 v[76:79], a[32:35], v[188:191], v[76:79]
  v_add_u32 v57, s62, v2
L_tp5:
  s_cbranch_execz L_tret1
  v_add_u32 v58, s62, v46
  v_mfma_f32_16x16x32_bf16 v[80:83], a[36:39], v[188:191], v[80:83]
  s_cbranch_vccnz L_slow_or02B
L_back_or02B:
  v_mfma_f32_16x16x32_bf16 v[64:67], a[40:43], v[204:207], v[64:67]
  v_mul_u32_u24 v1, 2176, v1
  v_add_u32 v60, v1, v46
  v_mfma_f32_16x16x32_bf16 v[68:71], a[44:47], v[204:207], v[68:71]
  v_lshrrev_b32 v1, 1, v0
  v_mul_u32_u24 v1, 2272, v1
  v_mfma_f32_16x16x32_bf16 v[72:75], a[48:51], v[204:207], v[72:75]
  v_add_u32 v59, v1, v46
  s_and_b32 s63, s54, 1
  v_mfma_f32_16x16x32_bf16 v[76:79], a[52:55], v[204:207], v[76:79]
  s_mul_i32 s63, s63, 36864
  s_add_u32 s62, s94, s63
  v_mfma_f32_16x16x32_bf16 v[80:83], a[56:59], v[204:207], v[80:83]
  s_lshl_b32 s65, s54, 7
  s_add_u32 s44, s62, s65
  v_mfma_f32_16x16x32_bf16 v[64:67], a[60:63], v[220:223], v[64:67]
  s_add_u32 s45, s44, 18432
  v_mfma_f32_16x16x32_bf16 v[68:71], a[64:67], v[220:223], v[68:71]
  s_xor_b32 s63, s63, 36864
  s_add_u32 s63, s63, s94
  v_mfma_f32_16x16x32_bf16 v[72:75], a[68:71], v[220:223], v[72:75]
  s_add_u32 s46, s63, s65
  v_mfma_f32_16x16x32_bf16 v[76:79], a[72:75], v[220:223], v[76:79]
  s_add_u32 s47, s46, 18432
  s_lshr_b32 s65, s54, 1
  v_mfma_f32_16x16x32_bf16 v[80:83], a[76:79], v[220:223], v[80:83]
  s_lshl_b32 s65, s65, 5
  v_mfma_f32_16x16x32_bf16 v[64:67], a[80:83], v[236:239], v[64:67]
  s_add_u32 s65, s65, 1024
  s_add_u32 s62, s62, s65
  v_mfma_f32_16x16x32_bf16 v[68:71], a[84:87], v[236:239], v[68:71]
  v_mfma_f32_16x16x32_bf16 v[72:75], a[88:91], v[236:239], v[72:75]
  v_mfma_f32_16x16x32_bf16 v[76:79], a[92:95], v[236:239], v[76:79]
  v_mfma_f32_16x16x32_bf16 v[80:83], a[96:99], v[236:239], v[80:83]
  v_mfma_f32_16x16x32_bf16 v[64:67], a[100:103], v[252:255], v[64:67]
  v_mfma_f32_16x16x32_bf16 v[68:71], a[104:107], v[252:255], v[68:71]
  v_mfma_f32_16x16x32_bf16 v[72:75], a[108:111], v[252:255], v[72:75]
  v_mfma_f32_16x16x32_bf16 v[76:79], a[112:115], v[252:255], v[76:79]
  v_mfma_f32_16x16x32_bf16 v[80:83], a[116:119], v[252:255], v[80:83]
  v_mfma_f32_16x16x32_bf16 v[64:67], a[120:123], v[32:35], v[64:67]
  s_waitcnt vmcnt(0)
  v_max3_u32 v7, v183, v199, v215
  v_mfma_f32_16x16x32_bf16 v[68:71], a[124:127], v[32:35], v[68:71]
  v_max3_u32 v7, v7, v231, v247
  v_max3_u32 v7, v7, v19, v43
  v_mfma_f32_16x16x32_bf16 v[72:75], a[128:131], v[32:35], v[72:75]
  v_cmp_eq_u32 vcc, -1, v7
  v_mfma_f32_16x16x32_bf16 v[76:79], a[132:135], v[32:35], v[76:79]
  v_mfma_f32_16x16x32_bf16 v[80:83], a[136:139], v[32:35], v[80:83]
  s_cbranch_vccnz L_slow_or10B
L_back_or10B:
  v_mfma_f32_16x16x32_bf16 v[84:87], a[0:3], v[180:183], v[84:87]
  v_cmp_u_f32 vcc, v64, v68
  v_cvt_pk_bf16_f32 v176, v64, v65
  v_cvt_pk_bf16_f32 v177, v66, v67
  v_mfma_f32_16x16x32_bf16 v[88:91], a[4:7], v[180:183], v[88:91]
  v_mfma_f32_16x16x32_bf16 v[92:95], a[8:11], v[180:183], v[92:95]
  s_cbranch_vccnz L_again0B
L_done0B:
  v_mfma_f32_16x16x32_bf16 v[96:99], a[12:15], v[180:183], v[96:99]
  ds_write_b64 v55, v[176:177] offset:0
  v_mfma_f32_16x16x32_bf16 v[84:87], a[20:23], v[196:199], v[84:87]
  v_cvt_pk_bf16_f32 v178, v68, v69
  v_cvt_pk_bf16_f32 v179, v70, v71
  v_mfma_f32_16x16x32_bf16 v[88:91], a[24:27], v[196:199], v[88:91]
  ds_write_b64 v55, v[178:179] offset:32
  v_mfma_f32_16x16x32_bf16 v[92:95], a[28:31], v[196:199], v[92:95]
  v_cvt_pk_bf16_f32 v192, v72, v73
  v_cvt_pk_bf16_f32 v193, v74, v75
  v_mfma_f32_16x16x32_bf16 v[96:99], a[32:35], v[196:199], v[96:99]
  ds_write_b64 v55, v[192:193] offset:64
  v_mfma_f32_16x16x32_bf16 v[84:87], a[40:43], v[212:215], v[84:87]
  v_cvt_pk_bf16_f32 v194, v76, v77
  v_cvt_pk_bf16_f32 v195, v78, v79
  v_mfma_f32_16x16x32_bf16 v[88:91], a[44:47], v[212:215], v[88:91]
  ds_write_b64 v55, v[194:195] offset:96
  v_mfma_f32_16x16x32_bf16 v[92:95], a[48:51], v[212:215], v[92:95]
  v_cvt_pk_bf16_f32 v208, v80, v81
  v_cvt_pk_bf16_f32 v209, v82, v83
  v_mfma_f32_16x16x32_bf16 v[96:99], a[52:55], v[212:215], v[96:99]
  ds_write_b64 v56, v[208:209] offset:4608
  v_mfma_f32_16x16x32_bf16 v[84:87], a[60:63], v[228:231], v[84:87]
  ds_read_b128 v[136:139], v57 offset:0
  ds_read_b128 v[184:187], v57 offset:1152
  v_mfma_f32_16x16x32_bf16 v[88:91], a[64:67], v[228:231], v[88:91]
  ds_read_b128 v[232:235], v58 offset:4608
  v_mfma_f32_16x16x32_bf16 v[92:95], a[68:71], v[228:231], v[92:95]
  v_mfma_f32_16x16x32_bf16 v[96:99], a[72:75], v[228:231], v[96:99]
  v_mfma_f32_16x16x32_bf16 v[84:87], a[80:83], v[244:247], v[84:87]
  v_mfma_f32_16x16x32_bf16 v[88:91], a[84:87], v[244:247], v[88:91]
  v_mfma_f32_16x16x32_bf16 v[92:95], a[88:91], v[244:247], v[92:95]
  s_waitcnt lgkmcnt(0)
  buffer_store_dwordx4 v[136:139], v60, s[40:43], s44 offen nt
  v_mfma_f32_16x16x32_bf16 v[96:99], a[92:95], v[244:247], v[96:99]
  v_mfma_f32_16x16x32_bf16 v[84:87], a[100:103], v[16:19], v[84:87]
  v_mfma_f32_16x16x32_bf16 v[88:91], a[104:107], v[16:19], v[88:91]
  v_mfma_f32_16x16x32_bf16 v[92:95], a[108:111], v[16:19], v[92:95]
  v_mfma_f32_16x16x32_bf16 v[96:99], a[112:115], v[16:19], v[96:99]
  v_mfma_f32_16x16x32_bf16 v[84:87], a[120:123], v[40:43], v[84:87]
  v_mfma_f32_16x16x32_bf16 v[88:91], a[124:127], v[40:43], v[88:91]
  v_mfma_f32_16x16x32_bf16 v[92:95], a[128:131], v[40:43], v[92:95]
  buffer_store_dwordx4 v[184:187], v60, s[40:43], s45 offen nt
  v_mfma_f32_16x16x32_bf16 v[96:99], a[132:135], v[40:43], v[96:99]
  s_nop 4
  v_cmp_u_f32 vcc, v84, v88
  s_cbranch_vccnz L_again1B
L_done1B:
  v_cvt_pk_bf16_f32 v224, v84, v85
  v_cvt_pk_bf16_f32 v225, v86, v87
  ds_write_b64 v55, v[224:225] offset:2304
  v_cvt_pk_bf16_f32 v226, v88, v89
  v_cvt_pk_bf16_f32 v227, v90, v91
  ds_write_b64 v55, v[226:227] offset:2336
  v_cvt_pk_bf16_f32 v240, v92, v93
  v_cvt_pk_bf16_f32 v241, v94, v95
  ds_write_b64 v55, v[240:241] offset:2368
  v_cvt_pk_bf16_f32 v242, v96, v97
  v_cvt_pk_bf16_f32 v243, v98, v99
  ds_write_b64 v55, v[242:243] offset:2400
  ds_read_b128 v[200:203], v57 offset:2304
  ds_read_b128 v[216:219], v57 offset:3456
  s_mov_b32 exec_hi, 0
  buffer_store_dwordx4 v[232:235], v59, s[40:43], s62 offen
  s_mov_b32 exec_hi, -1
  s_waitcnt lgkmcnt(1)
  buffer_store_dwordx4 v[200:203], v60, s[40:43], s46 offen nt
  s_waitcnt lgkmcnt(0)
  buffer_store_dwordx4 v[216:219], v60, s[40:43], s47 offen nt
  s_or_b32 s62, s66, s54
  s_cmp_lg_u32 s62, 0
  s_cbranch_scc1 L_noepB
  v_mov_b32 v1, 3670016
  v_mov_b32 v2, s95
  buffer_store_dword v2, v1, s[36:39], 0 offen
L_noepB:
L_end:
L_notouchB:
  s_endpgm
L_slow_agB:
L_sp_agB:
  buffer_load_dwordx4 v[104:107], v46, s[36:39], s92 offen offset:0 sc1
  buffer_load_dwordx4 v[108:111], v46, s[36:39], s92 offen offset:1024 sc1
  buffer_load_dwordx4 v[112:115], v46, s[36:39], s92 offen offset:2048 sc1
  s_waitcnt vmcnt(0)
  ds_write2_b32 v62, v104, v106 offset0:0 offset1:1
  ds_write2_b32 v62, v108, v110 offset0:160 offset1:161
  ds_write2_b32 v63, v112, v114 offset0:0 offset1:1
  v_xor_b32 v7, s95, v105
  v_bitop3_b32 v7, v7, s95, v107 bitop3:0xf6
  v_bitop3_b32 v7, v7, s95, v109 bitop3:0xf6
  v_bitop3_b32 v7, v7, s95, v111 bitop3:0xf6
  v_bitop3_b32 v7, v7, s95, v113 bitop3:0xf6
  v_bitop3_b32 v7, v7, s95, v115 bitop3:0xf6
  v_cmp_ne_u32 vcc, 0, v7
  s_waitcnt lgkmcnt(0)
  s_add_u32 s72, s72, 1
  s_cmp_gt_u32 s72, 30000
  s_cbranch_scc1 L_back_agB
  s_cbranch_vccnz L_sp_agB
  s_branch L_back_agB
L_slow_rfB:
L_sp_rfB:
  buffer_load_dword v116, v5, s[36:39], s70 offen sc1
  s_waitcnt vmcnt(0)
  v_xor_b32 v7, s49, v116
  v_cmp_lt_u32 vcc, 15, v7
  s_add_u32 s72, s72, 1
  s_cmp_gt_u32 s72, 30000
  s_cbranch_scc1 L_back_rfB
  s_cbranch_vccnz L_sp_rfB
  s_branch L_back_rfB
L_farB:
  buffer_store_dwordx4 v[104:107], v46, s[36:39], s84 offen offset:0 sc1
  buffer_store_dwordx4 v[108:111], v46, s[36:39], s84 offen offset:2048 sc1
  buffer_store_dwordx4 v[112:115], v46, s[36:39], s84 offen offset:1024 sc1
  buffer_store_dwordx4 v[116:119], v46, s[36:39], s84 offen offset:3072 sc1
  buffer_store_dword v120, v54, s[36:39], s84 offen offset:0 sc1
  buffer_store_dword v124, v54, s[36:39], s84 offen offset:256 sc1
  s_waitcnt vmcnt(0)
  buffer_store_dword v8, v9, s[36:39], s70 offen offset:32 sc1
L_farpB:
  buffer_load_dword v7, v5, s[36:39], s70 offen offset:32 sc1
  s_waitcnt vmcnt(0)
  v_xor_b32 v7, s49, v7
  v_cmp_lt_u32 vcc, 15, v7
  s_add_u32 s72, s72, 1
  s_cmp_gt_u32 s72, 30000
  s_cbranch_scc1 L_nearB
  s_cbranch_vccnz L_farpB
  s_branch L_nearB
L_slow_oa1B:
L_sp_oa1B:
  buffer_load_dwordx4 v[176:179], v26, s[36:39], s85 offen offset:0 sc1
  buffer_load_dwordx4 v[136:139], v25, s[36:39], s85 offen offset:0 sc1
  s_waitcnt vmcnt(0)
  v_max3_u32 v7, v179, v139, v179
  v_cmp_eq_u32 vcc, -1, v7
  s_add_u32 s72, s72, 1
  s_cmp_gt_u32 s72, 30000
  s_cbranch_scc1 L_back_oa1B
  s_cbranch_vccnz L_sp_oa1B
  s_branch L_back_oa1B
L_slow_oa2B:
L_sp_oa2B:
  buffer_load_dwordx4 v[192:195], v26, s[36:39], s86 offen offset:0 sc1
  buffer_load_dwordx4 v[184:187], v25, s[36:39], s86 offen offset:0 sc1
  buffer_load_dwordx4 v[208:211], v26, s[36:39], s87 offen offset:0 sc1
  buffer_load_dwordx4 v[200:203], v25, s[36:39], s87 offen offset:0 sc1
  s_waitcnt vmcnt(0)
  v_max3_u32 v7, v195, v187, v211
  v_max_u32 v7, v7, v203
  v_cmp_eq_u32 vcc, -1, v7
  s_add_u32 s72, s72, 1
  s_cmp_gt_u32 s72, 30000
  s_cbranch_scc1 L_back_oa2B
  s_cbranch_vccnz L_sp_oa2B
  s_branch L_back_oa2B
L_slow_oa4B:
L_sp_oa4B:
  buffer_load_dwordx4 v[224:227], v26, s[36:39], s88 offen offset:0 sc1
  buffer_load_dwordx4 v[216:219], v25, s[36:39], s88 offen offset:0 sc1
  buffer_load_dwordx4 v[240:243], v26, s[36:39], s89 offen offset:0 sc1
  buffer_load_dwordx4 v[232:235], v25, s[36:39], s89 offen offset:0 sc1
  s_waitcnt vmcnt(0)
  v_max3_u32 v7, v227, v219, v243
  v_max_u32 v7, v7, v235
  v_cmp_eq_u32 vcc, -1, v7
  s_add_u32 s72, s72, 1
  s_cmp_gt_u32 s72, 30000
  s_cbranch_scc1 L_back_oa4B
  s_cbranch_vccnz L_sp_oa4B
  s_branch L_back_oa4B
L_slow_oa6B:
L_sp_oa6B:
  buffer_load_dwordx4 v[12:15], v26, s[36:39], s90 offen offset:0 sc1
  buffer_load_dwordx4 v[248:251], v25, s[36:39], s90 offen offset:0 sc1
  buffer_load_dwordx4 v[36:39], v26, s[36:39], s91 offen offset:0 sc1
  buffer_load_dwordx4 v[28:31], v25, s[36:39], s91 offen offset:0 sc1
  s_waitcnt vmcnt(0)
  v_max3_u32 v7, v15, v251, v39
  v_max_u32 v7, v7, v31
  v_cmp_eq_u32 vcc, -1, v7
  s_add_u32 s72, s72, 1
  s_cmp_gt_u32 s72, 30000
  s_cbranch_scc1 L_back_oa6B
  s_cbranch_vccnz L_sp_oa6B
  s_branch L_back_oa6B
L_slow_ol0B:
L_sp_ol0B:
  buffer_load_dword v121, v51, s[36:39], s85 offen sc1
  buffer_load_dword v125, v52, s[36:39], s85 offen sc1
  buffer_load_dword v122, v51, s[36:39], s86 offen sc1
  buffer_load_dword v126, v52, s[36:39], s86 offen sc1
  buffer_load_dword v123, v51, s[36:39], s87 offen sc1
  buffer_load_dword v127, v52, s[36:39], s87 offen sc1
  s_waitcnt vmcnt(0)
  v_max3_u32 v7, v121, v125, v122
  v_max3_u32 v7, v7, v126, v123
  v_max_u32 v7, v7, v127
  v_cmp_eq_u32 vcc, -1, v7
  s_add_u32 s72, s72, 1
  s_cmp_gt_u32 s72, 30000
  s_cbranch_scc1 L_back_ol0B
  s_cbranch_vccnz L_sp_ol0B
  s_branch L_back_ol0B
L_slow_ol1B:
L_sp_ol1B:
  buffer_load_dword v128, v51, s[36:39], s88 offen sc1
  buffer_load_dword v132, v52, s[36:39], s88 offen sc1
  buffer_load_dword v129, v51, s[36:39], s89 offen sc1
  buffer_load_dword v133, v52, s[36:39], s89 offen sc1
  buffer_load_dword v130, v51, s[36:39], s90 offen sc1
  buffer_load_dword v134, v52, s[36:39], s90 offen sc1
  buffer_load_dword v131, v51, s[36:39], s91 offen sc1
  buffer_load_dword v135, v52, s[36:39], s91 offen sc1
  s_waitcnt vmcnt(0)
  v_max3_u32 v7, v128, v132, v129
  v_max3_u32 v7, v7, v133, v130
  v_max3_u32 v7, v7, v134, v131
  v_max_u32 v7, v7, v135
  v_cmp_eq_u32 vcc, -1, v7
  s_add_u32 s72, s72, 1
  s_cmp_gt_u32 s72, 30000
  s_cbranch_scc1 L_back_ol1B
  s_cbranch_vccnz L_sp_ol1B
  s_branch L_back_ol1B
L_slow_or00B:
L_sp_or00B:
  buffer_load_dwordx4 v[140:143], v25, s[36:39], s85 offen offset:1024 sc1
  buffer_load_dwordx4 v[188:191], v25, s[36:39], s86 offen offset:1024 sc1
  s_waitcnt vmcnt(0)
  v_max3_u32 v7, v143, v191, v143
  v_cmp_eq_u32 vcc, -1, v7
  s_add_u32 s72, s72, 1
  s_cmp_gt_u32 s72, 30000
  s_cbranch_scc1 L_back_or00B
  s_cbranch_vccnz L_sp_or00B
  s_branch L_back_or00B
L_slow_or02B:
L_sp_or02B:
  buffer_load_dwordx4 v[204:207], v25, s[36:39], s87 offen offset:1024 sc1
  buffer_load_dwordx4 v[220:223], v25, s[36:39], s88 offen offset:1024 sc1
  buffer_load_dwordx4 v[236:239], v25, s[36:39], s89 offen offset:1024 sc1
  buffer_load_dwordx4 v[252:255], v25, s[36:39], s90 offen offset:1024 sc1
  buffer_load_dwordx4 v[32:35], v25, s[36:39], s91 offen offset:1024 sc1
  s_waitcnt vmcnt(0)
  v_max3_u32 v7, v207, v223, v239
  v_max3_u32 v7, v7, v255, v35
  v_cmp_eq_u32 vcc, -1, v7
  s_add_u32 s72, s72, 1
  s_cmp_gt_u32 s72, 30000
  s_cbranch_scc1 L_back_or02B
  s_cbranch_vccnz L_sp_or02B
  s_branch L_back_or02B
L_slow_or10B:
L_sp_or10B:
  buffer_load_dwordx4 v[180:183], v26, s[36:39], s85 offen offset:1024 sc1
  buffer_load_dwordx4 v[196:199], v26, s[36:39], s86 offen offset:1024 sc1
  buffer_load_dwordx4 v[212:215], v26, s[36:39], s87 offen offset:1024 sc1
  buffer_load_dwordx4 v[228:231], v26, s[36:39], s88 offen offset:1024 sc1
  buffer_load_dwordx4 v[244:247], v26, s[36:39], s89 offen offset:1024 sc1
  buffer_load_dwordx4 v[16:19], v26, s[36:39], s90 offen offset:1024 sc1
  buffer_load_dwordx4 v[40:43], v26, s[36:39], s91 offen offset:1024 sc1
  s_waitcnt vmcnt(0)
  v_max3_u32 v7, v183, v199, v215
  v_max3_u32 v7, v7, v231, v247
  v_max3_u32 v7, v7, v19, v43
  v_cmp_eq_u32 vcc, -1, v7
  s_add_u32 s72, s72, 1
  s_cmp_gt_u32 s72, 30000
  s_cbranch_scc1 L_back_or10B
  s_cbranch_vccnz L_sp_or10B
  s_branch L_back_or10B
L_again0B:
  s_add_u32 s64, s64, 1
  s_cmp_gt_u32 s64, 16
  s_cbranch_scc1 L_done0B
  s_waitcnt vmcnt(0) lgkmcnt(0)
  s_nop 7
  s_branch L_redoB
L_again1B:
  s_add_u32 s64, s64, 1
  s_cmp_gt_u32 s64, 16
  s_cbranch_scc1 L_done1B
  s_waitcnt vmcnt(0) lgkmcnt(0)
  s_nop 7
  s_branch L_redoB
.p2align 7
L_dotouch:
L_tailA:
L_tp6:
  s_cbranch_execz L_tret0
  s_nop 7
  s_add_u32 m0, s80, 141312
  s_mov_b32 exec_hi, 0
  buffer_load_dwordx4 v31, s[28:31], s56 offen lds
  s_mov_b32 exec_hi, -1
  v_cvt_pk_bf16_f32 v104, v104, v105
  v_cvt_pk_bf16_f32 v105, v106, v107
  v_cvt_pk_bf16_f32 v106, v124, v125
  v_cvt_pk_bf16_f32 v107, v126, v127
  v_cvt_pk_bf16_f32 v108, v108, v109
  v_cvt_pk_bf16_f32 v109, v110, v111
  v_cvt_pk_bf16_f32 v110, v128, v129
  v_cvt_pk_bf16_f32 v111, v130, v131
  v_cvt_pk_bf16_f32 v112, v112, v113
  v_cvt_pk_bf16_f32 v113, v114, v115
  v_cvt_pk_bf16_f32 v114, v132, v133
  v_cvt_pk_bf16_f32 v115, v134, v135
  buffer_load_dwordx4 v32, s[28:31], s56 offen offset:512 lds
  v_cvt_pk_bf16_f32 v116, v116, v117
  v_cvt_pk_bf16_f32 v117, v118, v119
  v_cvt_pk_bf16_f32 v118, v136, v137
  v_cvt_pk_bf16_f32 v119, v138, v139
  v_mov_b32 v1, s82
  s_mov_b32 s72, 0
  v_add_u32 v21, 55296, v21
  v_add_u32 v22, 55296, v22
  v_add_u32 v23, 55296, v23
  v_add_u32 v24, 55296, v24
  v_add_u32 v25, 55296, v25
  v_add_u32 v26, 55296, v26
  v_pk_mul_f32 v[144:145], v[64:65], s[74:75]
  v_pk_mul_f32 v[146:147], v[66:67], s[74:75]
  buffer_load_dwordx4 v33, s[28:31], s56 offen offset:1536 lds
  v_pk_mul_f32 v[148:149], v[68:69], s[74:75]
  v_pk_mul_f32 v[150:151], v[70:71], s[74:75]
  v_pk_mul_f32 v[152:153], v[72:73], s[74:75]
  v_pk_mul_f32 v[154:155], v[74:75], s[74:75]
  v_pk_mul_f32 v[156:157], v[76:77], s[74:75]
  v_pk_mul_f32 v[158:159], v[78:79], s[74:75]
  ds_write_b128 v56, v[104:107] offset:0
  v_pk_mul_f32 v[160:161], v[80:81], s[74:75]
  v_exp_f32 v144, v144 clamp
  v_max_f32 v64, 0, v64
  v_exp_f32 v145, v145 clamp
  v_max_f32 v65, 0, v65
  v_pk_add_f32 v[64:65], v[64:65], s[76:77]
  v_pk_add_f32 v[64:65], v[64:65], v[144:145]
  buffer_load_dwordx4 v34, s[28:31], s56 offen offset:2560 lds
  v_cvt_pk_bf16_f32 v176, v64, v65
  v_exp_f32 v146, v146 clamp
  v_max_f32 v66, 0, v66
  v_exp_f32 v147, v147 clamp
  v_max_f32 v67, 0, v67
  v_pk_add_f32 v[66:67], v[66:67], s[76:77]
  v_pk_add_f32 v[66:67], v[66:67], v[146:147]
  ds_write_b128 v56, v[108:111] offset:1024
  v_cvt_pk_bf16_f32 v177, v66, v67
  v_exp_f32 v148, v148 clamp
  v_max_f32 v68, 0, v68
  v_exp_f32 v149, v149 clamp
  v_max_f32 v69, 0, v69
  v_pk_add_f32 v[68:69], v[68:69], s[76:77]
  v_pk_add_f32 v[68:69], v[68:69], v[148:149]
  buffer_load_dwordx4 v35, s[28:31], s56 offen offset:3584 lds
  s_add_u32 s56, s56, 442368
  s_cmp_ge_u32 s56, s50
  s_cselect_b32 s62, 1990656, 0
  s_sub_u32 s56, s56, s62
  v_cvt_pk_bf16_f32 v178, v68, v69
  v_exp_f32 v150, v150 clamp
  v_max_f32 v70, 0, v70
  v_exp_f32 v151, v151 clamp
  v_max_f32 v71, 0, v71
  v_pk_add_f32 v[70:71], v[70:71], s[76:77]
  v_pk_add_f32 v[70:71], v[70:71], v[150:151]
  s_add_u32 m0, s80, 76800
  s_mov_b32 exec_hi, 0
  buffer_load_dwordx4 v31, s[28:31], s56 offen lds
  s_mov_b32 exec_hi, -1
  v_cvt_pk_bf16_f32 v179, v70, v71
  ds_write_b128 v55, v[176:179] offset:0
  v_exp_f32 v152, v152 clamp
  v_max_f32 v72, 0, v72
  v_exp_f32 v153, v153 clamp
  v_max_f32 v73, 0, v73
  v_pk_add_f32 v[72:73], v[72:73], s[76:77]
  v_pk_add_f32 v[72:73], v[72:73], v[152:153]
  ds_write_b128 v56, v[112:115] offset:2048
  v_cvt_pk_bf16_f32 v180, v72, v73
  v_exp_f32 v154, v154 clamp
  v_max_f32 v74, 0, v74
  v_exp_f32 v155, v155 clamp
  v_max_f32 v75, 0, v75
  v_pk_add_f32 v[74:75], v[74:75], s[76:77]
  v_pk_add_f32 v[74:75], v[74:75], v[154:155]
  buffer_load_dwordx4 v32, s[28:31], s56 offen offset:512 lds
  v_cvt_pk_bf16_f32 v181, v74, v75
  v_exp_f32 v156, v156 clamp
  v_max_f32 v76, 0, v76
  v_exp_f32 v157, v157 clamp
  v_max_f32 v77, 0, v77
  v_pk_add_f32 v[76:77], v[76:77], s[76:77]
  v_pk_add_f32 v[76:77], v[76:77], v[156:157]
  ds_write_b128 v56, v[116:119] offset:3072
  v_cvt_pk_bf16_f32 v182, v76, v77
  v_exp_f32 v158, v158 clamp
  v_max_f32 v78, 0, v78
  v_exp_f32 v159, v159 clamp
  v_max_f32 v79, 0, v79
  v_pk_add_f32 v[78:79], v[78:79], s[76:77]
  v_pk_add_f32 v[78:79], v[78:79], v[158:159]
  buffer_load_dwordx4 v33, s[28:31], s56 offen offset:1536 lds
  v_cvt_pk_bf16_f32 v183, v78, v79
  ds_write_b128 v55, v[180:183] offset:16
  v_exp_f32 v160, v160 clamp
  v_max_f32 v80, 0, v80
  v_exp_f32 v161, v161 clamp
  v_max_f32 v81, 0, v81
  v_pk_add_f32 v[80:81], v[80:81], s[76:77]
  v_pk_add_f32 v[80:81], v[80:81], v[160:161]
  v_cvt_pk_bf16_f32 v184, v80, v81
  ds_write_b128 v55, v[184:187] offset:32
  v_pk_mul_f32 v[144:145], v[84:85], s[74:75]
  buffer_load_dwordx4 v34, s[28:31], s56 offen offset:2560 lds
  v_pk_mul_f32 v[146:147], v[86:87], s[74:75]
  v_pk_mul_f32 v[148:149], v[88:89], s[74:75]
  v_pk_mul_f32 v[150:151], v[90:91], s[74:75]
  v_pk_mul_f32 v[152:153], v[92:93], s[74:75]
  buffer_load_dwordx4 v35, s[28:31], s56 offen offset:3584 lds
  s_add_u32 s56, s56, 442368
  s_cmp_ge_u32 s56, s50
  s_cselect_b32 s62, 1990656, 0
  s_sub_u32 s56, s56, s62
  v_pk_mul_f32 v[154:155], v[94:95], s[74:75]
  v_pk_mul_f32 v[156:157], v[96:97], s[74:75]
  v_pk_mul_f32 v[158:159], v[98:99], s[74:75]
  v_pk_mul_f32 v[160:161], v[100:101], s[74:75]
  v_exp_f32 v144, v144 clamp
  s_add_u32 s56, s56, s21
  v_max_f32 v84, 0, v84
  v_exp_f32 v145, v145 clamp
  v_max_f32 v85, 0, v85
  v_pk_add_f32 v[84:85], v[84:85], s[76:77]
  v_pk_add_f32 v[84:85], v[84:85], v[144:145]
  s_add_u32 m0, s20, 95232
  s_mov_b32 exec_hi, 0
  buffer_load_dwordx4 v31, s[28:31], s56 offen lds
  s_mov_b32 exec_hi, -1
  v_cvt_pk_bf16_f32 v188, v84, v85
  v_exp_f32 v146, v146 clamp
  v_max_f32 v86, 0, v86
  v_exp_f32 v147, v147 clamp
  v_max_f32 v87, 0, v87
  buffer_load_dwordx4 v32, s[28:31], s56 offen offset:512 lds
  v_pk_add_f32 v[86:87], v[86:87], s[76:77]
  v_pk_add_f32 v[86:87], v[86:87], v[146:147]
  v_cvt_pk_bf16_f32 v189, v86, v87
  v_exp_f32 v148, v148 clamp
  v_max_f32 v88, 0, v88
  buffer_load_dwordx4 v33, s[28:31], s56 offen offset:1536 lds
  v_exp_f32 v149, v149 clamp
  v_max_f32 v89, 0, v89
  v_pk_add_f32 v[88:89], v[88:89], s[76:77]
  v_pk_add_f32 v[88:89], v[88:89], v[148:149]
  v_cvt_pk_bf16_f32 v190, v88, v89
  buffer_load_dwordx4 v34, s[28:31], s56 offen offset:2560 lds
  v_exp_f32 v150, v150 clamp
  v_max_f32 v90, 0, v90
  v_exp_f32 v151, v151 clamp
  v_max_f32 v91, 0, v91
  v_pk_add_f32 v[90:91], v[90:91], s[76:77]
  buffer_load_dwordx4 v35, s[28:31], s56 offen offset:3584 lds
  v_pk_add_f32 v[90:91], v[90:91], v[150:151]
  v_cvt_pk_bf16_f32 v191, v90, v91
  ds_write_b128 v55, v[188:191] offset:1280
  v_exp_f32 v152, v152 clamp
  v_max_f32 v92, 0, v92
  buffer_store_dwordx4 v[244:247], v46, s[36:39], s84 offen offset:0 sc1
  v_exp_f32 v153, v153 clamp
  v_max_f32 v93, 0, v93
  v_pk_add_f32 v[92:93], v[92:93], s[76:77]
  v_pk_add_f32 v[92:93], v[92:93], v[152:153]
  v_cvt_pk_bf16_f32 v192, v92, v93
  buffer_store_dwordx4 v[244:247], v46, s[36:39], s84 offen offset:1024 sc1
  v_exp_f32 v154, v154 clamp
  v_max_f32 v94, 0, v94
  v_exp_f32 v155, v155 clamp
  v_max_f32 v95, 0, v95
  v_pk_add_f32 v[94:95], v[94:95], s[76:77]
  buffer_store_dwordx4 v[244:247], v46, s[36:39], s84 offen offset:2048 sc1
  v_pk_add_f32 v[94:95], v[94:95], v[154:155]
  v_cvt_pk_bf16_f32 v193, v94, v95
  v_exp_f32 v156, v156 clamp
  v_max_f32 v96, 0, v96
  v_exp_f32 v157, v157 clamp
  buffer_store_dwordx4 v[244:247], v46, s[36:39], s84 offen offset:3072 sc1
  v_max_f32 v97, 0, v97
  v_pk_add_f32 v[96:97], v[96:97], s[76:77]
  v_pk_add_f32 v[96:97], v[96:97], v[156:157]
  v_cvt_pk_bf16_f32 v194, v96, v97
  v_exp_f32 v158, v158 clamp
  buffer_store_dword v244, v54, s[36:39], s84 offen offset:0 sc1
  v_max_f32 v98, 0, v98
  v_exp_f32 v159, v159 clamp
  v_max_f32 v99, 0, v99
  v_pk_add_f32 v[98:99], v[98:99], s[76:77]
  v_pk_add_f32 v[98:99], v[98:99], v[158:159]
  buffer_store_dword v244, v54, s[36:39], s84 offen offset:256 sc1
  v_cvt_pk_bf16_f32 v195, v98, v99
  ds_write_b128 v55, v[192:195] offset:1296
  v_exp_f32 v160, v160 clamp
  v_max_f32 v100, 0, v100
  v_exp_f32 v161, v161 clamp
  v_max_f32 v101, 0, v101
  v_pk_add_f32 v[100:101], v[100:101], s[76:77]
  v_pk_add_f32 v[100:101], v[100:101], v[160:161]
  v_cvt_pk_bf16_f32 v196, v100, v101
  ds_write_b128 v55, v[196:199] offset:1312
  s_waitcnt vmcnt(16) lgkmcnt(0)
  s_barrier
  s_nop 0
  ds_read_b128 a[204:207], v57 offset:0
  ds_read_b64_tr_b16 v[144:145], v51 offset:0
  ds_read_b64_tr_b16 v[146:147], v51 offset:1280
  ds_read_b64_tr_b16 a[208:209], v52 offset:40
  ds_read_b64_tr_b16 a[210:211], v52 offset:1320
  ds_read_b128 a[212:215], v57 offset:5120
  ds_read_b64_tr_b16 v[148:149], v51 offset:2560
  ds_read_b64_tr_b16 v[150:151], v51 offset:3840
  ds_read_b64_tr_b16 a[216:217], v52 offset:2600
  ds_read_b64_tr_b16 a[218:219], v52 offset:3880
  ds_read_b128 a[220:223], v57 offset:10240
  ds_read_b64_tr_b16 v[152:153], v51 offset:5120
  ds_read_b64_tr_b16 v[154:155], v51 offset:6400
  ds_read_b64_tr_b16 a[224:225], v52 offset:5160
  ds_read_b64_tr_b16 a[226:227], v52 offset:6440
  s_waitcnt lgkmcnt(10)
  v_mfma_f32_16x16x32_bf16 v[104:107], a[204:207], v[144:147], 0
  ds_read_b128 a[228:231], v57 offset:15360
  ds_read_b64_tr_b16 v[156:157], v51 offset:7680
  ds_read_b64_tr_b16 v[158:159], v51 offset:8960
  v_mfma_f32_16x16x32_bf16 v[116:119], a[208:211], v[144:147], 0
  ds_read_b64_tr_b16 a[232:233], v52 offset:7720
  ds_read_b64_tr_b16 a[234:235], v52 offset:9000
  s_waitcnt lgkmcnt(10)
  v_mfma_f32_16x16x32_bf16 v[104:107], a[212:215], v[148:151], v[104:107]
  ds_read_b64_tr_b16 v[160:161], v52 offset:32
  v_mfma_f32_16x16x32_bf16 v[116:119], a[216:219], v[148:151], v[116:119]
  ds_read_b64_tr_b16 v[162:163], v52 offset:1312
  s_waitcnt lgkmcnt(7)
  v_mfma_f32_16x16x32_bf16 v[104:107], a[220:223], v[152:155], v[104:107]
  ds_read_b64_tr_b16 v[164:165], v52 offset:2592
  v_mfma_f32_16x16x32_bf16 v[116:119], a[224:227], v[152:155], v[116:119]
  ds_read_b64_tr_b16 v[166:167], v52 offset:3872
  s_waitcnt lgkmcnt(4)
  v_mfma_f32_16x16x32_bf16 v[104:107], a[228:231], v[156:159], v[104:107]
  ds_read_b64_tr_b16 v[168:169], v52 offset:5152
  v_mfma_f32_16x16x32_bf16 v[116:119], a[232:235], v[156:159], v[116:119]
  ds_read_b64_tr_b16 v[170:171], v52 offset:6432
  s_waitcnt lgkmcnt(4)
  v_mfma_f32_16x16x32_bf16 v[112:115], a[204:207], v[160:163], 0
  ds_read_b64_tr_b16 v[172:173], v52 offset:7712
  v_mfma_f32_16x16x32_bf16 v[124:127], a[208:211], v[160:163], 0
  ds_read_b64_tr_b16 v[174:175], v52 offset:8992
  s_waitcnt lgkmcnt(4)
  v_mfma_f32_16x16x32_bf16 v[112:115], a[212:215], v[164:167], v[112:115]
  v_and_or_b32 v104, v104, s83, v1
  v_and_or_b32 v105, v105, s83, v1
  v_mfma_f32_16x16x32_bf16 v[124:127], a[216:219], v[164:167], v[124:127]
  v_and_or_b32 v106, v106, s83, v1
  s_waitcnt lgkmcnt(2)
  v_mfma_f32_16x16x32_bf16 v[112:115], a[220:223], v[168:171], v[112:115]
  v_and_or_b32 v107, v107, s83, v1
  buffer_store_dwordx4 v[104:107], v59, s[36:39], s68 offen sc1
  v_mfma_f32_16x16x32_bf16 v[124:127], a[224:227], v[168:171], v[124:127]
  s_add_u32 s63, s68, 20480
  s_waitcnt lgkmcnt(0)
  v_mfma_f32_16x16x32_bf16 v[112:115], a[228:231], v[172:175], v[112:115]
  v_and_or_b32 v116, v116, s83, v1
  v_and_or_b32 v117, v117, s83, v1
  v_mfma_f32_16x16x32_bf16 v[124:127], a[232:235], v[172:175], v[124:127]
  v_and_or_b32 v118, v118, s83, v1
  v_and_or_b32 v119, v119, s83, v1
  buffer_store_dwordx4 v[116:119], v61, s[36:39], s63 offen sc1
  ds_read_b64_tr_b16 v[144:145], v21 offset:0
  ds_read_b64_tr_b16 v[146:147], v22 offset:0
L_tp7:
  s_cbranch_execz L_tret0
  s_nop 0
  ds_read_b64_tr_b16 v[148:149], v21 offset:8
  ds_read_b64_tr_b16 v[150:151], v22 offset:8
  ds_read_b64_tr_b16 v[152:153], v21 offset:16
  ds_read_b64_tr_b16 v[154:155], v22 offset:16
  ds_read_b64_tr_b16 v[156:157], v23 offset:0
  ds_read_b64_tr_b16 v[158:159], v24 offset:0
  s_add_u32 s63, s68, 16384
  v_and_or_b32 v112, v112, s83, v1
  v_and_or_b32 v113, v113, s83, v1
  v_and_or_b32 v114, v114, s83, v1
  v_and_or_b32 v115, v115, s83, v1
  buffer_store_dwordx4 v[112:115], v60, s[36:39], s63 offen sc1
  s_add_u32 s63, s68, 24576
  v_and_or_b32 v124, v124, s83, v1
  v_and_or_b32 v125, v125, s83, v1
  v_and_or_b32 v126, v126, s83, v1
  v_and_or_b32 v127, v127, s83, v1
  buffer_store_dwordx4 v[124:127], v61, s[36:39], s63 offen sc1
  s_waitcnt lgkmcnt(4)
  v_mfma_f32_16x16x32_bf16 v[64:67], v[144:147], a[0:3], 0
  ds_read_b64_tr_b16 v[160:161], v25 offset:0
  v_mfma_f32_16x16x32_bf16 v[84:87], v[144:147], a[4:7], 0
  ds_read_b64_tr_b16 v[162:163], v26 offset:0
  s_barrier
  v_mfma_f32_16x16x32_bf16 v[68:71], v[148:151], a[0:3], 0
  ds_read_b64_tr_b16 v[164:165], v21 offset:144
  s_min_u32 s45, s55, 2
  v_mfma_f32_16x16x32_bf16 v[88:91], v[148:151], a[4:7], 0
  ds_read_b64_tr_b16 v[166:167], v22 offset:144
  s_waitcnt lgkmcnt(4)
  v_mfma_f32_16x16x32_bf16 v[72:75], v[152:155], a[0:3], 0
  ds_read_b64_tr_b16 v[168:169], v21 offset:152
  s_mul_i32 s46, s53, 3
  v_mfma_f32_16x16x32_bf16 v[92:95], v[152:155], a[4:7], 0
  ds_read_b64_tr_b16 v[170:171], v22 offset:152
  s_add_u32 s45, s45, s46
  v_mfma_f32_16x16x32_bf16 v[76:79], v[156:159], a[0:3], 0
  ds_read_b64_tr_b16 v[172:173], v21 offset:160
  s_mul_i32 s46, s54, 196608
  v_mfma_f32_16x16x32_bf16 v[96:99], v[156:159], a[4:7], 0
  ds_read_b64_tr_b16 v[174:175], v22 offset:160
  s_waitcnt lgkmcnt(4)
  v_mfma_f32_16x16x32_bf16 v[80:83], v[160:163], a[0:3], 0
  ds_read_b64_tr_b16 v[144:145], v23 offset:144
  s_bfe_u32 s81, s51, 262144
  s_mul_i32 s81, s81, 82944
  s_add_u32 s81, s81, s93
  s_add_u32 m0, s79, 0
  v_mfma_f32_16x16x32_bf16 v[100:103], v[160:163], a[4:7], 0
  ds_read_b64_tr_b16 v[146:147], v24 offset:144
  s_lshl_b32 s22, s45, 12
  v_mfma_f32_16x16x32_bf16 v[64:67], v[164:167], a[8:11], v[64:67]
  ds_read_b64_tr_b16 v[148:149], v25 offset:144
  s_add_u32 s22, s22, s46
  v_mfma_f32_16x16x32_bf16 v[84:87], v[164:167], a[12:15], v[84:87]
  ds_read_b64_tr_b16 v[150:151], v26 offset:144
  s_waitcnt lgkmcnt(4)
  v_mfma_f32_16x16x32_bf16 v[68:71], v[168:171], a[8:11], v[68:71]
  ds_read_b64_tr_b16 v[152:153], v21 offset:9216
  s_lshl_b32 s46, s54, 14
  v_mfma_f32_16x16x32_bf16 v[88:91], v[168:171], a[12:15], v[88:91]
  ds_read_b64_tr_b16 v[154:155], v22 offset:9216
  s_lshl_b32 s45, s45, 8
  v_mfma_f32_16x16x32_bf16 v[72:75], v[172:175], a[8:11], v[72:75]
  ds_read_b64_tr_b16 v[156:157], v21 offset:9224
  buffer_load_dwordx4 v36, s[32:35], s81 offen offset:0 lds
  v_mfma_f32_16x16x32_bf16 v[92:95], v[172:175], a[12:15], v[92:95]
  ds_read_b64_tr_b16 v[158:159], v22 offset:9224
  s_waitcnt lgkmcnt(4)
  v_mfma_f32_16x16x32_bf16 v[76:79], v[144:147], a[8:11], v[76:79]
  ds_read_b64_tr_b16 v[160:161], v21 offset:9232
  s_add_u32 s45, s45, s46
  v_mfma_f32_16x16x32_bf16 v[96:99], v[144:147], a[12:15], v[96:99]
  ds_read_b64_tr_b16 v[162:163], v22 offset:9232
  s_add_u32 s23, s45, 3145728
  v_mfma_f32_16x16x32_bf16 v[80:83], v[148:151], a[8:11], v[80:83]
  ds_read_b64_tr_b16 v[164:165], v23 offset:9216
  s_add_u32 s45, s55, 1
  v_mfma_f32_16x16x32_bf16 v[100:103], v[148:151], a[12:15], v[100:103]
  ds_read_b64_tr_b16 v[166:167], v24 offset:9216
  s_waitcnt lgkmcnt(4)
  v_mfma_f32_16x16x32_bf16 v[64:67], v[152:155], a[16:19], v[64:67]
  ds_read_b64_tr_b16 v[168:169], v25 offset:9216
  s_lshr_b32 s45, s45, 2
  v_mfma_f32_16x16x32_bf16 v[84:87], v[152:155], a[20:23], v[84:87]
  ds_read_b64_tr_b16 v[170:171], v26 offset:9216
  s_lshl_b32 s45, s45, 30
  v_mfma_f32_16x16x32_bf16 v[68:71], v[156:159], a[16:19], v[68:71]
  ds_read_b64_tr_b16 v[172:173], v21 offset:9360
  s_add_u32 s23, s23, s45
  v_mfma_f32_16x16x32_bf16 v[88:91], v[156:159], a[20:23], v[88:91]
  ds_read_b64_tr_b16 v[174:175], v22 offset:9360
  s_waitcnt lgkmcnt(4)
  v_mfma_f32_16x16x32_bf16 v[72:75], v[160:163], a[16:19], v[72:75]
  ds_read_b64_tr_b16 v[144:145], v21 offset:9368
  buffer_load_dwordx4 v37, s[32:35], s81 offen offset:1024 lds
  v_mfma_f32_16x16x32_bf16 v[92:95], v[160:163], a[20:23], v[92:95]
  ds_read_b64_tr_b16 v[146:147], v22 offset:9368
  v_lshl_add_u32 v2, v47, 3, v251
  v_mfma_f32_16x16x32_bf16 v[76:79], v[164:167], a[16:19], v[76:79]
  ds_read_b64_tr_b16 v[148:149], v21 offset:9376
  v_mul_u32_u24 v2, 40, v2
  v_mfma_f32_16x16x32_bf16 v[96:99], v[164:167], a[20:23], v[96:99]
  ds_read_b64_tr_b16 v[150:151], v22 offset:9376
  s_waitcnt lgkmcnt(4)
  v_mfma_f32_16x16x32_bf16 v[80:83], v[168:171], a[16:19], v[80:83]
  ds_read_b64_tr_b16 v[152:153], v23 offset:9360
  v_add_u32 v2, 61440, v2
  v_mfma_f32_16x16x32_bf16 v[100:103], v[168:171], a[20:23], v[100:103]
  ds_read_b64_tr_b16 v[154:155], v24 offset:9360
  v_lshl_add_u32 v10, v252, 3, v2
  v_mfma_f32_16x16x32_bf16 v[64:67], v[172:175], a[24:27], v[64:67]
  ds_read_b64_tr_b16 v[156:157], v25 offset:9360
  v_lshl_add_u32 v11, v252, 18, v2
  v_mfma_f32_16x16x32_bf16 v[84:87], v[172:175], a[28:31], v[84:87]
  ds_read_b64_tr_b16 v[158:159], v26 offset:9360
  s_waitcnt lgkmcnt(4)
  v_mfma_f32_16x16x32_bf16 v[68:71], v[144:147], a[24:27], v[68:71]
  ds_read_b64_tr_b16 v[160:161], v21 offset:18432
  v_xor_b32 v3, 1, v252
  v_mfma_f32_16x16x32_bf16 v[88:91], v[144:147], a[28:31], v[88:91]
  ds_read_b64_tr_b16 v[162:163], v22 offset:18432
  buffer_load_dwordx4 v38, s[32:35], s81 offen offset:2048 lds
  v_mfma_f32_16x16x32_bf16 v[72:75], v[148:151], a[24:27], v[72:75]
  ds_read_b64_tr_b16 v[164:165], v21 offset:18440
  v_lshl_add_u32 v12, v3, 18, v2
  v_mfma_f32_16x16x32_bf16 v[92:95], v[148:151], a[28:31], v[92:95]
  ds_read_b64_tr_b16 v[166:167], v22 offset:18440
  v_xor_b32 v3, 2, v252
  s_waitcnt lgkmcnt(4)
  v_mfma_f32_16x16x32_bf16 v[76:79], v[152:155], a[24:27], v[76:79]
  ds_read_b64_tr_b16 v[168:169], v21 offset:18448
  v_lshl_add_u32 v13, v3, 18, v2
  v_mfma_f32_16x16x32_bf16 v[96:99], v[152:155], a[28:31], v[96:99]
  ds_read_b64_tr_b16 v[170:171], v22 offset:18448
  v_xor_b32 v3, 3, v252
  v_mfma_f32_16x16x32_bf16 v[80:83], v[156:159], a[24:27], v[80:83]
  ds_read_b64_tr_b16 v[172:173], v23 offset:18432
  v_lshl_add_u32 v14, v3, 18, v2
  v_mfma_f32_16x16x32_bf16 v[100:103], v[156:159], a[28:31], v[100:103]
  ds_read_b64_tr_b16 v[174:175], v24 offset:18432
  s_waitcnt lgkmcnt(4)
  v_mfma_f32_16x16x32_bf16 v[64:67], v[160:163], a[32:35], v[64:67]
  ds_read_b64_tr_b16 v[144:145], v25 offset:18432
  s_bfe_u32 s44, s78, 262148
  v_mfma_f32_16x16x32_bf16 v[84:87], v[160:163], a[36:39], v[84:87]
  ds_read_b64_tr_b16 v[146:147], v26 offset:18432
  s_mul_i32 s44, s44, 4608
  v_mfma_f32_16x16x32_bf16 v[68:71], v[164:167], a[32:35], v[68:71]
  ds_read_b64_tr_b16 v[148:149], v21 offset:18576
  buffer_load_dwordx4 v39, s[32:35], s81 offen offset:3072 lds
  s_add_u32 m0, s79, 4096
  v_mfma_f32_16x16x32_bf16 v[88:91], v[164:167], a[36:39], v[88:91]
  ds_read_b64_tr_b16 v[150:151], v22 offset:18576
  s_add_u32 s85, s44, s71
  s_waitcnt lgkmcnt(4)
  v_mfma_f32_16x16x32_bf16 v[72:75], v[168:171], a[32:35], v[72:75]
  ds_read_b64_tr_b16 v[152:153], v21 offset:18584
  s_bfe_u32 s44, s78, 262152
  v_mfma_f32_16x16x32_bf16 v[92:95], v[168:171], a[36:39], v[92:95]
  ds_read_b64_tr_b16 v[154:155], v22 offset:18584
  s_mul_i32 s44, s44, 4608
  v_mfma_f32_16x16x32_bf16 v[76:79], v[172:175], a[32:35], v[76:79]
  ds_read_b64_tr_b16 v[156:157], v21 offset:18592
  s_add_u32 s86, s44, s71
  v_mfma_f32_16x16x32_bf16 v[96:99], v[172:175], a[36:39], v[96:99]
  ds_read_b64_tr_b16 v[158:159], v22 offset:18592
  s_waitcnt lgkmcnt(4)
  v_mfma_f32_16x16x32_bf16 v[80:83], v[144:147], a[32:35], v[80:83]
  ds_read_b64_tr_b16 v[160:161], v23 offset:18576
  s_bfe_u32 s44, s78, 262156
  v_mfma_f32_16x16x32_bf16 v[100:103], v[144:147], a[36:39], v[100:103]
  ds_read_b64_tr_b16 v[162:163], v24 offset:18576
  s_mul_i32 s44, s44, 4608
  v_mfma_f32_16x16x32_bf16 v[64:67], v[148:151], a[40:43], v[64:67]
  ds_read_b64_tr_b16 v[164:165], v25 offset:18576
  buffer_load_dwordx4 v40, s[32:35], s81 offen lds
  s_bfe_u32 s81, s51, 262152
  s_mul_i32 s81, s81, 82944
  s_add_u32 s81, s81, s93
  s_add_u32 m0, s79, 20480
  v_mfma_f32_16x16x32_bf16 v[84:87], v[148:151], a[44:47], v[84:87]
  ds_read_b64_tr_b16 v[166:167], v26 offset:18576
  s_add_u32 s87, s44, s71
  s_waitcnt lgkmcnt(4)
  v_mfma_f32_16x16x32_bf16 v[68:71], v[152:155], a[40:43], v[68:71]
  ds_read_b64_tr_b16 v[168:169], v21 offset:27648
  s_bfe_u32 s44, s78, 262160
  v_mfma_f32_16x16x32_bf16 v[88:91], v[152:155], a[44:47], v[88:91]
  ds_read_b64_tr_b16 v[170:171], v22 offset:27648
  s_mul_i32 s44, s44, 4608
  v_mfma_f32_16x16x32_bf16 v[72:75], v[156:159], a[40:43], v[72:75]
  ds_read_b64_tr_b16 v[172:173], v21 offset:27656
  s_add_u32 s88, s44, s71
  v_mfma_f32_16x16x32_bf16 v[92:95], v[156:159], a[44:47], v[92:95]
  ds_read_b64_tr_b16 v[174:175], v22 offset:27656
  s_waitcnt lgkmcnt(4)
  v_mfma_f32_16x16x32_bf16 v[76:79], v[160:163], a[40:43], v[76:79]
  ds_read_b64_tr_b16 v[144:145], v21 offset:27664
  s_bfe_u32 s44, s78, 262164
  v_mfma_f32_16x16x32_bf16 v[96:99], v[160:163], a[44:47], v[96:99]
  ds_read_b64_tr_b16 v[146:147], v22 offset:27664
  s_mul_i32 s44, s44, 4608
  v_mfma_f32_16x16x32_bf16 v[80:83], v[164:167], a[40:43], v[80:83]
  ds_read_b64_tr_b16 v[148:149], v23 offset:27648
  s_add_u32 s89, s44, s71
  v_mfma_f32_16x16x32_bf16 v[100:103], v[164:167], a[44:47], v[100:103]
  ds_read_b64_tr_b16 v[150:151], v24 offset:27648
  s_waitcnt lgkmcnt(4)
  v_mfma_f32_16x16x32_bf16 v[64:67], v[168:171], a[48:51], v[64:67]
  ds_read_b64_tr_b16 v[152:153], v25 offset:27648
  s_bfe_u32 s44, s78, 262168
  v_mfma_f32_16x16x32_bf16 v[84:87], v[168:171], a[52:55], v[84:87]
  ds_read_b64_tr_b16 v[154:155], v26 offset:27648
  s_mul_i32 s44, s44, 4608
  v_mfma_f32_16x16x32_bf16 v[68:71], v[172:175], a[48:51], v[68:71]
  ds_read_b64_tr_b16 v[156:157], v21 offset:27792
  s_add_u32 s90, s44, s71
  v_mfma_f32_16x16x32_bf16 v[88:91], v[172:175], a[52:55], v[88:91]
  ds_read_b64_tr_b16 v[158:159], v22 offset:27792
  s_waitcnt lgkmcnt(4)
  v_mfma_f32_16x16x32_bf16 v[72:75], v[144:147], a[48:51], v[72:75]
  ds_read_b64_tr_b16 v[160:161], v21 offset:27800
  s_bfe_u32 s44, s78, 262172
  v_mfma_f32_16x16x32_bf16 v[92:95], v[144:147], a[52:55], v[92:95]
  ds_read_b64_tr_b16 v[162:163], v22 offset:27800
  s_mul_i32 s44, s44, 4608
  v_mfma_f32_16x16x32_bf16 v[76:79], v[148:151], a[48:51], v[76:79]
  ds_read_b64_tr_b16 v[164:165], v21 offset:27808
  s_add_u32 s91, s44, s71
  v_mfma_f32_16x16x32_bf16 v[96:99], v[148:151], a[52:55], v[96:99]
  ds_read_b64_tr_b16 v[166:167], v22 offset:27808
  s_waitcnt lgkmcnt(4)
  v_mfma_f32_16x16x32_bf16 v[80:83], v[152:155], a[48:51], v[80:83]
  ds_read_b64_tr_b16 v[168:169], v23 offset:27792
  buffer_load_dwordx4 v[128:131], v46, s[36:39], s69 offen offset:0 sc1
  v_mfma_f32_16x16x32_bf16 v[100:103], v[152:155], a[52:55], v[100:103]
  ds_read_b64_tr_b16 v[170:171], v24 offset:27792
  buffer_load_dwordx4 v[132:135], v46, s[36:39], s69 offen offset:1024 sc1
  v_mfma_f32_16x16x32_bf16 v[64:67], v[156:159], a[56:59], v[64:67]
  ds_read_b64_tr_b16 v[172:173], v25 offset:27792
  buffer_load_dwordx4 v[136:139], v46, s[36:39], s69 offen offset:2048 sc1
  v_mfma_f32_16x16x32_bf16 v[84:87], v[156:159], a[60:63], v[84:87]
  ds_read_b64_tr_b16 v[174:175], v26 offset:27792
  s_waitcnt lgkmcnt(4)
  v_mfma_f32_16x16x32_bf16 v[68:71], v[160:163], a[56:59], v[68:71]
  ds_read_b64_tr_b16 v[144:145], v21 offset:36864
  buffer_load_dwordx4 v[140:143], v46, s[36:39], s69 offen offset:3072 sc1
  v_mfma_f32_16x16x32_bf16 v[88:91], v[160:163], a[60:63], v[88:91]
  ds_read_b64_tr_b16 v[146:147], v22 offset:36864
  buffer_load_dwordx4 v36, s[32:35], s81 offen offset:0 lds
  v_mfma_f32_16x16x32_bf16 v[72:75], v[164:167], a[56:59], v[72:75]
  ds_read_b64_tr_b16 v[148:149], v21 offset:36872
  v_mfma_f32_16x16x32_bf16 v[92:95], v[164:167], a[60:63], v[92:95]
  ds_read_b64_tr_b16 v[150:151], v22 offset:36872
  s_waitcnt lgkmcnt(4)
  v_mfma_f32_16x16x32_bf16 v[76:79], v[168:171], a[56:59], v[76:79]
  ds_read_b64_tr_b16 v[152:153], v21 offset:36880
  v_mfma_f32_16x16x32_bf16 v[96:99], v[168:171], a[60:63], v[96:99]
  ds_read_b64_tr_b16 v[154:155], v22 offset:36880
  v_mfma_f32_16x16x32_bf16 v[80:83], v[172:175], a[56:59], v[80:83]
  ds_read_b64_tr_b16 v[156:157], v23 offset:36864
  buffer_load_dwordx4 v37, s[32:35], s81 offen offset:1024 lds
  v_mfma_f32_16x16x32_bf16 v[100:103], v[172:175], a[60:63], v[100:103]
  ds_read_b64_tr_b16 v[158:159], v24 offset:36864
  s_waitcnt lgkmcnt(4)
  v_mfma_f32_16x16x32_bf16 v[64:67], v[144:147], a[64:67], v[64:67]
  ds_read_b64_tr_b16 v[160:161], v25 offset:36864
  v_mfma_f32_16x16x32_bf16 v[84:87], v[144:147], a[68:71], v[84:87]
  ds_read_b64_tr_b16 v[162:163], v26 offset:36864
  v_mfma_f32_16x16x32_bf16 v[68:71], v[148:151], a[64:67], v[68:71]
  ds_read_b64_tr_b16 v[164:165], v21 offset:37008
  v_mfma_f32_16x16x32_bf16 v[88:91], v[148:151], a[68:71], v[88:91]
  ds_read_b64_tr_b16 v[166:167], v22 offset:37008
  s_waitcnt lgkmcnt(4)
  v_mfma_f32_16x16x32_bf16 v[72:75], v[152:155], a[64:67], v[72:75]
  ds_read_b64_tr_b16 v[168:169], v21 offset:37016
  buffer_load_dwordx4 v38, s[32:35], s81 offen offset:2048 lds
  v_mfma_f32_16x16x32_bf16 v[92:95], v[152:155], a[68:71], v[92:95]
  ds_read_b64_tr_b16 v[170:171], v22 offset:37016
  v_mfma_f32_16x16x32_bf16 v[76:79], v[156:159], a[64:67], v[76:79]
  ds_read_b64_tr_b16 v[172:173], v21 offset:37024
  v_mfma_f32_16x16x32_bf16 v[96:99], v[156:159], a[68:71], v[96:99]
  ds_read_b64_tr_b16 v[174:175], v22 offset:37024
  s_waitcnt lgkmcnt(4)
  v_mfma_f32_16x16x32_bf16 v[80:83], v[160:163], a[64:67], v[80:83]
  ds_read_b64_tr_b16 v[144:145], v23 offset:37008
  v_mfma_f32_16x16x32_bf16 v[100:103], v[160:163], a[68:71], v[100:103]
  ds_read_b64_tr_b16 v[146:147], v24 offset:37008
  v_mfma_f32_16x16x32_bf16 v[64:67], v[164:167], a[72:75], v[64:67]
  ds_read_b64_tr_b16 v[148:149], v25 offset:37008
  buffer_load_dwordx4 v39, s[32:35], s81 offen offset:3072 lds
  s_add_u32 m0, s79, 24576
  v_mfma_f32_16x16x32_bf16 v[84:87], v[164:167], a[76:79], v[84:87]
  ds_read_b64_tr_b16 v[150:151], v26 offset:37008
  s_waitcnt lgkmcnt(4)
  v_mfma_f32_16x16x32_bf16 v[68:71], v[168:171], a[72:75], v[68:71]
  ds_read_b64_tr_b16 v[152:153], v21 offset:46080
  v_mfma_f32_16x16x32_bf16 v[88:91], v[168:171], a[76:79], v[88:91]
  ds_read_b64_tr_b16 v[154:155], v22 offset:46080
  v_mfma_f32_16x16x32_bf16 v[72:75], v[172:175], a[72:75], v[72:75]
  ds_read_b64_tr_b16 v[156:157], v21 offset:46088
  v_mfma_f32_16x16x32_bf16 v[92:95], v[172:175], a[76:79], v[92:95]
  ds_read_b64_tr_b16 v[158:159], v22 offset:46088
  s_waitcnt lgkmcnt(4)
  v_mfma_f32_16x16x32_bf16 v[76:79], v[144:147], a[72:75], v[76:79]
  ds_read_b64_tr_b16 v[160:161], v21 offset:46096
  buffer_load_dwordx4 v40, s[32:35], s81 offen lds
  s_bfe_u32 s81, s51, 262160
  s_mul_i32 s81, s81, 82944
  s_add_u32 s81, s81, s93
  s_add_u32 m0, s79, 40960
  v_mfma_f32_16x16x32_bf16 v[96:99], v[144:147], a[76:79], v[96:99]
  ds_read_b64_tr_b16 v[162:163], v22 offset:46096
  v_mfma_f32_16x16x32_bf16 v[80:83], v[148:151], a[72:75], v[80:83]
  ds_read_b64_tr_b16 v[164:165], v23 offset:46080
  v_mfma_f32_16x16x32_bf16 v[100:103], v[148:151], a[76:79], v[100:103]
  ds_read_b64_tr_b16 v[166:167], v24 offset:46080
  s_waitcnt lgkmcnt(4)
  v_mfma_f32_16x16x32_bf16 v[64:67], v[152:155], a[80:83], v[64:67]
  ds_read_b64_tr_b16 v[168:169], v25 offset:46080
  buffer_load_dwordx4 v[200:203], v46, s[36:39], s22 offen offset:0 sc1
  v_mfma_f32_16x16x32_bf16 v[84:87], v[152:155], a[84:87], v[84:87]
  ds_read_b64_tr_b16 v[170:171], v26 offset:46080
  s_waitcnt vmcnt(6)
  v_mfma_f32_16x16x32_bf16 v[68:71], v[156:159], a[80:83], v[68:71]
  ds_read_b64_tr_b16 v[172:173], v21 offset:46224
  v_xor_b32 v128, s82, v128
  v_mfma_f32_16x16x32_bf16 v[88:91], v[156:159], a[84:87], v[88:91]
  ds_read_b64_tr_b16 v[174:175], v22 offset:46224
  s_waitcnt lgkmcnt(4)
  v_mfma_f32_16x16x32_bf16 v[72:75], v[160:163], a[80:83], v[72:75]
  ds_read_b64_tr_b16 v[144:145], v21 offset:46232
  v_xor_b32 v129, s82, v129
  v_mfma_f32_16x16x32_bf16 v[92:95], v[160:163], a[84:87], v[92:95]
  ds_read_b64_tr_b16 v[146:147], v22 offset:46232
  s_waitcnt vmcnt(25)
  s_barrier
  v_mfma_f32_16x16x32_bf16 v[76:79], v[164:167], a[80:83], v[76:79]
  ds_read_b64_tr_b16 v[148:149], v21 offset:46240
  v_xor_b32 v130, s82, v130
  v_mfma_f32_16x16x32_bf16 v[96:99], v[164:167], a[84:87], v[96:99]
  ds_read_b64_tr_b16 v[150:151], v22 offset:46240
  s_waitcnt lgkmcnt(4)
  v_mfma_f32_16x16x32_bf16 v[80:83], v[168:171], a[80:83], v[80:83]
  ds_read_b64_tr_b16 v[152:153], v23 offset:46224
  buffer_load_dwordx4 v[204:207], v46, s[36:39], s22 offen offset:1024 sc1
  v_mfma_f32_16x16x32_bf16 v[100:103], v[168:171], a[84:87], v[100:103]
  ds_read_b64_tr_b16 v[154:155], v24 offset:46224
  v_xor_b32 v131, s82, v131
  v_xor_b32 v132, s82, v132
  v_xor_b32 v133, s82, v133
  v_mfma_f32_16x16x32_bf16 v[64:67], v[172:175], a[88:91], v[64:67]
  ds_read_b64_tr_b16 v[156:157], v25 offset:46224
  buffer_load_dwordx4 v[208:211], v46, s[36:39], s22 offen offset:2048 sc1
  v_mfma_f32_16x16x32_bf16 v[84:87], v[172:175], a[92:95], v[84:87]
  ds_read_b64_tr_b16 v[158:159], v26 offset:46224
  v_xor_b32 v134, s82, v134
  v_xor_b32 v135, s82, v135
  v_xor_b32 v136, s82, v136
  s_waitcnt lgkmcnt(4)
  v_mfma_f32_16x16x32_bf16 v[68:71], v[144:147], a[88:91], v[68:71]
  v_add_u32 v21, 4294939648, v21
  v_add_u32 v22, 4294939648, v22
  v_add_u32 v23, 4294939648, v23
  v_add_u32 v24, 4294939648, v24
  v_mfma_f32_16x16x32_bf16 v[88:91], v[144:147], a[92:95], v[88:91]
  v_add_u32 v25, 4294939648, v25
  v_add_u32 v26, 4294939648, v26
  ds_read_b64_tr_b16 v[160:161], v21 offset:0
  ds_read_b64_tr_b16 v[162:163], v22 offset:0
  buffer_load_dwordx4 v[212:215], v46, s[36:39], s22 offen offset:3072 sc1
  v_xor_b32 v137, s82, v137
  v_xor_b32 v138, s82, v138
  v_xor_b32 v139, s82, v139
  v_mfma_f32_16x16x32_bf16 v[72:75], v[148:151], a[88:91], v[72:75]
  ds_read_b64_tr_b16 v[164:165], v21 offset:8
  v_xor_b32 v140, s82, v140
  v_mfma_f32_16x16x32_bf16 v[92:95], v[148:151], a[92:95], v[92:95]
  ds_read_b64_tr_b16 v[166:167], v22 offset:8
  v_xor_b32 v141, s82, v141
  v_xor_b32 v142, s82, v142
  v_xor_b32 v143, s82, v143
  s_waitcnt lgkmcnt(4)
  v_mfma_f32_16x16x32_bf16 v[76:79], v[152:155], a[88:91], v[76:79]
  ds_read_b64_tr_b16 v[168:169], v21 offset:16
  v_or3_b32 v7, v128, v129, v130
  v_mfma_f32_16x16x32_bf16 v[96:99], v[152:155], a[92:95], v[96:99]
  ds_read_b64_tr_b16 v[170:171], v22 offset:16
  v_or3_b32 v7, v7, v131, v132
  v_or3_b32 v7, v7, v133, v134
  v_mfma_f32_16x16x32_bf16 v[80:83], v[156:159], a[88:91], v[80:83]
  ds_read_b64_tr_b16 v[172:173], v23 offset:0
  v_or3_b32 v7, v7, v135, v136
  v_mfma_f32_16x16x32_bf16 v[100:103], v[156:159], a[92:95], v[100:103]
  ds_read_b64_tr_b16 v[174:175], v24 offset:0
  v_or3_b32 v7, v7, v137, v138
  v_or3_b32 v7, v7, v139, v140
  s_waitcnt lgkmcnt(4)
  v_mfma_f32_16x16x32_bf16 v[64:67], v[160:163], a[96:99], v[64:67]
  ds_read_b64_tr_b16 v[144:145], v25 offset:0
  v_or3_b32 v7, v7, v141, v142
  v_mfma_f32_16x16x32_bf16 v[84:87], v[160:163], a[100:103], v[84:87]
  ds_read_b64_tr_b16 v[146:147], v26 offset:0
  v_or_b32 v7, v7, v143
  v_and_b32 v7, 255, v7
  v_mfma_f32_16x16x32_bf16 v[68:71], v[164:167], a[96:99], v[68:71]
  ds_read_b64_tr_b16 v[148:149], v21 offset:144
  v_cmp_ne_u32 vcc, 0, v7
  v_mfma_f32_16x16x32_bf16 v[88:91], v[164:167], a[100:103], v[88:91]
  ds_read_b64_tr_b16 v[150:151], v22 offset:144
  s_cbranch_vccnz L_slow_rsA
L_back_rsA:
  s_waitcnt lgkmcnt(4)
  v_mfma_f32_16x16x32_bf16 v[72:75], v[168:171], a[96:99], v[72:75]
  ds_read_b64_tr_b16 v[152:153], v21 offset:152
  v_add_f32 v128, v128, v136
  v_mfma_f32_16x16x32_bf16 v[92:95], v[168:171], a[100:103], v[92:95]
  ds_read_b64_tr_b16 v[154:155], v22 offset:152
  v_add_f32 v129, v129, v137
  v_add_f32 v130, v130, v138
  v_add_f32 v131, v131, v139
  v_mfma_f32_16x16x32_bf16 v[76:79], v[172:175], a[96:99], v[76:79]
  ds_read_b64_tr_b16 v[156:157], v21 offset:160
  v_add_f32 v132, v132, v140
  v_mfma_f32_16x16x32_bf16 v[96:99], v[172:175], a[100:103], v[96:99]
  ds_read_b64_tr_b16 v[158:159], v22 offset:160
  v_add_f32 v133, v133, v141
  v_add_f32 v134, v134, v142
  s_waitcnt lgkmcnt(4)
  v_mfma_f32_16x16x32_bf16 v[80:83], v[144:147], a[96:99], v[80:83]
  ds_read_b64_tr_b16 v[160:161], v23 offset:144
  v_add_f32 v135, v135, v143
  v_mfma_f32_16x16x32_bf16 v[100:103], v[144:147], a[100:103], v[100:103]
  ds_read_b64_tr_b16 v[162:163], v24 offset:144
  v_add_f32 v128, v128, v132
  v_add_f32 v129, v129, v133
  v_mfma_f32_16x16x32_bf16 v[64:67], v[148:151], a[104:107], v[64:67]
  ds_read_b64_tr_b16 v[164:165], v25 offset:144
  v_add_f32 v130, v130, v134
  v_mfma_f32_16x16x32_bf16 v[84:87], v[148:151], a[108:111], v[84:87]
  ds_read_b64_tr_b16 v[166:167], v26 offset:144
  v_add_f32 v131, v131, v135
  v_permlane32_swap_b32 v128, v130
  s_waitcnt lgkmcnt(4)
  v_mfma_f32_16x16x32_bf16 v[68:71], v[152:155], a[104:107], v[68:71]
  ds_read_b64_tr_b16 v[168:169], v21 offset:9216
  v_permlane32_swap_b32 v129, v131
  v_mfma_f32_16x16x32_bf16 v[88:91], v[152:155], a[108:111], v[88:91]
  ds_read_b64_tr_b16 v[170:171], v22 offset:9216
  v_add_f32 v128, v128, v130
  v_add_f32 v129, v129, v131
  v_mov_b32 v130, v128
  v_mfma_f32_16x16x32_bf16 v[72:75], v[156:159], a[104:107], v[72:75]
  ds_read_b64_tr_b16 v[172:173], v21 offset:9224
  v_mov_b32 v131, v129
  v_mfma_f32_16x16x32_bf16 v[92:95], v[156:159], a[108:111], v[92:95]
  ds_read_b64_tr_b16 v[174:175], v22 offset:9224
  v_permlane16_swap_b32 v128, v130
  v_permlane16_swap_b32 v129, v131
  s_waitcnt lgkmcnt(4)
  v_mfma_f32_16x16x32_bf16 v[76:79], v[160:163], a[104:107], v[76:79]
  ds_read_b64_tr_b16 v[144:145], v21 offset:9232
  v_add_f32 v128, v128, v130
  v_mfma_f32_16x16x32_bf16 v[96:99], v[160:163], a[108:111], v[96:99]
  ds_read_b64_tr_b16 v[146:147], v22 offset:9232
  v_add_f32 v129, v129, v131
  v_cvt_pk_bf16_f32 v128, v128, v129
  v_mfma_f32_16x16x32_bf16 v[80:83], v[164:167], a[104:107], v[80:83]
  ds_read_b64_tr_b16 v[148:149], v23 offset:9216
  v_mov_b32 v129, s95
  v_mfma_f32_16x16x32_bf16 v[100:103], v[164:167], a[108:111], v[100:103]
  ds_read_b64_tr_b16 v[150:151], v24 offset:9216
  buffer_store_dwordx2 v[128:129], v53, s[36:39], s73 offen sc1
  v_mov_b32 v8, s49
  s_waitcnt lgkmcnt(4)
  v_mfma_f32_16x16x32_bf16 v[64:67], v[168:171], a[112:115], v[64:67]
  ds_read_b64_tr_b16 v[152:153], v25 offset:9216
  s_lshl_b32 s63, s54, 2
  v_mfma_f32_16x16x32_bf16 v[84:87], v[168:171], a[116:119], v[84:87]
  ds_read_b64_tr_b16 v[154:155], v26 offset:9216
  v_mov_b32 v9, s63
  buffer_store_dword v8, v9, s[36:39], s70 offen sc1
  v_mfma_f32_16x16x32_bf16 v[68:71], v[172:175], a[112:115], v[68:71]
  ds_read_b64_tr_b16 v[156:157], v21 offset:9360
  s_waitcnt vmcnt(2)
  v_mfma_f32_16x16x32_bf16 v[88:91], v[172:175], a[116:119], v[88:91]
  ds_read_b64_tr_b16 v[158:159], v22 offset:9360
  v_xor_b32 v200, s82, v200
  v_xor_b32 v201, s82, v201
  v_xor_b32 v202, s82, v202
  s_waitcnt lgkmcnt(4)
  v_mfma_f32_16x16x32_bf16 v[72:75], v[144:147], a[112:115], v[72:75]
  ds_read_b64_tr_b16 v[160:161], v21 offset:9368
  v_xor_b32 v203, s82, v203
  v_mfma_f32_16x16x32_bf16 v[92:95], v[144:147], a[116:119], v[92:95]
  ds_read_b64_tr_b16 v[162:163], v22 offset:9368
  v_xor_b32 v204, s82, v204
  v_xor_b32 v205, s82, v205
  v_xor_b32 v206, s82, v206
  v_mfma_f32_16x16x32_bf16 v[76:79], v[148:151], a[112:115], v[76:79]
  ds_read_b64_tr_b16 v[164:165], v21 offset:9376
  v_xor_b32 v207, s82, v207
  v_mfma_f32_16x16x32_bf16 v[96:99], v[148:151], a[116:119], v[96:99]
  ds_read_b64_tr_b16 v[166:167], v22 offset:9376
  v_xor_b32 v208, s82, v208
  v_xor_b32 v209, s82, v209
  v_xor_b32 v210, s82, v210
  s_waitcnt lgkmcnt(4)
  v_mfma_f32_16x16x32_bf16 v[80:83], v[152:155], a[112:115], v[80:83]
  ds_read_b64_tr_b16 v[168:169], v23 offset:9360
  v_xor_b32 v211, s82, v211
  v_mfma_f32_16x16x32_bf16 v[100:103], v[152:155], a[116:119], v[100:103]
  ds_read_b64_tr_b16 v[170:171], v24 offset:9360
  v_xor_b32 v212, s82, v212
  v_xor_b32 v213, s82, v213
  v_xor_b32 v214, s82, v214
  v_mfma_f32_16x16x32_bf16 v[64:67], v[156:159], a[120:123], v[64:67]
  ds_read_b64_tr_b16 v[172:173], v25 offset:9360
  v_xor_b32 v215, s82, v215
  v_mfma_f32_16x16x32_bf16 v[84:87], v[156:159], a[124:127], v[84:87]
  ds_read_b64_tr_b16 v[174:175], v26 offset:9360
  v_or3_b32 v6, v200, v201, v202
  v_or3_b32 v6, v6, v203, v204
  v_or3_b32 v6, v6, v205, v206
  s_waitcnt lgkmcnt(4)
  v_mfma_f32_16x16x32_bf16 v[68:71], v[160:163], a[120:123], v[68:71]
  ds_read_b64_tr_b16 v[144:145], v21 offset:18432
  v_or3_b32 v6, v6, v207, v208
  v_mfma_f32_16x16x32_bf16 v[88:91], v[160:163], a[124:127], v[88:91]
  ds_read_b64_tr_b16 v[146:147], v22 offset:18432
  v_or3_b32 v6, v6, v209, v210
  v_or3_b32 v6, v6, v211, v212
  v_or3_b32 v6, v6, v213, v214
  v_mfma_f32_16x16x32_bf16 v[72:75], v[164:167], a[120:123], v[72:75]
  ds_read_b64_tr_b16 v[148:149], v21 offset:18440
  v_or_b32 v6, v6, v215
  v_mfma_f32_16x16x32_bf16 v[92:95], v[164:167], a[124:127], v[92:95]
  ds_read_b64_tr_b16 v[150:151], v22 offset:18440
  v_and_b32 v6, 255, v6
  v_cmp_ne_u32 vcc, 0, v6
  s_waitcnt lgkmcnt(4)
  v_mfma_f32_16x16x32_bf16 v[76:79], v[168:171], a[120:123], v[76:79]
  ds_read_b64_tr_b16 v[152:153], v21 offset:18448
  v_mfma_f32_16x16x32_bf16 v[96:99], v[168:171], a[124:127], v[96:99]
  ds_read_b64_tr_b16 v[154:155], v22 offset:18448
  s_cbranch_vccnz L_slow_rbA
L_back_rbA:
  v_add_f32 v200, v200, v208
  v_add_f32 v201, v201, v209
  v_mfma_f32_16x16x32_bf16 v[80:83], v[172:175], a[120:123], v[80:83]
  ds_read_b64_tr_b16 v[156:157], v23 offset:18432
  v_add_f32 v202, v202, v210
  v_mfma_f32_16x16x32_bf16 v[100:103], v[172:175], a[124:127], v[100:103]
  ds_read_b64_tr_b16 v[158:159], v24 offset:18432
  v_add_f32 v203, v203, v211
  v_add_f32 v204, v204, v212
  v_add_f32 v205, v205, v213
  s_waitcnt lgkmcnt(4)
  v_mfma_f32_16x16x32_bf16 v[64:67], v[144:147], a[128:131], v[64:67]
  ds_read_b64_tr_b16 v[160:161], v25 offset:18432
  v_add_f32 v206, v206, v214
  v_mfma_f32_16x16x32_bf16 v[84:87], v[144:147], a[132:135], v[84:87]
  ds_read_b64_tr_b16 v[162:163], v26 offset:18432
  v_add_f32 v207, v207, v215
  v_add_f32 v200, v200, v204
  v_add_f32 v201, v201, v205
  v_mfma_f32_16x16x32_bf16 v[68:71], v[148:151], a[128:131], v[68:71]
  ds_read_b64_tr_b16 v[164:165], v21 offset:18576
  v_add_f32 v202, v202, v206
  v_mfma_f32_16x16x32_bf16 v[88:91], v[148:151], a[132:135], v[88:91]
  ds_read_b64_tr_b16 v[166:167], v22 offset:18576
  v_add_f32 v203, v203, v207
  v_permlane32_swap_b32 v200, v202
  s_nop 0
  v_permlane32_swap_b32 v201, v203
  s_waitcnt lgkmcnt(4)
  v_mfma_f32_16x16x32_bf16 v[72:75], v[152:155], a[128:131], v[72:75]
  ds_read_b64_tr_b16 v[168:169], v21 offset:18584
  v_add_f32 v200, v200, v202
  v_mfma_f32_16x16x32_bf16 v[92:95], v[152:155], a[132:135], v[92:95]
  ds_read_b64_tr_b16 v[170:171], v22 offset:18584
  v_add_f32 v201, v201, v203
  v_mov_b32 v202, v200
  v_mov_b32 v203, v201
  v_mfma_f32_16x16x32_bf16 v[76:79], v[156:159], a[128:131], v[76:79]
  ds_read_b64_tr_b16 v[172:173], v21 offset:18592
  v_permlane16_swap_b32 v200, v202
  v_mfma_f32_16x16x32_bf16 v[96:99], v[156:159], a[132:135], v[96:99]
  ds_read_b64_tr_b16 v[174:175], v22 offset:18592
  v_permlane16_swap_b32 v201, v203
  v_add_f32 v200, v200, v202
  v_add_f32 v201, v201, v203
  s_waitcnt lgkmcnt(4)
L_tp8:
  s_cbranch_execz L_tret1
  v_mfma_f32_16x16x32_bf16 v[80:83], v[160:163], a[128:131], v[80:83]
  ds_read_b64_tr_b16 v[144:145], v23 offset:18576
  v_cvt_pk_bf16_f32 v200, v200, v201
  v_mfma_f32_16x16x32_bf16 v[100:103], v[160:163], a[132:135], v[100:103]
  ds_read_b64_tr_b16 v[146:147], v24 offset:18576
  v_mov_b32 v201, s95
  buffer_store_dwordx2 v[200:201], v53, s[36:39], s23 offen sc1
  v_mfma_f32_16x16x32_bf16 v[64:67], v[164:167], a[136:139], v[64:67]
  ds_read_b64_tr_b16 v[148:149], v25 offset:18576
  v_mfma_f32_16x16x32_bf16 v[84:87], v[164:167], a[140:143], v[84:87]
  ds_read_b64_tr_b16 v[150:151], v26 offset:18576
  s_waitcnt lgkmcnt(4)
  v_mfma_f32_16x16x32_bf16 v[68:71], v[168:171], a[136:139], v[68:71]
  v_mfma_f32_16x16x32_bf16 v[88:91], v[168:171], a[140:143], v[88:91]
  v_mfma_f32_16x16x32_bf16 v[72:75], v[172:175], a[136:139], v[72:75]
  v_mfma_f32_16x16x32_bf16 v[92:95], v[172:175], a[140:143], v[92:95]
  s_waitcnt lgkmcnt(0)
  v_mfma_f32_16x16x32_bf16 v[76:79], v[144:147], a[136:139], v[76:79]
  v_mfma_f32_16x16x32_bf16 v[96:99], v[144:147], a[140:143], v[96:99]
  v_mfma_f32_16x16x32_bf16 v[80:83], v[148:151], a[136:139], v[80:83]
  v_mfma_f32_16x16x32_bf16 v[100:103], v[148:151], a[140:143], v[100:103]
  v_min_u32 v4, 752, v46
  v_and_b32 v5, 7, v0
  v_lshlrev_b32 v5, 2, v5
  v_and_b32 v1, 1, v47
  v_lshl_add_u32 v2, v47, 3, v251
  v_lshl_add_u32 v2, v1, 2, v2
  v_xor_b32 v3, 4, v2
  v_mul_u32_u24 v2, 160, v2
  v_mul_u32_u24 v3, 160, v3
  v_lshl_add_u32 v21, v252, 3, v2
  v_lshl_add_u32 v22, v252, 3, v3
  v_add_u32 v23, 104448, v21
  v_add_u32 v24, 104448, v22
  v_mov_b32 v209, 0
  v_mov_b32 v210, 0
  v_mov_b32 v211, 0
  v_mov_b32 v212, 0
  v_mov_b32 v213, 0
  v_mov_b32 v214, 0
  v_mov_b32 v215, 0
  v_mov_b32 v229, 0
  v_mov_b32 v230, 0
  v_mov_b32 v231, 0
  v_mov_b32 v232, 0
  v_mov_b32 v233, 0
  v_mov_b32 v234, 0
  v_mov_b32 v235, 0
  s_mul_i32 s63, s55, 1920
  s_add_u32 s63, s63, 62240
  v_min_u32 v1, 464, v46
  v_add_u32 v1, s63, v1
  ds_write_b128 v1, v[212:215]
  v_permlane16_swap_b32 v80, v82
  buffer_load_dwordx4 v36, s[32:35], s81 offen offset:0 lds
  v_permlane16_swap_b32 v81, v83
  s_nop 0
  v_pk_mul_f32 v[144:145], v[64:65], s[74:75]
  v_pk_mul_f32 v[146:147], v[66:67], s[74:75]
  v_pk_mul_f32 v[148:149], v[68:69], s[74:75]
  v_pk_mul_f32 v[150:151], v[70:71], s[74:75]
  v_pk_mul_f32 v[152:153], v[72:73], s[74:75]
  v_pk_mul_f32 v[154:155], v[74:75], s[74:75]
  v_pk_mul_f32 v[156:157], v[76:77], s[74:75]
  v_pk_mul_f32 v[158:159], v[78:79], s[74:75]
  v_pk_mul_f32 v[160:161], v[80:81], s[74:75]
  v_exp_f32 v144, v144 clamp
  v_max_f32 v64, 0, v64
  v_exp_f32 v145, v145 clamp
  v_max_f32 v65, 0, v65
  v_pk_add_f32 v[64:65], v[64:65], s[76:77]
  v_pk_add_f32 v[64:65], v[64:65], v[144:145]
  v_cvt_pk_bf16_f32 v200, v64, v65
  v_exp_f32 v146, v146 clamp
  v_max_f32 v66, 0, v66
  v_exp_f32 v147, v147 clamp
  v_max_f32 v67, 0, v67
  v_pk_add_f32 v[66:67], v[66:67], s[76:77]
  v_pk_add_f32 v[66:67], v[66:67], v[146:147]
  v_cvt_pk_bf16_f32 v201, v66, v67
  buffer_load_dwordx4 v37, s[32:35], s81 offen offset:1024 lds
  v_exp_f32 v148, v148 clamp
  v_max_f32 v68, 0, v68
  v_exp_f32 v149, v149 clamp
  v_max_f32 v69, 0, v69
  v_pk_add_f32 v[68:69], v[68:69], s[76:77]
  v_pk_add_f32 v[68:69], v[68:69], v[148:149]
  v_cvt_pk_bf16_f32 v202, v68, v69
  v_exp_f32 v150, v150 clamp
  v_max_f32 v70, 0, v70
  v_exp_f32 v151, v151 clamp
  v_max_f32 v71, 0, v71
  v_pk_add_f32 v[70:71], v[70:71], s[76:77]
  v_pk_add_f32 v[70:71], v[70:71], v[150:151]
  v_cvt_pk_bf16_f32 v203, v70, v71
  v_exp_f32 v152, v152 clamp
  v_max_f32 v72, 0, v72
  v_exp_f32 v153, v153 clamp
  v_max_f32 v73, 0, v73
  v_pk_add_f32 v[72:73], v[72:73], s[76:77]
  v_pk_add_f32 v[72:73], v[72:73], v[152:153]
  v_cvt_pk_bf16_f32 v204, v72, v73
  v_exp_f32 v154, v154 clamp
  v_max_f32 v74, 0, v74
  v_exp_f32 v155, v155 clamp
  v_max_f32 v75, 0, v75
  buffer_load_dwordx4 v38, s[32:35], s81 offen offset:2048 lds
  v_pk_add_f32 v[74:75], v[74:75], s[76:77]
  v_pk_add_f32 v[74:75], v[74:75], v[154:155]
  v_cvt_pk_bf16_f32 v205, v74, v75
  v_exp_f32 v156, v156 clamp
  v_max_f32 v76, 0, v76
  v_exp_f32 v157, v157 clamp
  v_max_f32 v77, 0, v77
  v_pk_add_f32 v[76:77], v[76:77], s[76:77]
  v_pk_add_f32 v[76:77], v[76:77], v[156:157]
  v_cvt_pk_bf16_f32 v206, v76, v77
  v_exp_f32 v158, v158 clamp
  v_max_f32 v78, 0, v78
  v_exp_f32 v159, v159 clamp
  v_max_f32 v79, 0, v79
  v_pk_add_f32 v[78:79], v[78:79], s[76:77]
  v_pk_add_f32 v[78:79], v[78:79], v[158:159]
  v_cvt_pk_bf16_f32 v207, v78, v79
  v_exp_f32 v160, v160 clamp
  v_max_f32 v80, 0, v80
  v_exp_f32 v161, v161 clamp
  v_max_f32 v81, 0, v81
  v_pk_add_f32 v[80:81], v[80:81], s[76:77]
  v_pk_add_f32 v[80:81], v[80:81], v[160:161]
  v_cvt_pk_bf16_f32 v208, v80, v81
  v_permlane16_swap_b32 v100, v102
  buffer_load_dwordx4 v39, s[32:35], s81 offen offset:3072 lds
  s_add_u32 m0, s79, 45056
  v_permlane16_swap_b32 v101, v103
  v_pk_mul_f32 v[144:145], v[84:85], s[74:75]
  v_pk_mul_f32 v[146:147], v[86:87], s[74:75]
  v_pk_mul_f32 v[148:149], v[88:89], s[74:75]
  v_pk_mul_f32 v[150:151], v[90:91], s[74:75]
  v_pk_mul_f32 v[152:153], v[92:93], s[74:75]
  v_pk_mul_f32 v[154:155], v[94:95], s[74:75]
  v_pk_mul_f32 v[156:157], v[96:97], s[74:75]
  v_pk_mul_f32 v[158:159], v[98:99], s[74:75]
  v_pk_mul_f32 v[160:161], v[100:101], s[74:75]
  v_exp_f32 v144, v144 clamp
  v_max_f32 v84, 0, v84
  v_exp_f32 v145, v145 clamp
  v_max_f32 v85, 0, v85
  buffer_load_dwordx4 v40, s[32:35], s81 offen lds
  s_bfe_u32 s81, s51, 262168
  s_mul_i32 s81, s81, 82944
  s_add_u32 s81, s81, s93
  s_add_u32 m0, s79, 104448
  v_pk_add_f32 v[84:85], v[84:85], s[76:77]
  v_pk_add_f32 v[84:85], v[84:85], v[144:145]
  v_cvt_pk_bf16_f32 v220, v84, v85
  v_exp_f32 v146, v146 clamp
  v_max_f32 v86, 0, v86
  v_exp_f32 v147, v147 clamp
  v_max_f32 v87, 0, v87
  v_pk_add_f32 v[86:87], v[86:87], s[76:77]
  v_pk_add_f32 v[86:87], v[86:87], v[146:147]
  v_cvt_pk_bf16_f32 v221, v86, v87
  v_exp_f32 v148, v148 clamp
  v_max_f32 v88, 0, v88
  v_exp_f32 v149, v149 clamp
  v_max_f32 v89, 0, v89
  v_pk_add_f32 v[88:89], v[88:89], s[76:77]
  buffer_load_dword v116, v5, s[36:39], s70 offen sc1
  v_pk_add_f32 v[88:89], v[88:89], v[148:149]
  v_cvt_pk_bf16_f32 v222, v88, v89
  v_exp_f32 v150, v150 clamp
  v_max_f32 v90, 0, v90
  v_exp_f32 v151, v151 clamp
  v_max_f32 v91, 0, v91
  v_pk_add_f32 v[90:91], v[90:91], s[76:77]
  v_pk_add_f32 v[90:91], v[90:91], v[150:151]
  v_cvt_pk_bf16_f32 v223, v90, v91
  v_exp_f32 v152, v152 clamp
  v_max_f32 v92, 0, v92
  v_exp_f32 v153, v153 clamp
  v_max_f32 v93, 0, v93
  v_pk_add_f32 v[92:93], v[92:93], s[76:77]
  v_pk_add_f32 v[92:93], v[92:93], v[152:153]
  buffer_load_dwordx4 v[104:107], v46, s[36:39], s92 offen offset:0 sc1
  v_cvt_pk_bf16_f32 v224, v92, v93
  v_exp_f32 v154, v154 clamp
  v_max_f32 v94, 0, v94
  v_exp_f32 v155, v155 clamp
  v_max_f32 v95, 0, v95
  v_pk_add_f32 v[94:95], v[94:95], s[76:77]
  v_pk_add_f32 v[94:95], v[94:95], v[154:155]
  v_cvt_pk_bf16_f32 v225, v94, v95
  v_exp_f32 v156, v156 clamp
  v_max_f32 v96, 0, v96
  v_exp_f32 v157, v157 clamp
  v_max_f32 v97, 0, v97
  v_pk_add_f32 v[96:97], v[96:97], s[76:77]
  v_pk_add_f32 v[96:97], v[96:97], v[156:157]
  v_cvt_pk_bf16_f32 v226, v96, v97
  buffer_load_dwordx4 v[108:111], v4, s[36:39], s92 offen offset:1024 sc1
  v_exp_f32 v158, v158 clamp
  v_max_f32 v98, 0, v98
  v_exp_f32 v159, v159 clamp
  v_max_f32 v99, 0, v99
  v_pk_add_f32 v[98:99], v[98:99], s[76:77]
  v_pk_add_f32 v[98:99], v[98:99], v[158:159]
  v_cvt_pk_bf16_f32 v227, v98, v99
  v_exp_f32 v160, v160 clamp
  v_max_f32 v100, 0, v100
  v_exp_f32 v161, v161 clamp
  v_max_f32 v101, 0, v101
  v_pk_add_f32 v[100:101], v[100:101], s[76:77]
  v_pk_add_f32 v[100:101], v[100:101], v[160:161]
  v_cvt_pk_bf16_f32 v228, v100, v101
  buffer_load_dwordx4 v36, s[32:35], s81 offen offset:0 lds
  v_permlane32_swap_b32 v200, v208
  v_permlane32_swap_b32 v204, v212
  v_permlane32_swap_b32 v201, v209
  v_permlane32_swap_b32 v205, v213
  buffer_load_dwordx4 v37, s[32:35], s81 offen offset:1024 lds
  v_permlane32_swap_b32 v202, v210
  v_permlane32_swap_b32 v206, v214
  v_permlane32_swap_b32 v203, v211
  buffer_load_dwordx4 v38, s[32:35], s81 offen offset:2048 lds
  v_permlane32_swap_b32 v207, v215
  v_permlane16_swap_b32 v200, v204
  v_permlane16_swap_b32 v208, v212
  buffer_load_dwordx4 v39, s[32:35], s81 offen offset:3072 lds
  s_add_u32 m0, s79, 108544
  v_permlane16_swap_b32 v201, v205
  v_permlane16_swap_b32 v209, v213
  v_permlane16_swap_b32 v202, v206
  buffer_load_dwordx4 v40, s[32:35], s81 offen lds
  s_lshl_b32 s81, s54, 7
  s_add_u32 s81, s81, s21
  s_sub_u32 s20, s20, s80
  s_add_u32 s20, s20, s79
  s_add_u32 m0, s20, 124928
  v_permlane16_swap_b32 v210, v214
  v_permlane16_swap_b32 v203, v207
  v_permlane16_swap_b32 v211, v215
  buffer_load_dwordx4 v41, s[32:35], s81 offen offset:0 lds
  v_permlane32_swap_b32 v220, v228
  v_permlane32_swap_b32 v224, v232
  v_permlane32_swap_b32 v221, v229
  v_permlane32_swap_b32 v225, v233
  buffer_load_dwordx4 v42, s[32:35], s81 offen offset:1024 lds
  v_permlane32_swap_b32 v222, v230
  v_permlane32_swap_b32 v226, v234
  v_permlane32_swap_b32 v223, v231
  buffer_load_dwordx4 v43, s[32:35], s81 offen offset:2048 lds
  v_permlane32_swap_b32 v227, v235
  v_permlane16_swap_b32 v220, v224
  v_permlane16_swap_b32 v228, v232
  buffer_load_dwordx4 v44, s[32:35], s81 offen offset:3072 lds
  s_add_u32 m0, s20, 129024
  v_permlane16_swap_b32 v221, v225
  v_permlane16_swap_b32 v229, v233
  v_permlane16_swap_b32 v222, v226
  buffer_load_dwordx4 v45, s[32:35], s81 offen lds
  v_permlane16_swap_b32 v230, v234
  v_permlane16_swap_b32 v223, v227
  v_permlane16_swap_b32 v231, v235
  s_waitcnt vmcnt(10)
  ds_write2_b32 v62, v104, v106 offset0:0 offset1:1
  ds_write2_b32 v63, v108, v110 offset0:0 offset1:1
  v_xor_b32 v7, s95, v105
  v_bitop3_b32 v7, v7, s95, v107 bitop3:0xf6
  v_bitop3_b32 v7, v7, s95, v109 bitop3:0xf6
  v_bitop3_b32 v7, v7, s95, v111 bitop3:0xf6
  v_cmp_ne_u32 vcc, 0, v7
  s_waitcnt lgkmcnt(0)
  s_cbranch_vccnz L_slow_agA
L_back_agA:
  s_barrier
  s_nop 0
  ds_read_b64_tr_b16 a[16:17], v11 offset:32
  ds_read_b64_tr_b16 a[18:19], v11 offset:192
  ds_read_b64_tr_b16 a[20:21], v12 offset:1952
  ds_read_b64_tr_b16 a[22:23], v12 offset:2112
  ds_read_b64_tr_b16 a[24:25], v13 offset:3872
  ds_read_b64_tr_b16 a[26:27], v13 offset:4032
  ds_read_b64_tr_b16 a[28:29], v14 offset:5792
  ds_read_b64_tr_b16 a[30:31], v14 offset:5952
  ds_read_b64_tr_b16 a[0:1], v10 offset:0
  ds_read_b64_tr_b16 a[2:3], v10 offset:160
  ds_read_b64_tr_b16 a[4:5], v10 offset:1920
  ds_read_b64_tr_b16 a[6:7], v10 offset:2080
  ds_read_b64_tr_b16 a[8:9], v10 offset:3840
  ds_read_b64_tr_b16 a[10:11], v10 offset:4000
  s_waitcnt lgkmcnt(10)
  v_mfma_f32_16x16x32_bf16 v[80:83], a[16:19], v[200:203], 0
  ds_read_b64_tr_b16 a[12:13], v10 offset:5760
  v_xor_b32 v7, s49, v116
  v_mfma_f32_16x16x32_bf16 v[100:103], a[16:19], v[220:223], 0
  ds_read_b64_tr_b16 a[14:15], v10 offset:5920
  v_cmp_lt_u32 vcc, 15, v7
  v_mfma_f32_16x16x32_bf16 v[80:83], a[20:23], v[204:207], v[80:83]
  v_mfma_f32_16x16x32_bf16 v[100:103], a[20:23], v[224:227], v[100:103]
  s_waitcnt lgkmcnt(8)
  v_mfma_f32_16x16x32_bf16 v[80:83], a[24:27], v[208:211], v[80:83]
  s_cbranch_vccnz L_slow_rfA
L_back_rfA:
  v_cmp_ne_u32 s[50:51], 0, v7
  v_mfma_f32_16x16x32_bf16 v[100:103], a[24:27], v[228:231], v[100:103]
  v_mfma_f32_16x16x32_bf16 v[80:83], a[28:31], v[212:215], v[80:83]
  v_mfma_f32_16x16x32_bf16 v[100:103], a[28:31], v[232:235], v[100:103]
  s_waitcnt lgkmcnt(4)
  v_mfma_f32_16x16x32_bf16 v[64:67], a[0:3], v[200:203], 0
  v_mfma_f32_16x16x32_bf16 v[84:87], a[0:3], v[220:223], 0
  v_mfma_f32_16x16x32_bf16 v[68:71], a[4:7], v[204:207], 0
  v_mfma_f32_16x16x32_bf16 v[88:91], a[4:7], v[224:227], 0
  s_waitcnt lgkmcnt(0)
  v_mfma_f32_16x16x32_bf16 v[72:75], a[8:11], v[208:211], 0
  v_add_f32 v82, s76, v82
  v_add_f32 v102, s76, v102
  v_mfma_f32_16x16x32_bf16 v[92:95], a[8:11], v[228:231], 0
  v_rcp_f32 v82, v82
  v_rcp_f32 v102, v102
  v_mfma_f32_16x16x32_bf16 v[76:79], a[12:15], v[212:215], 0
  v_mov_b32 v144, v82
  v_mov_b32 v145, v82
  v_mfma_f32_16x16x32_bf16 v[96:99], a[12:15], v[232:235], 0
  v_mov_b32 v148, v102
  v_mov_b32 v149, v102
  v_permlane16_swap_b32 v144, v145
  s_nop 0
  v_permlane16_swap_b32 v148, v149
  v_mov_b32 v146, v144
  v_mov_b32 v147, v145
  v_mov_b32 v150, v148
  v_mov_b32 v151, v149
  v_permlane32_swap_b32 v144, v146
  v_permlane32_swap_b32 v145, v147
  v_permlane32_swap_b32 v148, v150
  v_permlane32_swap_b32 v149, v151
  v_pk_mul_f32 v[64:65], v[64:65], v[144:145] op_sel:[0,0] op_sel_hi:[1,0]
  v_pk_mul_f32 v[66:67], v[66:67], v[144:145] op_sel:[0,0] op_sel_hi:[1,0]
  v_pk_mul_f32 v[68:69], v[68:69], v[144:145] op_sel:[0,1] op_sel_hi:[1,1]
  v_pk_mul_f32 v[70:71], v[70:71], v[144:145] op_sel:[0,1] op_sel_hi:[1,1]
  v_cvt_pk_bf16_f32 v104, v64, v65
  v_cvt_pk_bf16_f32 v105, v66, v67
  v_cvt_pk_bf16_f32 v106, v68, v69
  v_cvt_pk_bf16_f32 v107, v70, v71
  buffer_store_dwordx4 v[104:107], v46, s[36:39], s84 offen offset:0
  v_pk_mul_f32 v[84:85], v[84:85], v[148:149] op_sel:[0,0] op_sel_hi:[1,0]
  v_pk_mul_f32 v[86:87], v[86:87], v[148:149] op_sel:[0,0] op_sel_hi:[1,0]
  v_pk_mul_f32 v[88:89], v[88:89], v[148:149] op_sel:[0,1] op_sel_hi:[1,1]
  v_pk_mul_f32 v[90:91], v[90:91], v[148:149] op_sel:[0,1] op_sel_hi:[1,1]
  v_cvt_pk_bf16_f32 v108, v84, v85
  v_cvt_pk_bf16_f32 v109, v86, v87
  v_cvt_pk_bf16_f32 v110, v88, v89
  v_cvt_pk_bf16_f32 v111, v90, v91
  buffer_store_dwordx4 v[108:111], v46, s[36:39], s84 offen offset:2048
  v_pk_mul_f32 v[80:81], v[80:81], v[82:83] op_sel:[0,0] op_sel_hi:[1,0]
  v_cvt_pk_bf16_f32 v120, v80, v81
  buffer_store_dword v120, v54, s[36:39], s84 offen offset:0 sc1
  v_pk_mul_f32 v[100:101], v[100:101], v[102:103] op_sel:[0,0] op_sel_hi:[1,0]
  v_cvt_pk_bf16_f32 v124, v100, v101
  buffer_store_dword v124, v54, s[36:39], s84 offen offset:256 sc1
  v_pk_mul_f32 v[72:73], v[72:73], v[146:147] op_sel:[0,0] op_sel_hi:[1,0]
  v_pk_mul_f32 v[74:75], v[74:75], v[146:147] op_sel:[0,0] op_sel_hi:[1,0]
  v_pk_mul_f32 v[76:77], v[76:77], v[146:147] op_sel:[0,1] op_sel_hi:[1,1]
  v_pk_mul_f32 v[78:79], v[78:79], v[146:147] op_sel:[0,1] op_sel_hi:[1,1]
  v_cvt_pk_bf16_f32 v112, v72, v73
  v_cvt_pk_bf16_f32 v113, v74, v75
  v_cvt_pk_bf16_f32 v114, v76, v77
  v_cvt_pk_bf16_f32 v115, v78, v79
  buffer_store_dwordx4 v[112:115], v46, s[36:39], s84 offen offset:1024 sc1
  v_pk_mul_f32 v[92:93], v[92:93], v[150:151] op_sel:[0,0] op_sel_hi:[1,0]
  v_pk_mul_f32 v[94:95], v[94:95], v[150:151] op_sel:[0,0] op_sel_hi:[1,0]
  v_pk_mul_f32 v[96:97], v[96:97], v[150:151] op_sel:[0,1] op_sel_hi:[1,1]
  v_pk_mul_f32 v[98:99], v[98:99], v[150:151] op_sel:[0,1] op_sel_hi:[1,1]
  v_cvt_pk_bf16_f32 v116, v92, v93
  v_cvt_pk_bf16_f32 v117, v94, v95
  v_cvt_pk_bf16_f32 v118, v96, v97
  v_cvt_pk_bf16_f32 v119, v98, v99
  buffer_store_dwordx4 v[116:119], v46, s[36:39], s84 offen offset:3072 sc1
  s_cmp_lg_u64 s[50:51], 0
  s_cbranch_scc1 L_farA
L_nearA:
  s_and_b32 s63, s54, 1
  s_cbranch_scc0 L_noswA
  v_swap_b32 v104, v108
  v_swap_b32 v105, v109
  v_swap_b32 v106, v110
  v_swap_b32 v107, v111
  v_swap_b32 v112, v116
  v_swap_b32 v113, v117
  v_swap_b32 v114, v118
  v_swap_b32 v115, v119
  v_swap_b32 v120, v124
L_noswA:
  s_lshl_b32 s62, s63, 11
  s_lshl_b32 s63, s63, 8
  v_add_u32 v25, s62, v46
  v_xor_b32 v26, 2048, v25
  v_add_u32 v51, s63, v54
  v_xor_b32 v52, 256, v51
  s_waitcnt vmcnt(6)
  s_barrier
  s_mov_b32 s64, 0
L_redoA:
  ds_read_b64_tr_b16 v[144:145], v21 offset:0
  ds_read_b64_tr_b16 v[146:147], v22 offset:0
  ds_read_b64_tr_b16 v[148:149], v21 offset:32
  ds_read_b64_tr_b16 v[150:151], v22 offset:32
  ds_read_b64_tr_b16 v[152:153], v21 offset:64
  ds_read_b64_tr_b16 v[154:155], v22 offset:64
  ds_read_b64_tr_b16 v[156:157], v21 offset:96
  ds_read_b64_tr_b16 v[158:159], v22 offset:96
  s_waitcnt lgkmcnt(4)
  v_mfma_f32_16x16x32_bf16 v[64:67], v[144:147], v[104:107], 0
  ds_read_b64_tr_b16 v[160:161], v21 offset:128
  buffer_load_dwordx4 v[176:179], v26, s[36:39], s85 offen offset:0 sc1
  v_mfma_f32_16x16x32_bf16 v[84:87], v[144:147], v[108:111], 0
  ds_read_b64_tr_b16 v[162:163], v22 offset:128
  ds_read_b64_tr_b16 a[0:1], v21 offset:15360
  ds_read_b64_tr_b16 a[2:3], v22 offset:15360
  v_mfma_f32_16x16x32_bf16 v[68:71], v[148:151], v[104:107], 0
  ds_read_b64_tr_b16 v[164:165], v21 offset:5120
  ds_read_b64_tr_b16 a[4:5], v21 offset:15392
  ds_read_b64_tr_b16 a[6:7], v22 offset:15392
  v_mfma_f32_16x16x32_bf16 v[88:91], v[148:151], v[108:111], 0
  ds_read_b64_tr_b16 v[166:167], v22 offset:5120
  s_waitcnt lgkmcnt(8)
  v_mfma_f32_16x16x32_bf16 v[72:75], v[152:155], v[104:107], 0
  ds_read_b64_tr_b16 v[168:169], v21 offset:5152
  buffer_load_dwordx4 v[136:139], v25, s[36:39], s85 offen offset:0 sc1
  v_mfma_f32_16x16x32_bf16 v[92:95], v[152:155], v[108:111], 0
  ds_read_b64_tr_b16 v[170:171], v22 offset:5152
  ds_read_b64_tr_b16 a[8:9], v21 offset:15424
  ds_read_b64_tr_b16 a[10:11], v22 offset:15424
  v_mfma_f32_16x16x32_bf16 v[76:79], v[156:159], v[104:107], 0
  ds_read_b64_tr_b16 v[172:173], v21 offset:5184
  ds_read_b64_tr_b16 a[12:13], v21 offset:15456
  ds_read_b64_tr_b16 a[14:15], v22 offset:15456
  v_mfma_f32_16x16x32_bf16 v[96:99], v[156:159], v[108:111], 0
  ds_read_b64_tr_b16 v[174:175], v22 offset:5184
  s_waitcnt lgkmcnt(8)
  v_mfma_f32_16x16x32_bf16 v[80:83], v[160:163], v[104:107], 0
  ds_read_b64_tr_b16 v[144:145], v21 offset:5216
  buffer_load_dwordx4 v[192:195], v26, s[36:39], s86 offen offset:0 sc1
  ds_read_b64_tr_b16 v[146:147], v22 offset:5216
  v_mfma_f32_16x16x32_bf16 v[64:67], v[164:167], v[112:115], v[64:67]
  ds_read_b64_tr_b16 v[148:149], v21 offset:5248
  ds_read_b64_tr_b16 a[16:17], v21 offset:15488
  ds_read_b64_tr_b16 a[18:19], v22 offset:15488
  v_mfma_f32_16x16x32_bf16 v[84:87], v[164:167], v[116:119], v[84:87]
  ds_read_b64_tr_b16 v[150:151], v22 offset:5248
  s_waitcnt lgkmcnt(6)
  v_mfma_f32_16x16x32_bf16 v[68:71], v[168:171], v[112:115], v[68:71]
  ds_read_b64_tr_b16 v[152:153], v21 offset:10240
  buffer_load_dwordx4 v[184:187], v25, s[36:39], s86 offen offset:0 sc1
  v_mfma_f32_16x16x32_bf16 v[88:91], v[168:171], v[116:119], v[88:91]
  ds_read_b64_tr_b16 v[154:155], v22 offset:10240
  ds_read_b64_tr_b16 a[20:21], v21 offset:25600
  ds_read_b64_tr_b16 a[22:23], v22 offset:25600
  v_mfma_f32_16x16x32_bf16 v[72:75], v[172:175], v[112:115], v[72:75]
  ds_read_b64_tr_b16 v[156:157], v21 offset:10272
  ds_read_b64_tr_b16 a[24:25], v21 offset:25632
  ds_read_b64_tr_b16 a[26:27], v22 offset:25632
  v_mfma_f32_16x16x32_bf16 v[92:95], v[172:175], v[116:119], v[92:95]
  ds_read_b64_tr_b16 v[158:159], v22 offset:10272
  s_waitcnt lgkmcnt(8)
  v_mfma_f32_16x16x32_bf16 v[76:79], v[144:147], v[112:115], v[76:79]
  ds_read_b64_tr_b16 v[160:161], v21 offset:10304
  buffer_load_dwordx4 v[208:211], v26, s[36:39], s87 offen offset:0 sc1
  v_mfma_f32_16x16x32_bf16 v[96:99], v[144:147], v[116:119], v[96:99]
  ds_read_b64_tr_b16 v[162:163], v22 offset:10304
  ds_read_b64_tr_b16 a[28:29], v21 offset:25664
  ds_read_b64_tr_b16 a[30:31], v22 offset:25664
  v_mfma_f32_16x16x32_bf16 v[80:83], v[148:151], v[112:115], v[80:83]
  ds_read_b64_tr_b16 v[164:165], v21 offset:10336
  ds_read_b64_tr_b16 v[166:167], v22 offset:10336
  ds_read_b64_tr_b16 a[32:33], v21 offset:25696
  ds_read_b64_tr_b16 a[34:35], v22 offset:25696
  buffer_load_dwordx4 v[200:203], v25, s[36:39], s87 offen offset:0 sc1
  ds_read_b64_tr_b16 a[36:37], v21 offset:25728
  ds_read_b64_tr_b16 a[38:39], v22 offset:25728
  ds_read_b64_tr_b16 a[40:41], v21 offset:35840
  ds_read_b64_tr_b16 a[42:43], v22 offset:35840
  buffer_load_dwordx4 v[224:227], v26, s[36:39], s88 offen offset:0 sc1
  ds_read_b64_tr_b16 a[44:45], v21 offset:35872
  ds_read_b64_tr_b16 a[46:47], v22 offset:35872
  ds_read_b64_tr_b16 a[48:49], v21 offset:35904
  ds_read_b64_tr_b16 a[50:51], v22 offset:35904
  buffer_load_dwordx4 v[216:219], v25, s[36:39], s88 offen offset:0 sc1
  s_nop 0
  ds_read_b64_tr_b16 a[52:53], v21 offset:35936
  ds_read_b64_tr_b16 a[54:55], v22 offset:35936
  ds_read_b64_tr_b16 a[56:57], v21 offset:35968
  ds_read_b64_tr_b16 a[58:59], v22 offset:35968
  ds_read_b64_tr_b16 a[60:61], v21 offset:46080
  ds_read_b64_tr_b16 a[62:63], v22 offset:46080
  buffer_load_dwordx4 v[240:243], v26, s[36:39], s89 offen offset:0 sc1
  ds_read_b64_tr_b16 a[64:65], v21 offset:46112
  ds_read_b64_tr_b16 a[66:67], v22 offset:46112
  ds_read_b64_tr_b16 a[68:69], v21 offset:46144
  ds_read_b64_tr_b16 a[70:71], v22 offset:46144
  buffer_load_dwordx4 v[232:235], v25, s[36:39], s89 offen offset:0 sc1
  ds_read_b64_tr_b16 a[72:73], v21 offset:46176
  ds_read_b64_tr_b16 a[74:75], v22 offset:46176
  ds_read_b64_tr_b16 a[76:77], v21 offset:46208
  ds_read_b64_tr_b16 a[78:79], v22 offset:46208
  s_waitcnt vmcnt(8)
  v_max3_u32 v7, v179, v139, v179
  v_cmp_eq_u32 vcc, -1, v7
  s_cbranch_vccnz L_slow_oa1A
L_back_oa1A:
  s_waitcnt lgkmcnt(15)
  v_mfma_f32_16x16x32_bf16 v[64:67], v[152:155], v[136:139], v[64:67]
  ds_read_b64_tr_b16 v[168:169], v21 offset:10368
  buffer_load_dwordx4 v[12:15], v26, s[36:39], s90 offen offset:0 sc1
  v_mfma_f32_16x16x32_bf16 v[84:87], v[152:155], v[176:179], v[84:87]
  ds_read_b64_tr_b16 v[170:171], v22 offset:10368
  v_mfma_f32_16x16x32_bf16 v[68:71], v[156:159], v[136:139], v[68:71]
  ds_read_b64_tr_b16 v[172:173], v21 offset:20480
  v_mfma_f32_16x16x32_bf16 v[88:91], v[156:159], v[176:179], v[88:91]
  ds_read_b64_tr_b16 v[174:175], v22 offset:20480
  v_mfma_f32_16x16x32_bf16 v[72:75], v[160:163], v[136:139], v[72:75]
  ds_read_b64_tr_b16 v[144:145], v21 offset:20512
  ds_read_b64_tr_b16 a[80:81], v21 offset:56320
  v_mfma_f32_16x16x32_bf16 v[92:95], v[160:163], v[176:179], v[92:95]
  ds_read_b64_tr_b16 v[146:147], v22 offset:20512
  buffer_load_dwordx4 v[248:251], v25, s[36:39], s90 offen offset:0 sc1
  v_mfma_f32_16x16x32_bf16 v[76:79], v[164:167], v[136:139], v[76:79]
  ds_read_b64_tr_b16 v[148:149], v21 offset:20544
  s_waitcnt vmcnt(6)
  v_mfma_f32_16x16x32_bf16 v[96:99], v[164:167], v[176:179], v[96:99]
  ds_read_b64_tr_b16 v[150:151], v22 offset:20544
  s_waitcnt lgkmcnt(5)
  v_mfma_f32_16x16x32_bf16 v[80:83], v[168:171], v[136:139], v[80:83]
  ds_read_b64_tr_b16 v[152:153], v21 offset:20576
  v_max3_u32 v7, v195, v187, v211
  ds_read_b64_tr_b16 v[154:155], v22 offset:20576
  v_max_u32 v7, v7, v203
  v_cmp_eq_u32 vcc, -1, v7
  s_cbranch_vccnz L_slow_oa2A
L_back_oa2A:
  v_mfma_f32_16x16x32_bf16 v[64:67], v[172:175], v[184:187], v[64:67]
  ds_read_b64_tr_b16 v[156:157], v21 offset:20608
  ds_read_b64_tr_b16 a[82:83], v22 offset:56320
  v_mfma_f32_16x16x32_bf16 v[84:87], v[172:175], v[192:195], v[84:87]
  ds_read_b64_tr_b16 v[158:159], v22 offset:20608
  s_waitcnt lgkmcnt(5)
  v_mfma_f32_16x16x32_bf16 v[68:71], v[144:147], v[184:187], v[68:71]
  ds_read_b64_tr_b16 v[160:161], v21 offset:30720
  ds_read_b64_tr_b16 a[84:85], v21 offset:56352
  v_mfma_f32_16x16x32_bf16 v[88:91], v[144:147], v[192:195], v[88:91]
  ds_read_b64_tr_b16 v[162:163], v22 offset:30720
  buffer_load_dwordx4 v[36:39], v26, s[36:39], s91 offen offset:0 sc1
  v_mfma_f32_16x16x32_bf16 v[72:75], v[148:151], v[184:187], v[72:75]
  ds_read_b64_tr_b16 v[164:165], v21 offset:30752
  ds_read_b64_tr_b16 a[86:87], v22 offset:56352
  v_mfma_f32_16x16x32_bf16 v[92:95], v[148:151], v[192:195], v[92:95]
  ds_read_b64_tr_b16 v[166:167], v22 offset:30752
  s_waitcnt lgkmcnt(6)
  v_mfma_f32_16x16x32_bf16 v[76:79], v[152:155], v[184:187], v[76:79]
  ds_read_b64_tr_b16 v[168:169], v21 offset:30784
  ds_read_b64_tr_b16 a[88:89], v21 offset:56384
  v_mfma_f32_16x16x32_bf16 v[96:99], v[152:155], v[192:195], v[96:99]
  ds_read_b64_tr_b16 v[170:171], v22 offset:30784
  buffer_load_dwordx4 v[28:31], v25, s[36:39], s91 offen offset:0 sc1
  v_mfma_f32_16x16x32_bf16 v[80:83], v[156:159], v[184:187], v[80:83]
  ds_read_b64_tr_b16 v[172:173], v21 offset:30816
  ds_read_b64_tr_b16 a[90:91], v22 offset:56384
  ds_read_b64_tr_b16 v[174:175], v22 offset:30816
  s_waitcnt lgkmcnt(6)
  v_mfma_f32_16x16x32_bf16 v[64:67], v[160:163], v[200:203], v[64:67]
  ds_read_b64_tr_b16 v[144:145], v21 offset:30848
  ds_read_b64_tr_b16 a[92:93], v21 offset:56416
  v_mfma_f32_16x16x32_bf16 v[84:87], v[160:163], v[208:211], v[84:87]
  ds_read_b64_tr_b16 v[146:147], v22 offset:30848
  buffer_load_dword v121, v51, s[36:39], s85 offen sc1
  v_mfma_f32_16x16x32_bf16 v[68:71], v[164:167], v[200:203], v[68:71]
  ds_read_b64_tr_b16 v[148:149], v21 offset:40960
  buffer_load_dword v125, v52, s[36:39], s85 offen sc1
  v_mfma_f32_16x16x32_bf16 v[88:91], v[164:167], v[208:211], v[88:91]
  ds_read_b64_tr_b16 v[150:151], v22 offset:40960
  s_waitcnt lgkmcnt(5)
  v_mfma_f32_16x16x32_bf16 v[72:75], v[168:171], v[200:203], v[72:75]
  ds_read_b64_tr_b16 v[152:153], v21 offset:40992
  ds_read_b64_tr_b16 a[94:95], v22 offset:56416
  v_mfma_f32_16x16x32_bf16 v[92:95], v[168:171], v[208:211], v[92:95]
  ds_read_b64_tr_b16 v[154:155], v22 offset:40992
  buffer_load_dword v122, v51, s[36:39], s86 offen sc1
  v_mfma_f32_16x16x32_bf16 v[76:79], v[172:175], v[200:203], v[76:79]
  ds_read_b64_tr_b16 v[156:157], v21 offset:41024
  s_waitcnt vmcnt(7)
  v_mfma_f32_16x16x32_bf16 v[96:99], v[172:175], v[208:211], v[96:99]
  ds_read_b64_tr_b16 v[158:159], v22 offset:41024
  buffer_load_dword v126, v52, s[36:39], s86 offen sc1
  s_waitcnt lgkmcnt(5)
  v_mfma_f32_16x16x32_bf16 v[80:83], v[144:147], v[200:203], v[80:83]
  ds_read_b64_tr_b16 v[160:161], v21 offset:41056
  v_max3_u32 v7, v227, v219, v243
  ds_read_b64_tr_b16 v[162:163], v22 offset:41056
  v_max_u32 v7, v7, v235
  v_cmp_eq_u32 vcc, -1, v7
  ds_read_b64_tr_b16 a[96:97], v21 offset:56448
  buffer_load_dword v123, v51, s[36:39], s87 offen sc1
  buffer_load_dword v127, v52, s[36:39], s87 offen sc1
  s_cbranch_vccnz L_slow_oa4A
L_back_oa4A:
  v_mfma_f32_16x16x32_bf16 v[64:67], v[148:151], v[216:219], v[64:67]
  ds_read_b64_tr_b16 v[164:165], v21 offset:41088
L_tp9:
  s_cbranch_execz L_tret1
  ds_read_b64_tr_b16 a[98:99], v22 offset:56448
  v_mfma_f32_16x16x32_bf16 v[84:87], v[148:151], v[224:227], v[84:87]
  ds_read_b64_tr_b16 v[166:167], v22 offset:41088
  buffer_load_dword v128, v51, s[36:39], s88 offen sc1
  buffer_load_dword v132, v52, s[36:39], s88 offen sc1
  s_waitcnt lgkmcnt(6)
  v_mfma_f32_16x16x32_bf16 v[68:71], v[152:155], v[216:219], v[68:71]
  ds_read_b64_tr_b16 v[168:169], v21 offset:51200
  ds_read_b64_tr_b16 a[100:101], v23 offset:5120
  v_mfma_f32_16x16x32_bf16 v[88:91], v[152:155], v[224:227], v[88:91]
  ds_read_b64_tr_b16 v[170:171], v22 offset:51200
  buffer_load_dword v129, v51, s[36:39], s89 offen sc1
  buffer_load_dword v133, v52, s[36:39], s89 offen sc1
  v_mfma_f32_16x16x32_bf16 v[72:75], v[156:159], v[216:219], v[72:75]
  ds_read_b64_tr_b16 v[172:173], v21 offset:51232
  ds_read_b64_tr_b16 a[102:103], v24 offset:5120
  v_mfma_f32_16x16x32_bf16 v[92:95], v[156:159], v[224:227], v[92:95]
  ds_read_b64_tr_b16 v[174:175], v22 offset:51232
  buffer_load_dword v130, v51, s[36:39], s90 offen sc1
  buffer_load_dword v134, v52, s[36:39], s90 offen sc1
  s_waitcnt lgkmcnt(6)
  v_mfma_f32_16x16x32_bf16 v[76:79], v[160:163], v[216:219], v[76:79]
  ds_read_b64_tr_b16 v[144:145], v21 offset:51264
  buffer_load_dword v131, v51, s[36:39], s91 offen sc1
  v_mfma_f32_16x16x32_bf16 v[96:99], v[160:163], v[224:227], v[96:99]
  ds_read_b64_tr_b16 v[146:147], v22 offset:51264
  buffer_load_dword v135, v52, s[36:39], s91 offen sc1
  v_mfma_f32_16x16x32_bf16 v[80:83], v[164:167], v[216:219], v[80:83]
  ds_read_b64_tr_b16 v[148:149], v21 offset:51296
  ds_read_b64_tr_b16 a[104:105], v23 offset:5152
  ds_read_b64_tr_b16 v[150:151], v22 offset:51296
  buffer_load_dwordx4 v[140:143], v25, s[36:39], s85 offen offset:1024 sc1
  s_waitcnt lgkmcnt(5)
  v_mfma_f32_16x16x32_bf16 v[64:67], v[168:171], v[232:235], v[64:67]
  ds_read_b64_tr_b16 v[152:153], v21 offset:51328
  ds_read_b64_tr_b16 a[106:107], v24 offset:5152
  v_mfma_f32_16x16x32_bf16 v[84:87], v[168:171], v[240:243], v[84:87]
  ds_read_b64_tr_b16 v[154:155], v22 offset:51328
  ds_read_b64_tr_b16 a[108:109], v23 offset:5184
  v_mfma_f32_16x16x32_bf16 v[68:71], v[172:175], v[232:235], v[68:71]
  ds_read_b64_tr_b16 v[156:157], v23 offset:0
  buffer_load_dwordx4 v[188:191], v25, s[36:39], s86 offen offset:1024 sc1
  v_mfma_f32_16x16x32_bf16 v[88:91], v[172:175], v[240:243], v[88:91]
  ds_read_b64_tr_b16 v[158:159], v24 offset:0
  s_waitcnt lgkmcnt(6)
  v_mfma_f32_16x16x32_bf16 v[72:75], v[144:147], v[232:235], v[72:75]
  ds_read_b64_tr_b16 v[160:161], v23 offset:32
  ds_read_b64_tr_b16 a[110:111], v24 offset:5184
  v_mfma_f32_16x16x32_bf16 v[92:95], v[144:147], v[240:243], v[92:95]
  ds_read_b64_tr_b16 v[162:163], v24 offset:32
  ds_read_b64_tr_b16 a[112:113], v23 offset:5216
  v_mfma_f32_16x16x32_bf16 v[76:79], v[148:151], v[232:235], v[76:79]
  ds_read_b64_tr_b16 v[164:165], v23 offset:64
  s_waitcnt vmcnt(16)
  v_mfma_f32_16x16x32_bf16 v[96:99], v[148:151], v[240:243], v[96:99]
  ds_read_b64_tr_b16 v[166:167], v24 offset:64
  buffer_load_dwordx4 v[204:207], v25, s[36:39], s87 offen offset:1024 sc1
  s_waitcnt lgkmcnt(6)
  v_mfma_f32_16x16x32_bf16 v[80:83], v[152:155], v[232:235], v[80:83]
  ds_read_b64_tr_b16 v[168:169], v23 offset:96
  v_max3_u32 v7, v15, v251, v39
  ds_read_b64_tr_b16 v[170:171], v24 offset:96
  v_max_u32 v7, v7, v31
  v_cmp_eq_u32 vcc, -1, v7
  ds_read_b64_tr_b16 a[114:115], v24 offset:5216
  s_cbranch_vccnz L_slow_oa6A
L_back_oa6A:
  v_mfma_f32_16x16x32_bf16 v[64:67], v[156:159], v[248:251], v[64:67]
  ds_read_b64_tr_b16 v[172:173], v23 offset:128
  buffer_load_dwordx4 v[220:223], v25, s[36:39], s88 offen offset:1024 sc1
  v_mfma_f32_16x16x32_bf16 v[84:87], v[156:159], v[12:15], v[84:87]
  ds_read_b64_tr_b16 v[174:175], v24 offset:128
  s_waitcnt lgkmcnt(5)
  v_mfma_f32_16x16x32_bf16 v[68:71], v[160:163], v[248:251], v[68:71]
  ds_read_b64_tr_b16 v[144:145], v23 offset:10240
  ds_read_b64_tr_b16 a[116:117], v23 offset:5248
  v_mfma_f32_16x16x32_bf16 v[88:91], v[160:163], v[12:15], v[88:91]
  ds_read_b64_tr_b16 v[146:147], v24 offset:10240
  ds_read_b64_tr_b16 a[118:119], v24 offset:5248
  v_mfma_f32_16x16x32_bf16 v[72:75], v[164:167], v[248:251], v[72:75]
  ds_read_b64_tr_b16 v[148:149], v23 offset:10272
  ds_read_b64_tr_b16 a[120:121], v23 offset:15360
  v_mfma_f32_16x16x32_bf16 v[92:95], v[164:167], v[12:15], v[92:95]
  ds_read_b64_tr_b16 v[150:151], v24 offset:10272
  s_waitcnt lgkmcnt(7)
  v_mfma_f32_16x16x32_bf16 v[76:79], v[168:171], v[248:251], v[76:79]
  ds_read_b64_tr_b16 v[152:153], v23 offset:10304
  buffer_load_dwordx4 v[236:239], v25, s[36:39], s89 offen offset:1024 sc1
  v_mfma_f32_16x16x32_bf16 v[96:99], v[168:171], v[12:15], v[96:99]
  ds_read_b64_tr_b16 v[154:155], v24 offset:10304
  ds_read_b64_tr_b16 a[122:123], v24 offset:15360
  v_mfma_f32_16x16x32_bf16 v[80:83], v[172:175], v[248:251], v[80:83]
  ds_read_b64_tr_b16 v[156:157], v23 offset:10336
  ds_read_b64_tr_b16 a[124:125], v23 offset:15392
  ds_read_b64_tr_b16 v[158:159], v24 offset:10336
  s_waitcnt lgkmcnt(6)
  v_mfma_f32_16x16x32_bf16 v[64:67], v[144:147], v[28:31], v[64:67]
  ds_read_b64_tr_b16 v[160:161], v23 offset:10368
  buffer_load_dwordx4 v[252:255], v25, s[36:39], s90 offen offset:1024 sc1
  v_mfma_f32_16x16x32_bf16 v[84:87], v[144:147], v[36:39], v[84:87]
  ds_read_b64_tr_b16 v[162:163], v24 offset:10368
  ds_read_b64_tr_b16 a[126:127], v24 offset:15392
  v_mfma_f32_16x16x32_bf16 v[68:71], v[148:151], v[28:31], v[68:71]
  ds_read_b64_tr_b16 v[164:165], v23 offset:20480
  buffer_load_dwordx4 v[32:35], v25, s[36:39], s91 offen offset:1024 sc1
  v_mfma_f32_16x16x32_bf16 v[88:91], v[148:151], v[36:39], v[88:91]
  ds_read_b64_tr_b16 v[166:167], v24 offset:20480
  s_waitcnt lgkmcnt(5)
  v_mfma_f32_16x16x32_bf16 v[72:75], v[152:155], v[28:31], v[72:75]
  ds_read_b64_tr_b16 v[168:169], v23 offset:20512
  s_waitcnt vmcnt(15)
  v_mfma_f32_16x16x32_bf16 v[92:95], v[152:155], v[36:39], v[92:95]
  ds_read_b64_tr_b16 v[170:171], v24 offset:20512
  v_max3_u32 v7, v121, v125, v122
  v_mfma_f32_16x16x32_bf16 v[76:79], v[156:159], v[28:31], v[76:79]
  ds_read_b64_tr_b16 v[172:173], v23 offset:20544
  v_max3_u32 v7, v7, v126, v123
  v_mfma_f32_16x16x32_bf16 v[96:99], v[156:159], v[36:39], v[96:99]
  ds_read_b64_tr_b16 v[174:175], v24 offset:20544
  ds_read_b64_tr_b16 a[128:129], v23 offset:15424
  s_waitcnt lgkmcnt(5)
  v_mfma_f32_16x16x32_bf16 v[80:83], v[160:163], v[28:31], v[80:83]
  ds_read_b64_tr_b16 v[144:145], v23 offset:20576
  v_max_u32 v7, v7, v127
  ds_read_b64_tr_b16 v[146:147], v24 offset:20576
  v_cmp_eq_u32 vcc, -1, v7
  ds_read_b64_tr_b16 a[130:131], v24 offset:15424
  buffer_load_dwordx4 v[180:183], v26, s[36:39], s85 offen offset:1024 sc1
  s_cbranch_vccnz L_slow_ol0A
L_back_ol0A:
  v_mfma_f32_16x16x32_bf16 v[64:67], v[164:167], v[120:123], v[64:67]
  ds_read_b64_tr_b16 v[148:149], v23 offset:20608
  ds_read_b64_tr_b16 a[132:133], v23 offset:15456
  v_mfma_f32_16x16x32_bf16 v[84:87], v[164:167], v[124:127], v[84:87]
  ds_read_b64_tr_b16 v[150:151], v24 offset:20608
  s_waitcnt lgkmcnt(7)
  v_mfma_f32_16x16x32_bf16 v[68:71], v[168:171], v[120:123], v[68:71]
  ds_read_b64_tr_b16 v[152:153], v23 offset:25600
  ds_read_b64_tr_b16 a[134:135], v24 offset:15456
  v_mfma_f32_16x16x32_bf16 v[88:91], v[168:171], v[124:127], v[88:91]
  ds_read_b64_tr_b16 v[154:155], v24 offset:25600
  ds_read_b64_tr_b16 a[136:137], v23 offset:15488
  v_mfma_f32_16x16x32_bf16 v[72:75], v[172:175], v[120:123], v[72:75]
  ds_read_b64_tr_b16 v[156:157], v23 offset:25632
  s_waitcnt vmcnt(8)
  v_mfma_f32_16x16x32_bf16 v[92:95], v[172:175], v[124:127], v[92:95]
  ds_read_b64_tr_b16 v[158:159], v24 offset:25632
  buffer_load_dwordx4 v[196:199], v26, s[36:39], s86 offen offset:1024 sc1
  s_waitcnt lgkmcnt(6)
  v_mfma_f32_16x16x32_bf16 v[76:79], v[144:147], v[120:123], v[76:79]
  ds_read_b64_tr_b16 v[160:161], v23 offset:25664
  v_max3_u32 v7, v128, v132, v129
  v_mfma_f32_16x16x32_bf16 v[96:99], v[144:147], v[124:127], v[96:99]
  ds_read_b64_tr_b16 v[162:163], v24 offset:25664
  v_max3_u32 v7, v7, v133, v130
  ds_read_b64_tr_b16 a[138:139], v24 offset:15488
  v_mfma_f32_16x16x32_bf16 v[80:83], v[148:151], v[120:123], v[80:83]
  ds_read_b64_tr_b16 v[164:165], v23 offset:25696
  v_max3_u32 v7, v7, v134, v131
  ds_read_b64_tr_b16 v[166:167], v24 offset:25696
  v_max_u32 v7, v7, v135
  v_cmp_eq_u32 vcc, -1, v7
  buffer_load_dwordx4 v[212:215], v26, s[36:39], s87 offen offset:1024 sc1
  s_cbranch_vccnz L_slow_ol1A
L_back_ol1A:
  s_waitcnt lgkmcnt(5)
  v_mfma_f32_16x16x32_bf16 v[64:67], v[152:155], v[128:131], v[64:67]
  ds_read_b64_tr_b16 v[168:169], v23 offset:25728
  buffer_load_dwordx4 v[228:231], v26, s[36:39], s88 offen offset:1024 sc1
  v_mfma_f32_16x16x32_bf16 v[84:87], v[152:155], v[132:135], v[84:87]
  ds_read_b64_tr_b16 v[170:171], v24 offset:25728
  buffer_load_dwordx4 v[244:247], v26, s[36:39], s89 offen offset:1024 sc1
  v_mfma_f32_16x16x32_bf16 v[68:71], v[156:159], v[128:131], v[68:71]
  v_mfma_f32_16x16x32_bf16 v[88:91], v[156:159], v[132:135], v[88:91]
  s_waitcnt lgkmcnt(2)
  v_mfma_f32_16x16x32_bf16 v[72:75], v[160:163], v[128:131], v[72:75]
  v_mfma_f32_16x16x32_bf16 v[92:95], v[160:163], v[132:135], v[92:95]
  v_mfma_f32_16x16x32_bf16 v[76:79], v[164:167], v[128:131], v[76:79]
  s_waitcnt vmcnt(10)
  v_max3_u32 v7, v143, v191, v143
  v_mfma_f32_16x16x32_bf16 v[96:99], v[164:167], v[132:135], v[96:99]
  v_cmp_eq_u32 vcc, -1, v7
  s_waitcnt lgkmcnt(0)
  v_mfma_f32_16x16x32_bf16 v[80:83], v[168:171], v[128:131], v[80:83]
  buffer_load_dwordx4 v[16:19], v26, s[36:39], s90 offen offset:1024 sc1
  s_waitcnt lgkmcnt(0)
  s_cbranch_vccnz L_slow_or00A
L_back_or00A:
  v_mfma_f32_16x16x32_bf16 v[64:67], a[0:3], v[140:143], v[64:67]
  buffer_load_dwordx4 v[40:43], v26, s[36:39], s91 offen offset:1024 sc1
  s_add_u32 s62, s79, 76800
  v_mfma_f32_16x16x32_bf16 v[68:71], a[4:7], v[140:143], v[68:71]
  v_mul_u32_u24 v1, 144, v48
  v_lshl_add_u32 v1, v47, 3, v1
  v_mfma_f32_16x16x32_bf16 v[72:75], a[8:11], v[140:143], v[72:75]
  v_add_u32 v55, s62, v1
  v_lshlrev_b32 v1, 5, v48
  v_mfma_f32_16x16x32_bf16 v[76:79], a[12:15], v[140:143], v[76:79]
  v_lshl_add_u32 v1, v47, 3, v1
  v_mfma_f32_16x16x32_bf16 v[80:83], a[16:19], v[140:143], v[80:83]
  v_add_u32 v56, s62, v1
  v_lshrrev_b32 v1, 3, v0
  v_mfma_f32_16x16x32_bf16 v[64:67], a[20:23], v[188:191], v[64:67]
  v_lshl_add_u32 v2, v1, 4, v46
  v_mfma_f32_16x16x32_bf16 v[68:71], a[24:27], v[188:191], v[68:71]
  s_waitcnt vmcnt(7)
  v_max3_u32 v7, v207, v223, v239
  v_mfma_f32_16x16x32_bf16 v[72:75], a[28:31], v[188:191], v[72:75]
  v_max3_u32 v7, v7, v255, v35
  v_cmp_eq_u32 vcc, -1, v7
  v_mfma_f32_16x16x32_bf16 v[76:79], a[32:35], v[188:191], v[76:79]
  v_add_u32 v57, s62, v2
  v_add_u32 v58, s62, v46
  v_mfma_f32_16x16x32_bf16 v[80:83], a[36:39], v[188:191], v[80:83]
  s_cbranch_vccnz L_slow_or02A
L_back_or02A:
  v_mfma_f32_16x16x32_bf16 v[64:67], a[40:43], v[204:207], v[64:67]
  v_mul_u32_u24 v1, 2176, v1
  v_add_u32 v60, v1, v46
  v_mfma_f32_16x16x32_bf16 v[68:71], a[44:47], v[204:207], v[68:71]
  v_lshrrev_b32 v1, 1, v0
  v_mul_u32_u24 v1, 2272, v1
  v_mfma_f32_16x16x32_bf16 v[72:75], a[48:51], v[204:207], v[72:75]
  v_add_u32 v59, v1, v46
  s_and_b32 s63, s54, 1
  v_mfma_f32_16x16x32_bf16 v[76:79], a[52:55], v[204:207], v[76:79]
  s_mul_i32 s63, s63, 36864
  s_add_u32 s62, s94, s63
  v_mfma_f32_16x16x32_bf16 v[80:83], a[56:59], v[204:207], v[80:83]
  s_lshl_b32 s65, s54, 7
  s_add_u32 s44, s62, s65
  v_mfma_f32_16x16x32_bf16 v[64:67], a[60:63], v[220:223], v[64:67]
  s_add_u32 s45, s44, 18432
  v_mfma_f32_16x16x32_bf16 v[68:71], a[64:67], v[220:223], v[68:71]
  s_xor_b32 s63, s63, 36864
  s_add_u32 s63, s63, s94
  v_mfma_f32_16x16x32_bf16 v[72:75], a[68:71], v[220:223], v[72:75]
  s_add_u32 s46, s63, s65
  v_mfma_f32_16x16x32_bf16 v[76:79], a[72:75], v[220:223], v[76:79]
  s_add_u32 s47, s46, 18432
  s_lshr_b32 s65, s54, 1
  v_mfma_f32_16x16x32_bf16 v[80:83], a[76:79], v[220:223], v[80:83]
  s_lshl_b32 s65, s65, 5
  v_mfma_f32_16x16x32_bf16 v[64:67], a[80:83], v[236:239], v[64:67]
  s_add_u32 s65, s65, 1024
  s_add_u32 s62, s62, s65
  v_mfma_f32_16x16x32_bf16 v[68:71], a[84:87], v[236:239], v[68:71]
  v_mfma_f32_16x16x32_bf16 v[72:75], a[88:91], v[236:239], v[72:75]
  v_mfma_f32_16x16x32_bf16 v[76:79], a[92:95], v[236:239], v[76:79]
  v_mfma_f32_16x16x32_bf16 v[80:83], a[96:99], v[236:239], v[80:83]
  v_mfma_f32_16x16x32_bf16 v[64:67], a[100:103], v[252:255], v[64:67]
  v_mfma_f32_16x16x32_bf16 v[68:71], a[104:107], v[252:255], v[68:71]
  v_mfma_f32_16x16x32_bf16 v[72:75], a[108:111], v[252:255], v[72:75]
  v_mfma_f32_16x16x32_bf16 v[76:79], a[112:115], v[252:255], v[76:79]
  v_mfma_f32_16x16x32_bf16 v[80:83], a[116:119], v[252:255], v[80:83]
  v_mfma_f32_16x16x32_bf16 v[64:67], a[120:123], v[32:35], v[64:67]
  s_waitcnt vmcnt(0)
  v_max3_u32 v7, v183, v199, v215
  v_mfma_f32_16x16x32_bf16 v[68:71], a[124:127], v[32:35], v[68:71]
  v_max3_u32 v7, v7, v231, v247
  v_max3_u32 v7, v7, v19, v43
  v_mfma_f32_16x16x32_bf16 v[72:75], a[128:131], v[32:35], v[72:75]
  v_cmp_eq_u32 vcc, -1, v7
  v_mfma_f32_16x16x32_bf16 v[76:79], a[132:135], v[32:35], v[76:79]
  v_mfma_f32_16x16x32_bf16 v[80:83], a[136:139], v[32:35], v[80:83]
  s_cbranch_vccnz L_slow_or10A
L_back_or10A:
  v_mfma_f32_16x16x32_bf16 v[84:87], a[0:3], v[180:183], v[84:87]
  v_cmp_u_f32 vcc, v64, v68
  v_cvt_pk_bf16_f32 v176, v64, v65
  v_cvt_pk_bf16_f32 v177, v66, v67
  v_mfma_f32_16x16x32_bf16 v[88:91], a[4:7], v[180:183], v[88:91]
  v_mfma_f32_16x16x32_bf16 v[92:95], a[8:11], v[180:183], v[92:95]
  s_cbranch_vccnz L_again0A
L_done0A:
  v_mfma_f32_16x16x32_bf16 v[96:99], a[12:15], v[180:183], v[96:99]
  ds_write_b64 v55, v[176:177] offset:0
  v_mfma_f32_16x16x32_bf16 v[84:87], a[20:23], v[196:199], v[84:87]
  v_cvt_pk_bf16_f32 v178, v68, v69
  v_cvt_pk_bf16_f32 v179, v70, v71
  v_mfma_f32_16x16x32_bf16 v[88:91], a[24:27], v[196:199], v[88:91]
  ds_write_b64 v55, v[178:179] offset:32
  v_mfma_f32_16x16x32_bf16 v[92:95], a[28:31], v[196:199], v[92:95]
  v_cvt_pk_bf16_f32 v192, v72, v73
  v_cvt_pk_bf16_f32 v193, v74, v75
  v_mfma_f32_16x16x32_bf16 v[96:99], a[32:35], v[196:199], v[96:99]
  ds_write_b64 v55, v[192:193] offset:64
  v_mfma_f32_16x16x32_bf16 v[84:87], a[40:43], v[212:215], v[84:87]
  v_cvt_pk_bf16_f32 v194, v76, v77
  v_cvt_pk_bf16_f32 v195, v78, v79
  v_mfma_f32_16x16x32_bf16 v[88:91], a[44:47], v[212:215], v[88:91]
  ds_write_b64 v55, v[194:195] offset:96
  v_mfma_f32_16x16x32_bf16 v[92:95], a[48:51], v[212:215], v[92:95]
  v_cvt_pk_bf16_f32 v208, v80, v81
  v_cvt_pk_bf16_f32 v209, v82, v83
  v_mfma_f32_16x16x32_bf16 v[96:99], a[52:55], v[212:215], v[96:99]
  ds_write_b64 v56, v[208:209] offset:4608
  v_mfma_f32_16x16x32_bf16 v[84:87], a[60:63], v[228:231], v[84:87]
  ds_read_b128 v[136:139], v57 offset:0
  ds_read_b128 v[184:187], v57 offset:1152
  v_mfma_f32_16x16x32_bf16 v[88:91], a[64:67], v[228:231], v[88:91]
  ds_read_b128 v[232:235], v58 offset:4608
  v_mfma_f32_16x16x32_bf16 v[92:95], a[68:71], v[228:231], v[92:95]
  v_mfma_f32_16x16x32_bf16 v[96:99], a[72:75], v[228:231], v[96:99]
  v_mfma_f32_16x16x32_bf16 v[84:87], a[80:83], v[244:247], v[84:87]
  v_mfma_f32_16x16x32_bf16 v[88:91], a[84:87], v[244:247], v[88:91]
  v_mfma_f32_16x16x32_bf16 v[92:95], a[88:91], v[244:247], v[92:95]
  s_waitcnt lgkmcnt(0)
  buffer_store_dwordx4 v[136:139], v60, s[40:43], s44 offen nt
  v_mfma_f32_16x16x32_bf16 v[96:99], a[92:95], v[244:247], v[96:99]
  v_mfma_f32_16x16x32_bf16 v[84:87], a[100:103], v[16:19], v[84:87]
  v_mfma_f32_16x16x32_bf16 v[88:91], a[104:107], v[16:19], v[88:91]
  v_mfma_f32_16x16x32_bf16 v[92:95], a[108:111], v[16:19], v[92:95]
  v_mfma_f32_16x16x32_bf16 v[96:99], a[112:115], v[16:19], v[96:99]
  v_mfma_f32_16x16x32_bf16 v[84:87], a[120:123], v[40:43], v[84:87]
  v_mfma_f32_16x16x32_bf16 v[88:91], a[124:127], v[40:43], v[88:91]
  v_mfma_f32_16x16x32_bf16 v[92:95], a[128:131], v[40:43], v[92:95]
  buffer_store_dwordx4 v[184:187], v60, s[40:43], s45 offen nt
  v_mfma_f32_16x16x32_bf16 v[96:99], a[132:135], v[40:43], v[96:99]
  s_nop 4
  v_cmp_u_f32 vcc, v84, v88
  s_cbranch_vccnz L_again1A
L_done1A:
  v_cvt_pk_bf16_f32 v224, v84, v85
  v_cvt_pk_bf16_f32 v225, v86, v87
  ds_write_b64 v55, v[224:225] offset:2304
  v_cvt_pk_bf16_f32 v226, v88, v89
  v_cvt_pk_bf16_f32 v227, v90, v91
  ds_write_b64 v55, v[226:227] offset:2336
  v_cvt_pk_bf16_f32 v240, v92, v93
  v_cvt_pk_bf16_f32 v241, v94, v95
  ds_write_b64 v55, v[240:241] offset:2368
  v_cvt_pk_bf16_f32 v242, v96, v97
  v_cvt_pk_bf16_f32 v243, v98, v99
  ds_write_b64 v55, v[242:243] offset:2400
  ds_read_b128 v[200:203], v57 offset:2304
  ds_read_b128 v[216:219], v57 offset:3456
  s_mov_b32 exec_hi, 0
  buffer_store_dwordx4 v[232:235], v59, s[40:43], s62 offen
  s_mov_b32 exec_hi, -1
  s_waitcnt lgkmcnt(1)
  buffer_store_dwordx4 v[200:203], v60, s[40:43], s46 offen nt
  s_waitcnt lgkmcnt(0)
  buffer_store_dwordx4 v[216:219], v60, s[40:43], s47 offen nt
L_notouchA:
  s_endpgm
L_slow_rsA:
L_sp_rsA:
  buffer_load_dwordx4 v[128:131], v46, s[36:39], s69 offen offset:0 sc1
  buffer_load_dwordx4 v[132:135], v46, s[36:39], s69 offen offset:1024 sc1
  buffer_load_dwordx4 v[136:139], v46, s[36:39], s69 offen offset:2048 sc1
  buffer_load_dwordx4 v[140:143], v46, s[36:39], s69 offen offset:3072 sc1
  s_waitcnt vmcnt(0)
  v_xor_b32 v128, s82, v128
  v_xor_b32 v129, s82, v129
  v_xor_b32 v130, s82, v130
  v_xor_b32 v131, s82, v131
  v_xor_b32 v132, s82, v132
  v_xor_b32 v133, s82, v133
  v_xor_b32 v134, s82, v134
  v_xor_b32 v135, s82, v135
  v_xor_b32 v136, s82, v136
  v_xor_b32 v137, s82, v137
  v_xor_b32 v138, s82, v138
  v_xor_b32 v139, s82, v139
  v_xor_b32 v140, s82, v140
  v_xor_b32 v141, s82, v141
  v_xor_b32 v142, s82, v142
  v_xor_b32 v143, s82, v143
  v_or3_b32 v7, v128, v129, v130
  v_or3_b32 v7, v7, v131, v132
  v_or3_b32 v7, v7, v133, v134
  v_or3_b32 v7, v7, v135, v136
  v_or3_b32 v7, v7, v137, v138
  v_or3_b32 v7, v7, v139, v140
  v_or3_b32 v7, v7, v141, v142
  v_or_b32 v7, v7, v143
  v_and_b32 v7, 255, v7
  v_cmp_ne_u32 vcc, 0, v7
  s_add_u32 s72, s72, 1
  s_cmp_gt_u32 s72, 30000
  s_cbranch_scc1 L_back_rsA
  s_cbranch_vccnz L_sp_rsA
  s_branch L_back_rsA
L_slow_rbA:
L_sp_rbA:
  buffer_load_dwordx4 v[200:203], v46, s[36:39], s22 offen offset:0 sc1
  buffer_load_dwordx4 v[204:207], v46, s[36:39], s22 offen offset:1024 sc1
  buffer_load_dwordx4 v[208:211], v46, s[36:39], s22 offen offset:2048 sc1
  buffer_load_dwordx4 v[212:215], v46, s[36:39], s22 offen offset:3072 sc1
  s_waitcnt vmcnt(0)
  v_xor_b32 v200, s82, v200
  v_xor_b32 v201, s82, v201
  v_xor_b32 v202, s82, v202
  v_xor_b32 v203, s82, v203
  v_xor_b32 v204, s82, v204
  v_xor_b32 v205, s82, v205
  v_xor_b32 v206, s82, v206
  v_xor_b32 v207, s82, v207
  v_xor_b32 v208, s82, v208
  v_xor_b32 v209, s82, v209
  v_xor_b32 v210, s82, v210
  v_xor_b32 v211, s82, v211
  v_xor_b32 v212, s82, v212
  v_xor_b32 v213, s82, v213
  v_xor_b32 v214, s82, v214
  v_xor_b32_e64 v215, s82, v215
  v_or3_b32 v6, v200, v201, v202
  v_or3_b32 v6, v6, v203, v204
  v_or3_b32 v6, v6, v205, v206
  v_or3_b32 v6, v6, v207, v208
  v_or3_b32 v6, v6, v209, v210
  v_or3_b32 v6, v6, v211, v212
  v_or3_b32 v6, v6, v213, v214
  v_or_b32 v6, v6, v215
  v_and_b32 v6, 255, v6
  v_cmp_ne_u32 vcc, 0, v6
  s_add_u32 s72, s72, 1
  s_cmp_gt_u32 s72, 30000
  s_cbranch_scc1 L_back_rbA
  s_cbranch_vccnz L_sp_rbA
  s_branch L_back_rbA
L_slow_agA:
L_sp_agA:
  buffer_load_dwordx4 v[104:107], v46, s[36:39], s92 offen offset:0 sc1
  buffer_load_dwordx4 v[108:111], v4, s[36:39], s92 offen offset:1024 sc1
  s_waitcnt vmcnt(0)
  ds_write2_b32 v62, v104, v106 offset0:0 offset1:1
  ds_write2_b32 v63, v108, v110 offset0:0 offset1:1
  v_xor_b32 v7, s95, v105
  v_bitop3_b32 v7, v7, s95, v107 bitop3:0xf6
  v_bitop3_b32 v7, v7, s95, v109 bitop3:0xf6
  v_bitop3_b32 v7, v7, s95, v111 bitop3:0xf6
  v_cmp_ne_u32 vcc, 0, v7
  s_waitcnt lgkmcnt(0)
  s_add_u32 s72, s72, 1
  s_cmp_gt_u32 s72, 30000
  s_cbranch_scc1 L_back_agA
  s_cbranch_vccnz L_sp_agA
  s_branch L_back_agA
L_slow_rfA:
L_sp_rfA:
  buffer_load_dword v116, v5, s[36:39], s70 offen sc1
  s_waitcnt vmcnt(0)
  v_xor_b32 v7, s49, v116
  v_cmp_lt_u32 vcc, 15, v7
  s_add_u32 s72, s72, 1
  s_cmp_gt_u32 s72, 30000
  s_cbranch_scc1 L_back_rfA
  s_cbranch_vccnz L_sp_rfA
  s_branch L_back_rfA
L_farA:
  buffer_store_dwordx4 v[104:107], v46, s[36:39], s84 offen offset:0 sc1
  buffer_store_dwordx4 v[108:111], v46, s[36:39], s84 offen offset:2048 sc1
  buffer_store_dwordx4 v[112:115], v46, s[36:39], s84 offen offset:1024 sc1
  buffer_store_dwordx4 v[116:119], v46, s[36:39], s84 offen offset:3072 sc1
  buffer_store_dword v120, v54, s[36:39], s84 offen offset:0 sc1
  buffer_store_dword v124, v54, s[36:39], s84 offen offset:256 sc1
  s_waitcnt vmcnt(0)
  buffer_store_dword v8, v9, s[36:39], s70 offen offset:32 sc1
L_farpA:
  buffer_load_dword v7, v5, s[36:39], s70 offen offset:32 sc1
  s_waitcnt vmcnt(0)
  v_xor_b32 v7, s49, v7
  v_cmp_lt_u32 vcc, 15, v7
  s_add_u32 s72, s72, 1
  s_cmp_gt_u32 s72, 30000
  s_cbranch_scc1 L_nearA
  s_cbranch_vccnz L_farpA
  s_branch L_nearA
L_slow_oa1A:
L_sp_oa1A:
  buffer_load_dwordx4 v[176:179], v26, s[36:39], s85 offen offset:0 sc1
  buffer_load_dwordx4 v[136:139], v25, s[36:39], s85 offen offset:0 sc1
  s_waitcnt vmcnt(0)
  v_max3_u32 v7, v179, v139, v179
  v_cmp_eq_u32 vcc, -1, v7
  s_add_u32 s72, s72, 1
  s_cmp_gt_u32 s72, 30000
  s_cbranch_scc1 L_back_oa1A
  s_cbranch_vccnz L_sp_oa1A
  s_branch L_back_oa1A
L_slow_oa2A:
L_sp_oa2A:
  buffer_load_dwordx4 v[192:195], v26, s[36:39], s86 offen offset:0 sc1
  buffer_load_dwordx4 v[184:187], v25, s[36:39], s86 offen offset:0 sc1
  buffer_load_dwordx4 v[208:211], v26, s[36:39], s87 offen offset:0 sc1
  buffer_load_dwordx4 v[200:203], v25, s[36:39], s87 offen offset:0 sc1
  s_waitcnt vmcnt(0)
  v_max3_u32 v7, v195, v187, v211
  v_max_u32 v7, v7, v203
  v_cmp_eq_u32 vcc, -1, v7
  s_add_u32 s72, s72, 1
  s_cmp_gt_u32 s72, 30000
  s_cbranch_scc1 L_back_oa2A
  s_cbranch_vccnz L_sp_oa2A
  s_branch L_back_oa2A
L_slow_oa4A:
L_sp_oa4A:
  buffer_load_dwordx4 v[224:227], v26, s[36:39], s88 offen offset:0 sc1
  buffer_load_dwordx4 v[216:219], v25, s[36:39], s88 offen offset:0 sc1
  buffer_load_dwordx4 v[240:243], v26, s[36:39], s89 offen offset:0 sc1
  buffer_load_dwordx4 v[232:235], v25, s[36:39], s89 offen offset:0 sc1
  s_waitcnt vmcnt(0)
  v_max3_u32 v7, v227, v219, v243
  v_max_u32 v7, v7, v235
  v_cmp_eq_u32 vcc, -1, v7
  s_add_u32 s72, s72, 1
  s_cmp_gt_u32 s72, 30000
  s_cbranch_scc1 L_back_oa4A
  s_cbranch_vccnz L_sp_oa4A
  s_branch L_back_oa4A
L_slow_oa6A:
L_sp_oa6A:
  buffer_load_dwordx4 v[12:15], v26, s[36:39], s90 offen offset:0 sc1
  buffer_load_dwordx4 v[248:251], v25, s[36:39], s90 offen offset:0 sc1
  buffer_load_dwordx4 v[36:39], v26, s[36:39], s91 offen offset:0 sc1
  buffer_load_dwordx4 v[28:31], v25, s[36:39], s91 offen offset:0 sc1
  s_waitcnt vmcnt(0)
  v_max3_u32 v7, v15, v251, v39
  v_max_u32 v7, v7, v31
  v_cmp_eq_u32 vcc, -1, v7
  s_add_u32 s72, s72, 1
  s_cmp_gt_u32 s72, 30000
  s_cbranch_scc1 L_back_oa6A
  s_cbranch_vccnz L_sp_oa6A
  s_branch L_back_oa6A
L_slow_ol0A:
L_sp_ol0A:
  buffer_load_dword v121, v51, s[36:39], s85 offen sc1
  buffer_load_dword v125, v52, s[36:39], s85 offen sc1
  buffer_load_dword v122, v51, s[36:39], s86 offen sc1
  buffer_load_dword v126, v52, s[36:39], s86 offen sc1
  buffer_load_dword v123, v51, s[36:39], s87 offen sc1
  buffer_load_dword v127, v52, s[36:39], s87 offen sc1
  s_waitcnt vmcnt(0)
  v_max3_u32 v7, v121, v125, v122
  v_max3_u32 v7, v7, v126, v123
  v_max_u32 v7, v7, v127
  v_cmp_eq_u32 vcc, -1, v7
  s_add_u32 s72, s72, 1
  s_cmp_gt_u32 s72, 30000
  s_cbranch_scc1 L_back_ol0A
  s_cbranch_vccnz L_sp_ol0A
  s_branch L_back_ol0A
L_slow_ol1A:
L_sp_ol1A:
  buffer_load_dword v128, v51, s[36:39], s88 offen sc1
  buffer_load_dword v132, v52, s[36:39], s88 offen sc1
  buffer_load_dword v129, v51, s[36:39], s89 offen sc1
  buffer_load_dword v133, v52, s[36:39], s89 offen sc1
  buffer_load_dword v130, v51, s[36:39], s90 offen sc1
  buffer_load_dword v134, v52, s[36:39], s90 offen sc1
  buffer_load_dword v131, v51, s[36:39], s91 offen sc1
  buffer_load_dword v135, v52, s[36:39], s91 offen sc1
  s_waitcnt vmcnt(0)
  v_max3_u32 v7, v128, v132, v129
  v_max3_u32 v7, v7, v133, v130
  v_max3_u32 v7, v7, v134, v131
  v_max_u32 v7, v7, v135
  v_cmp_eq_u32 vcc, -1, v7
  s_add_u32 s72, s72, 1
  s_cmp_gt_u32 s72, 30000
  s_cbranch_scc1 L_back_ol1A
  s_cbranch_vccnz L_sp_ol1A
  s_branch L_back_ol1A
L_slow_or00A:
L_sp_or00A:
  buffer_load_dwordx4 v[140:143], v25, s[36:39], s85 offen offset:1024 sc1
  buffer_load_dwordx4 v[188:191], v25, s[36:39], s86 offen offset:1024 sc1
  s_waitcnt vmcnt(0)
  v_max3_u32 v7, v143, v191, v143
  v_cmp_eq_u32 vcc, -1, v7
  s_add_u32 s72, s72, 1
  s_cmp_gt_u32 s72, 30000
  s_cbranch_scc1 L_back_or00A
  s_cbranch_vccnz L_sp_or00A
  s_branch L_back_or00A
L_slow_or02A:
L_sp_or02A:
  buffer_load_dwordx4 v[204:207], v25, s[36:39], s87 offen offset:1024 sc1
  buffer_load_dwordx4 v[220:223], v25, s[36:39], s88 offen offset:1024 sc1
  buffer_load_dwordx4 v[236:239], v25, s[36:39], s89 offen offset:1024 sc1
  buffer_load_dwordx4 v[252:255], v25, s[36:39], s90 offen offset:1024 sc1
  buffer_load_dwordx4 v[32:35], v25, s[36:39], s91 offen offset:1024 sc1
  s_waitcnt vmcnt(0)
  v_max3_u32 v7, v207, v223, v239
  v_max3_u32 v7, v7, v255, v35
  v_cmp_eq_u32 vcc, -1, v7
  s_add_u32 s72, s72, 1
  s_cmp_gt_u32 s72, 30000
  s_cbranch_scc1 L_back_or02A
  s_cbranch_vccnz L_sp_or02A
  s_branch L_back_or02A
L_slow_or10A:
L_sp_or10A:
  buffer_load_dwordx4 v[180:183], v26, s[36:39], s85 offen offset:1024 sc1
  buffer_load_dwordx4 v[196:199], v26, s[36:39], s86 offen offset:1024 sc1
  buffer_load_dwordx4 v[212:215], v26, s[36:39], s87 offen offset:1024 sc1
  buffer_load_dwordx4 v[228:231], v26, s[36:39], s88 offen offset:1024 sc1
  buffer_load_dwordx4 v[244:247], v26, s[36:39], s89 offen offset:1024 sc1
  buffer_load_dwordx4 v[16:19], v26, s[36:39], s90 offen offset:1024 sc1
  buffer_load_dwordx4 v[40:43], v26, s[36:39], s91 offen offset:1024 sc1
  s_waitcnt vmcnt(0)
  v_max3_u32 v7, v183, v199, v215
  v_max3_u32 v7, v7, v231, v247
  v_max3_u32 v7, v7, v19, v43
  v_cmp_eq_u32 vcc, -1, v7
  s_add_u32 s72, s72, 1
  s_cmp_gt_u32 s72, 30000
  s_cbranch_scc1 L_back_or10A
  s_cbranch_vccnz L_sp_or10A
  s_branch L_back_or10A
L_again0A:
  s_add_u32 s64, s64, 1
  s_cmp_gt_u32 s64, 16
  s_cbranch_scc1 L_done0A
  s_waitcnt vmcnt(0) lgkmcnt(0)
  s_nop 7
  s_branch L_redoA
L_again1A:
  s_add_u32 s64, s64, 1
  s_cmp_gt_u32 s64, 16
  s_cbranch_scc1 L_done1A
  s_waitcnt vmcnt(0) lgkmcnt(0)
  s_nop 7
  s_branch L_redoA
L_last:
L_smxk0:
  s_nop 1
  v_mfma_f32_16x16x32_bf16 v[64:67], a[144:147], v[176:179], 0
  v_mfma_f32_16x16x32_bf16 v[68:71], a[156:159], v[176:179], 0
  v_mfma_f32_16x16x32_bf16 v[72:75], a[168:171], v[176:179], 0
  v_mfma_f32_16x16x32_bf16 v[76:79], a[180:183], v[176:179], 0
  v_mfma_f32_16x16x32_bf16 v[80:83], a[192:195], v[176:179], 0
  v_mfma_f32_16x16x32_bf16 v[64:67], a[148:151], v[180:183], v[64:67]
  v_mfma_f32_16x16x32_bf16 v[68:71], a[160:163], v[180:183], v[68:71]
  v_mfma_f32_16x16x32_bf16 v[72:75], a[172:175], v[180:183], v[72:75]
  v_mfma_f32_16x16x32_bf16 v[76:79], a[184:187], v[180:183], v[76:79]
  v_mfma_f32_16x16x32_bf16 v[80:83], a[196:199], v[180:183], v[80:83]
  v_mfma_f32_16x16x32_bf16 v[64:67], a[152:155], v[184:187], v[64:67]
  v_mfma_f32_16x16x32_bf16 v[68:71], a[164:167], v[184:187], v[68:71]
  v_mfma_f32_16x16x32_bf16 v[72:75], a[176:179], v[184:187], v[72:75]
  v_mfma_f32_16x16x32_bf16 v[76:79], a[188:191], v[184:187], v[76:79]
  v_mfma_f32_16x16x32_bf16 v[80:83], a[200:203], v[184:187], v[80:83]
  s_nop 3
  v_max3_f32 v162, v64, v65, v66
  v_min3_f32 v163, v64, v65, v66
  v_max3_f32 v162, v162, v67, v68
  v_min3_f32 v163, v163, v67, v68
  v_max3_f32 v162, v162, v69, v70
  v_min3_f32 v163, v163, v69, v70
  v_max3_f32 v162, v162, v71, v72
  v_min3_f32 v163, v163, v71, v72
  v_max3_f32 v162, v162, v73, v74
  v_min3_f32 v163, v163, v73, v74
  v_max3_f32 v162, v162, v75, v76
  v_min3_f32 v163, v163, v75, v76
  v_max3_f32 v162, v162, v77, v78
  v_min3_f32 v163, v163, v77, v78
  v_max3_f32 v162, v162, v79, v80
  v_min3_f32 v163, v163, v79, v80
  v_max_f32 v162, v162, v81
  v_min_f32 v163, v163, v81
  v_mul_f32 v164, s74, v162
  v_mul_f32 v165, s74, v163
  v_pk_fma_f32 v[144:145], v[64:65], s[74:75], v[164:165] op_sel:[0,0,1] op_sel_hi:[1,1,1] neg_lo:[1,0,0] neg_hi:[1,0,0]
  v_pk_fma_f32 v[64:65], v[64:65], s[74:75], v[164:165] op_sel:[0,0,0] op_sel_hi:[1,1,0] neg_lo:[0,0,1] neg_hi:[0,0,1]
  v_pk_fma_f32 v[146:147], v[66:67], s[74:75], v[164:165] op_sel:[0,0,1] op_sel_hi:[1,1,1] neg_lo:[1,0,0] neg_hi:[1,0,0]
  v_pk_fma_f32 v[66:67], v[66:67], s[74:75], v[164:165] op_sel:[0,0,0] op_sel_hi:[1,1,0] neg_lo:[0,0,1] neg_hi:[0,0,1]
  v_pk_fma_f32 v[148:149], v[68:69], s[74:75], v[164:165] op_sel:[0,0,1] op_sel_hi:[1,1,1] neg_lo:[1,0,0] neg_hi:[1,0,0]
  v_pk_fma_f32 v[68:69], v[68:69], s[74:75], v[164:165] op_sel:[0,0,0] op_sel_hi:[1,1,0] neg_lo:[0,0,1] neg_hi:[0,0,1]
  v_pk_fma_f32 v[150:151], v[70:71], s[74:75], v[164:165] op_sel:[0,0,1] op_sel_hi:[1,1,1] neg_lo:[1,0,0] neg_hi:[1,0,0]
  v_pk_fma_f32 v[70:71], v[70:71], s[74:75], v[164:165] op_sel:[0,0,0] op_sel_hi:[1,1,0] neg_lo:[0,0,1] neg_hi:[0,0,1]
  v_pk_fma_f32 v[152:153], v[72:73], s[74:75], v[164:165] op_sel:[0,0,1] op_sel_hi:[1,1,1] neg_lo:[1,0,0] neg_hi:[1,0,0]
  v_pk_fma_f32 v[72:73], v[72:73], s[74:75], v[164:165] op_sel:[0,0,0] op_sel_hi:[1,1,0] neg_lo:[0,0,1] neg_hi:[0,0,1]
  v_pk_fma_f32 v[154:155], v[74:75], s[74:75], v[164:165] op_sel:[0,0,1] op_sel_hi:[1,1,1] neg_lo:[1,0,0] neg_hi:[1,0,0]
  v_pk_fma_f32 v[74:75], v[74:75], s[74:75], v[164:165] op_sel:[0,0,0] op_sel_hi:[1,1,0] neg_lo:[0,0,1] neg_hi:[0,0,1]
  v_pk_fma_f32 v[156:157], v[76:77], s[74:75], v[164:165] op_sel:[0,0,1] op_sel_hi:[1,1,1] neg_lo:[1,0,0] neg_hi:[1,0,0]
  v_pk_fma_f32 v[76:77], v[76:77], s[74:75], v[164:165] op_sel:[0,0,0] op_sel_hi:[1,1,0] neg_lo:[0,0,1] neg_hi:[0,0,1]
  v_pk_fma_f32 v[158:159], v[78:79], s[74:75], v[164:165] op_sel:[0,0,1] op_sel_hi:[1,1,1] neg_lo:[1,0,0] neg_hi:[1,0,0]
  v_pk_fma_f32 v[78:79], v[78:79], s[74:75], v[164:165] op_sel:[0,0,0] op_sel_hi:[1,1,0] neg_lo:[0,0,1] neg_hi:[0,0,1]
  v_pk_fma_f32 v[160:161], v[80:81], s[74:75], v[164:165] op_sel:[0,0,1] op_sel_hi:[1,1,1] neg_lo:[1,0,0] neg_hi:[1,0,0]
  v_pk_fma_f32 v[80:81], v[80:81], s[74:75], v[164:165] op_sel:[0,0,0] op_sel_hi:[1,1,0] neg_lo:[0,0,1] neg_hi:[0,0,1]
  v_exp_f32 v64, v64
  v_exp_f32 v144, v144
  v_exp_f32 v65, v65
  v_exp_f32 v145, v145
  v_exp_f32 v66, v66
  v_exp_f32 v146, v146
  v_exp_f32 v67, v67
  v_exp_f32 v147, v147
  v_exp_f32 v68, v68
  v_exp_f32 v148, v148
  v_exp_f32 v69, v69
  v_exp_f32 v149, v149
  v_pk_add_f32 v[162:163], v[64:65], v[66:67]
  v_pk_add_f32 v[164:165], v[144:145], v[146:147]
  v_exp_f32 v70, v70
  v_exp_f32 v150, v150
  v_exp_f32 v71, v71
  v_exp_f32 v151, v151
  v_pk_add_f32 v[162:163], v[162:163], v[68:69]
  v_pk_add_f32 v[164:165], v[164:165], v[148:149]
  v_exp_f32 v72, v72
  v_exp_f32 v152, v152
  v_exp_f32 v73, v73
  v_exp_f32 v153, v153
  v_pk_add_f32 v[162:163], v[162:163], v[70:71]
  v_pk_add_f32 v[164:165], v[164:165], v[150:151]
  v_exp_f32 v74, v74
  v_exp_f32 v154, v154
  v_exp_f32 v75, v75
  v_exp_f32 v155, v155
  v_pk_add_f32 v[162:163], v[162:163], v[72:73]
  v_pk_add_f32 v[164:165], v[164:165], v[152:153]
  v_exp_f32 v76, v76
  v_exp_f32 v156, v156
  v_exp_f32 v77, v77
  v_exp_f32 v157, v157
  v_pk_add_f32 v[162:163], v[162:163], v[74:75]
  v_pk_add_f32 v[164:165], v[164:165], v[154:155]
  v_exp_f32 v78, v78
  v_exp_f32 v158, v158
  v_exp_f32 v79, v79
  v_exp_f32 v159, v159
  v_pk_add_f32 v[162:163], v[162:163], v[76:77]
  v_pk_add_f32 v[164:165], v[164:165], v[156:157]
  v_exp_f32 v80, v80
  v_exp_f32 v160, v160
  v_exp_f32 v81, v81
  v_exp_f32 v161, v161
  v_pk_add_f32 v[162:163], v[162:163], v[78:79]
  v_pk_add_f32 v[164:165], v[164:165], v[158:159]
  v_pk_add_f32 v[162:163], v[162:163], v[80:81]
  v_pk_add_f32 v[164:165], v[164:165], v[160:161]
  v_add_f32 v167, v164, v165
  v_add_f32 v166, v162, v163
  v_rcp_f32 v167, v167
  v_rcp_f32 v166, v166
  s_branch L_smbk0
L_smxk1:
  s_nop 1
  v_mfma_f32_16x16x32_bf16 v[84:87], a[144:147], v[188:191], 0
  v_mfma_f32_16x16x32_bf16 v[88:91], a[156:159], v[188:191], 0
  v_mfma_f32_16x16x32_bf16 v[92:95], a[168:171], v[188:191], 0
  v_mfma_f32_16x16x32_bf16 v[96:99], a[180:183], v[188:191], 0
  v_mfma_f32_16x16x32_bf16 v[100:103], a[192:195], v[188:191], 0
  v_mfma_f32_16x16x32_bf16 v[84:87], a[148:151], v[192:195], v[84:87]
  v_mfma_f32_16x16x32_bf16 v[88:91], a[160:163], v[192:195], v[88:91]
  v_mfma_f32_16x16x32_bf16 v[92:95], a[172:175], v[192:195], v[92:95]
  v_mfma_f32_16x16x32_bf16 v[96:99], a[184:187], v[192:195], v[96:99]
  v_mfma_f32_16x16x32_bf16 v[100:103], a[196:199], v[192:195], v[100:103]
  v_mfma_f32_16x16x32_bf16 v[84:87], a[152:155], v[196:199], v[84:87]
  v_mfma_f32_16x16x32_bf16 v[88:91], a[164:167], v[196:199], v[88:91]
  v_mfma_f32_16x16x32_bf16 v[92:95], a[176:179], v[196:199], v[92:95]
  v_mfma_f32_16x16x32_bf16 v[96:99], a[188:191], v[196:199], v[96:99]
  v_mfma_f32_16x16x32_bf16 v[100:103], a[200:203], v[196:199], v[100:103]
  s_nop 3
  s_nop 0
  v_max3_f32 v162, v84, v85, v86
  v_min3_f32 v163, v84, v85, v86
  v_max3_f32 v162, v162, v87, v88
  v_min3_f32 v163, v163, v87, v88
  v_max3_f32 v162, v162, v89, v90
  v_min3_f32 v163, v163, v89, v90
  v_max3_f32 v162, v162, v91, v92
  v_min3_f32 v163, v163, v91, v92
  v_max3_f32 v162, v162, v93, v94
  v_min3_f32 v163, v163, v93, v94
  v_max3_f32 v162, v162, v95, v96
  v_min3_f32 v163, v163, v95, v96
  v_max3_f32 v162, v162, v97, v98
  v_min3_f32 v163, v163, v97, v98
  v_max3_f32 v162, v162, v99, v100
  v_min3_f32 v163, v163, v99, v100
  v_max_f32 v162, v162, v101
  v_min_f32 v163, v163, v101
  v_mul_f32 v164, s74, v162
  v_mul_f32 v165, s74, v163
  v_pk_fma_f32 v[144:145], v[84:85], s[74:75], v[164:165] op_sel:[0,0,1] op_sel_hi:[1,1,1] neg_lo:[1,0,0] neg_hi:[1,0,0]
  v_pk_fma_f32 v[84:85], v[84:85], s[74:75], v[164:165] op_sel:[0,0,0] op_sel_hi:[1,1,0] neg_lo:[0,0,1] neg_hi:[0,0,1]
  v_pk_fma_f32 v[146:147], v[86:87], s[74:75], v[164:165] op_sel:[0,0,1] op_sel_hi:[1,1,1] neg_lo:[1,0,0] neg_hi:[1,0,0]
  v_pk_fma_f32 v[86:87], v[86:87], s[74:75], v[164:165] op_sel:[0,0,0] op_sel_hi:[1,1,0] neg_lo:[0,0,1] neg_hi:[0,0,1]
  v_pk_fma_f32 v[148:149], v[88:89], s[74:75], v[164:165] op_sel:[0,0,1] op_sel_hi:[1,1,1] neg_lo:[1,0,0] neg_hi:[1,0,0]
  v_pk_fma_f32 v[88:89], v[88:89], s[74:75], v[164:165] op_sel:[0,0,0] op_sel_hi:[1,1,0] neg_lo:[0,0,1] neg_hi:[0,0,1]
  v_pk_fma_f32 v[150:151], v[90:91], s[74:75], v[164:165] op_sel:[0,0,1] op_sel_hi:[1,1,1] neg_lo:[1,0,0] neg_hi:[1,0,0]
  v_pk_fma_f32 v[90:91], v[90:91], s[74:75], v[164:165] op_sel:[0,0,0] op_sel_hi:[1,1,0] neg_lo:[0,0,1] neg_hi:[0,0,1]
  v_pk_fma_f32 v[152:153], v[92:93], s[74:75], v[164:165] op_sel:[0,0,1] op_sel_hi:[1,1,1] neg_lo:[1,0,0] neg_hi:[1,0,0]
  v_pk_fma_f32 v[92:93], v[92:93], s[74:75], v[164:165] op_sel:[0,0,0] op_sel_hi:[1,1,0] neg_lo:[0,0,1] neg_hi:[0,0,1]
  v_pk_fma_f32 v[154:155], v[94:95], s[74:75], v[164:165] op_sel:[0,0,1] op_sel_hi:[1,1,1] neg_lo:[1,0,0] neg_hi:[1,0,0]
  v_pk_fma_f32 v[94:95], v[94:95], s[74:75], v[164:165] op_sel:[0,0,0] op_sel_hi:[1,1,0] neg_lo:[0,0,1] neg_hi:[0,0,1]
  v_pk_fma_f32 v[156:157], v[96:97], s[74:75], v[164:165] op_sel:[0,0,1] op_sel_hi:[1,1,1] neg_lo:[1,0,0] neg_hi:[1,0,0]
  v_pk_fma_f32 v[96:97], v[96:97], s[74:75], v[164:165] op_sel:[0,0,0] op_sel_hi:[1,1,0] neg_lo:[0,0,1] neg_hi:[0,0,1]
  v_pk_fma_f32 v[158:159], v[98:99], s[74:75], v[164:165] op_sel:[0,0,1] op_sel_hi:[1,1,1] neg_lo:[1,0,0] neg_hi:[1,0,0]
  v_pk_fma_f32 v[98:99], v[98:99], s[74:75], v[164:165] op_sel:[0,0,0] op_sel_hi:[1,1,0] neg_lo:[0,0,1] neg_hi:[0,0,1]
  v_pk_fma_f32 v[160:161], v[100:101], s[74:75], v[164:165] op_sel:[0,0,1] op_sel_hi:[1,1,1] neg_lo:[1,0,0] neg_hi:[1,0,0]
  v_pk_fma_f32 v[100:101], v[100:101], s[74:75], v[164:165] op_sel:[0,0,0] op_sel_hi:[1,1,0] neg_lo:[0,0,1] neg_hi:[0,0,1]
  v_exp_f32 v84, v84
  v_exp_f32 v144, v144
  v_exp_f32 v85, v85
  v_exp_f32 v145, v145
  v_exp_f32 v86, v86
  v_exp_f32 v146, v146
  v_exp_f32 v87, v87
  v_exp_f32 v147, v147
  v_exp_f32 v88, v88
  v_exp_f32 v148, v148
  v_exp_f32 v89, v89
  v_exp_f32 v149, v149
  v_pk_add_f32 v[162:163], v[84:85], v[86:87]
  v_pk_add_f32 v[164:165], v[144:145], v[146:147]
  v_exp_f32 v90, v90
  v_exp_f32 v150, v150
  v_exp_f32 v91, v91
  v_exp_f32 v151, v151
  v_pk_add_f32 v[162:163], v[162:163], v[88:89]
  v_pk_add_f32 v[164:165], v[164:165], v[148:149]
  v_exp_f32 v92, v92
  v_exp_f32 v152, v152
  v_exp_f32 v93, v93
  v_exp_f32 v153, v153
  v_pk_add_f32 v[162:163], v[162:163], v[90:91]
  v_pk_add_f32 v[164:165], v[164:165], v[150:151]
  v_exp_f32 v94, v94
  v_exp_f32 v154, v154
  v_exp_f32 v95, v95
  v_exp_f32 v155, v155
  v_pk_add_f32 v[162:163], v[162:163], v[92:93]
  v_pk_add_f32 v[164:165], v[164:165], v[152:153]
  v_exp_f32 v96, v96
  v_exp_f32 v156, v156
  v_exp_f32 v97, v97
  v_exp_f32 v157, v157
  v_pk_add_f32 v[162:163], v[162:163], v[94:95]
  v_pk_add_f32 v[164:165], v[164:165], v[154:155]
  v_exp_f32 v98, v98
  v_exp_f32 v158, v158
  v_exp_f32 v99, v99
  v_exp_f32 v159, v159
  v_pk_add_f32 v[162:163], v[162:163], v[96:97]
  v_pk_add_f32 v[164:165], v[164:165], v[156:157]
  v_exp_f32 v100, v100
  v_exp_f32 v160, v160
  v_exp_f32 v101, v101
  v_exp_f32 v161, v161
  v_pk_add_f32 v[162:163], v[162:163], v[98:99]
  v_pk_add_f32 v[164:165], v[164:165], v[158:159]
  v_pk_add_f32 v[162:163], v[162:163], v[100:101]
  v_pk_add_f32 v[164:165], v[164:165], v[160:161]
  v_add_f32 v167, v164, v165
  v_add_f32 v166, v162, v163
  v_rcp_f32 v167, v167
  v_rcp_f32 v166, v166
  s_branch L_smbk1
L_smxq0:
  s_nop 1
  v_mfma_f32_16x16x32_bf16 v[64:67], a[144:147], v[176:179], 0
  v_mfma_f32_16x16x32_bf16 v[68:71], a[156:159], v[176:179], 0
  v_mfma_f32_16x16x32_bf16 v[72:75], a[168:171], v[176:179], 0
  v_mfma_f32_16x16x32_bf16 v[76:79], a[180:183], v[176:179], 0
  v_mfma_f32_16x16x32_bf16 v[80:83], a[192:195], v[176:179], 0
  v_mfma_f32_16x16x32_bf16 v[64:67], a[148:151], v[180:183], v[64:67]
  v_mfma_f32_16x16x32_bf16 v[68:71], a[160:163], v[180:183], v[68:71]
  v_mfma_f32_16x16x32_bf16 v[72:75], a[172:175], v[180:183], v[72:75]
  v_mfma_f32_16x16x32_bf16 v[76:79], a[184:187], v[180:183], v[76:79]
  v_mfma_f32_16x16x32_bf16 v[80:83], a[196:199], v[180:183], v[80:83]
  v_mfma_f32_16x16x32_bf16 v[64:67], a[152:155], v[184:187], v[64:67]
  v_mfma_f32_16x16x32_bf16 v[68:71], a[164:167], v[184:187], v[68:71]
  v_mfma_f32_16x16x32_bf16 v[72:75], a[176:179], v[184:187], v[72:75]
  v_mfma_f32_16x16x32_bf16 v[76:79], a[188:191], v[184:187], v[76:79]
  v_mfma_f32_16x16x32_bf16 v[80:83], a[200:203], v[184:187], v[80:83]
  s_nop 3
  s_nop 0
  v_max3_f32 v162, v64, v65, v66
  v_min3_f32 v163, v64, v65, v66
  v_max3_f32 v162, v162, v67, v68
  v_min3_f32 v163, v163, v67, v68
  v_max3_f32 v162, v162, v69, v70
  v_min3_f32 v163, v163, v69, v70
  v_max3_f32 v162, v162, v71, v72
  v_min3_f32 v163, v163, v71, v72
  v_max3_f32 v162, v162, v73, v74
  v_min3_f32 v163, v163, v73, v74
  v_max3_f32 v162, v162, v75, v76
  v_min3_f32 v163, v163, v75, v76
  v_max3_f32 v162, v162, v77, v78
  v_min3_f32 v163, v163, v77, v78
  v_max3_f32 v162, v162, v79, v80
  v_min3_f32 v163, v163, v79, v80
  v_max_f32 v162, v162, v81
  v_min_f32 v163, v163, v81
  v_mul_f32 v164, s74, v162
  v_mul_f32 v165, s74, v163
  v_pk_fma_f32 v[144:145], v[64:65], s[74:75], v[164:165] op_sel:[0,0,1] op_sel_hi:[1,1,1] neg_lo:[1,0,0] neg_hi:[1,0,0]
  v_pk_fma_f32 v[64:65], v[64:65], s[74:75], v[164:165] op_sel:[0,0,0] op_sel_hi:[1,1,0] neg_lo:[0,0,1] neg_hi:[0,0,1]
  v_pk_fma_f32 v[146:147], v[66:67], s[74:75], v[164:165] op_sel:[0,0,1] op_sel_hi:[1,1,1] neg_lo:[1,0,0] neg_hi:[1,0,0]
  v_pk_fma_f32 v[66:67], v[66:67], s[74:75], v[164:165] op_sel:[0,0,0] op_sel_hi:[1,1,0] neg_lo:[0,0,1] neg_hi:[0,0,1]
  v_pk_fma_f32 v[148:149], v[68:69], s[74:75], v[164:165] op_sel:[0,0,1] op_sel_hi:[1,1,1] neg_lo:[1,0,0] neg_hi:[1,0,0]
  v_pk_fma_f32 v[68:69], v[68:69], s[74:75], v[164:165] op_sel:[0,0,0] op_sel_hi:[1,1,0] neg_lo:[0,0,1] neg_hi:[0,0,1]
  v_pk_fma_f32 v[150:151], v[70:71], s[74:75], v[164:165] op_sel:[0,0,1] op_sel_hi:[1,1,1] neg_lo:[1,0,0] neg_hi:[1,0,0]
  v_pk_fma_f32 v[70:71], v[70:71], s[74:75], v[164:165] op_sel:[0,0,0] op_sel_hi:[1,1,0] neg_lo:[0,0,1] neg_hi:[0,0,1]
  v_pk_fma_f32 v[152:153], v[72:73], s[74:75], v[164:165] op_sel:[0,0,1] op_sel_hi:[1,1,1] neg_lo:[1,0,0] neg_hi:[1,0,0]
  v_pk_fma_f32 v[72:73], v[72:73], s[74:75], v[164:165] op_sel:[0,0,0] op_sel_hi:[1,1,0] neg_lo:[0,0,1] neg_hi:[0,0,1]
  v_pk_fma_f32 v[154:155], v[74:75], s[74:75], v[164:165] op_sel:[0,0,1] op_sel_hi:[1,1,1] neg_lo:[1,0,0] neg_hi:[1,0,0]
  v_pk_fma_f32 v[74:75], v[74:75], s[74:75], v[164:165] op_sel:[0,0,0] op_sel_hi:[1,1,0] neg_lo:[0,0,1] neg_hi:[0,0,1]
  v_pk_fma_f32 v[156:157], v[76:77], s[74:75], v[164:165] op_sel:[0,0,1] op_sel_hi:[1,1,1] neg_lo:[1,0,0] neg_hi:[1,0,0]
  v_pk_fma_f32 v[76:77], v[76:77], s[74:75], v[164:165] op_sel:[0,0,0] op_sel_hi:[1,1,0] neg_lo:[0,0,1] neg_hi:[0,0,1]
  v_pk_fma_f32 v[158:159], v[78:79], s[74:75], v[164:165] op_sel:[0,0,1] op_sel_hi:[1,1,1] neg_lo:[1,0,0] neg_hi:[1,0,0]
  v_pk_fma_f32 v[78:79], v[78:79], s[74:75], v[164:165] op_sel:[0,0,0] op_sel_hi:[1,1,0] neg_lo:[0,0,1] neg_hi:[0,0,1]
  v_pk_fma_f32 v[160:161], v[80:81], s[74:75], v[164:165] op_sel:[0,0,1] op_sel_hi:[1,1,1] neg_lo:[1,0,0] neg_hi:[1,0,0]
  v_pk_fma_f32 v[80:81], v[80:81], s[74:75], v[164:165] op_sel:[0,0,0] op_sel_hi:[1,1,0] neg_lo:[0,0,1] neg_hi:[0,0,1]
  v_exp_f32 v64, v64
  v_exp_f32 v144, v144
  v_exp_f32 v65, v65
  v_exp_f32 v145, v145
  v_exp_f32 v66, v66
  v_exp_f32 v146, v146
  v_exp_f32 v67, v67
  v_exp_f32 v147, v147
  v_exp_f32 v68, v68
  v_exp_f32 v148, v148
  v_exp_f32 v69, v69
  v_exp_f32 v149, v149
  v_pk_add_f32 v[162:163], v[64:65], v[66:67]
  v_pk_add_f32 v[164:165], v[144:145], v[146:147]
  v_exp_f32 v70, v70
  v_exp_f32 v150, v150
  v_exp_f32 v71, v71
  v_exp_f32 v151, v151
  v_pk_add_f32 v[162:163], v[162:163], v[68:69]
  v_pk_add_f32 v[164:165], v[164:165], v[148:149]
  v_exp_f32 v72, v72
  v_exp_f32 v152, v152
  v_exp_f32 v73, v73
  v_exp_f32 v153, v153
  v_pk_add_f32 v[162:163], v[162:163], v[70:71]
  v_pk_add_f32 v[164:165], v[164:165], v[150:151]
  v_exp_f32 v74, v74
  v_exp_f32 v154, v154
  v_exp_f32 v75, v75
  v_exp_f32 v155, v155
  v_pk_add_f32 v[162:163], v[162:163], v[72:73]
  v_pk_add_f32 v[164:165], v[164:165], v[152:153]
  v_exp_f32 v76, v76
  v_exp_f32 v156, v156
  v_exp_f32 v77, v77
  v_exp_f32 v157, v157
  v_pk_add_f32 v[162:163], v[162:163], v[74:75]
  v_pk_add_f32 v[164:165], v[164:165], v[154:155]
  v_exp_f32 v78, v78
  v_exp_f32 v158, v158
  v_exp_f32 v79, v79
  v_exp_f32 v159, v159
  v_pk_add_f32 v[162:163], v[162:163], v[76:77]
  v_pk_add_f32 v[164:165], v[164:165], v[156:157]
  v_exp_f32 v80, v80
  v_exp_f32 v160, v160
  v_exp_f32 v81, v81
  v_exp_f32 v161, v161
  v_pk_add_f32 v[162:163], v[162:163], v[78:79]
  v_pk_add_f32 v[164:165], v[164:165], v[158:159]
  v_pk_add_f32 v[162:163], v[162:163], v[80:81]
  v_pk_add_f32 v[164:165], v[164:165], v[160:161]
  v_add_f32 v167, v164, v165
  v_add_f32 v166, v162, v163
  v_rcp_f32 v167, v167
  v_rcp_f32 v166, v166
  s_branch L_smbq0
L_smxq1:
  s_nop 1
  v_mfma_f32_16x16x32_bf16 v[84:87], a[144:147], v[188:191], 0
  v_mfma_f32_16x16x32_bf16 v[88:91], a[156:159], v[188:191], 0
  v_mfma_f32_16x16x32_bf16 v[92:95], a[168:171], v[188:191], 0
  v_mfma_f32_16x16x32_bf16 v[96:99], a[180:183], v[188:191], 0
  v_mfma_f32_16x16x32_bf16 v[100:103], a[192:195], v[188:191], 0
  v_mfma_f32_16x16x32_bf16 v[84:87], a[148:151], v[192:195], v[84:87]
  v_mfma_f32_16x16x32_bf16 v[88:91], a[160:163], v[192:195], v[88:91]
  v_mfma_f32_16x16x32_bf16 v[92:95], a[172:175], v[192:195], v[92:95]
  v_mfma_f32_16x16x32_bf16 v[96:99], a[184:187], v[192:195], v[96:99]
  v_mfma_f32_16x16x32_bf16 v[100:103], a[196:199], v[192:195], v[100:103]
  v_mfma_f32_16x16x32_bf16 v[84:87], a[152:155], v[196:199], v[84:87]
  v_mfma_f32_16x16x32_bf16 v[88:91], a[164:167], v[196:199], v[88:91]
  v_mfma_f32_16x16x32_bf16 v[92:95], a[176:179], v[196:199], v[92:95]
  v_mfma_f32_16x16x32_bf16 v[96:99], a[188:191], v[196:199], v[96:99]
  v_mfma_f32_16x16x32_bf16 v[100:103], a[200:203], v[196:199], v[100:103]
  s_nop 3
  s_nop 0
  v_max3_f32 v162, v84, v85, v86
  v_min3_f32 v163, v84, v85, v86
  v_max3_f32 v162, v162, v87, v88
  v_min3_f32 v163, v163, v87, v88
  v_max3_f32 v162, v162, v89, v90
  v_min3_f32 v163, v163, v89, v90
  v_max3_f32 v162, v162, v91, v92
  v_min3_f32 v163, v163, v91, v92
  v_max3_f32 v162, v162, v93, v94
  v_min3_f32 v163, v163, v93, v94
  v_max3_f32 v162, v162, v95, v96
  v_min3_f32 v163, v163, v95, v96
  v_max3_f32 v162, v162, v97, v98
  v_min3_f32 v163, v163, v97, v98
  v_max3_f32 v162, v162, v99, v100
  v_min3_f32 v163, v163, v99, v100
  v_max_f32 v162, v162, v101
  v_min_f32 v163, v163, v101
  v_mul_f32 v164, s74, v162
  v_mul_f32 v165, s74, v163
  v_pk_fma_f32 v[144:145], v[84:85], s[74:75], v[164:165] op_sel:[0,0,1] op_sel_hi:[1,1,1] neg_lo:[1,0,0] neg_hi:[1,0,0]
  v_pk_fma_f32 v[84:85], v[84:85], s[74:75], v[164:165] op_sel:[0,0,0] op_sel_hi:[1,1,0] neg_lo:[0,0,1] neg_hi:[0,0,1]
  v_pk_fma_f32 v[146:147], v[86:87], s[74:75], v[164:165] op_sel:[0,0,1] op_sel_hi:[1,1,1] neg_lo:[1,0,0] neg_hi:[1,0,0]
  v_pk_fma_f32 v[86:87], v[86:87], s[74:75], v[164:165] op_sel:[0,0,0] op_sel_hi:[1,1,0] neg_lo:[0,0,1] neg_hi:[0,0,1]
  v_pk_fma_f32 v[148:149], v[88:89], s[74:75], v[164:165] op_sel:[0,0,1] op_sel_hi:[1,1,1] neg_lo:[1,0,0] neg_hi:[1,0,0]
  v_pk_fma_f32 v[88:89], v[88:89], s[74:75], v[164:165] op_sel:[0,0,0] op_sel_hi:[1,1,0] neg_lo:[0,0,1] neg_hi:[0,0,1]
  v_pk_fma_f32 v[150:151], v[90:91], s[74:75], v[164:165] op_sel:[0,0,1] op_sel_hi:[1,1,1] neg_lo:[1,0,0] neg_hi:[1,0,0]
  v_pk_fma_f32 v[90:91], v[90:91], s[74:75], v[164:165] op_sel:[0,0,0] op_sel_hi:[1,1,0] neg_lo:[0,0,1] neg_hi:[0,0,1]
  v_pk_fma_f32 v[152:153], v[92:93], s[74:75], v[164:165] op_sel:[0,0,1] op_sel_hi:[1,1,1] neg_lo:[1,0,0] neg_hi:[1,0,0]
  v_pk_fma_f32 v[92:93], v[92:93], s[74:75], v[164:165] op_sel:[0,0,0] op_sel_hi:[1,1,0] neg_lo:[0,0,1] neg_hi:[0,0,1]
  v_pk_fma_f32 v[154:155], v[94:95], s[74:75], v[164:165] op_sel:[0,0,1] op_sel_hi:[1,1,1] neg_lo:[1,0,0] neg_hi:[1,0,0]
  v_pk_fma_f32 v[94:95], v[94:95], s[74:75], v[164:165] op_sel:[0,0,0] op_sel_hi:[1,1,0] neg_lo:[0,0,1] neg_hi:[0,0,1]
  v_pk_fma_f32 v[156:157], v[96:97], s[74:75], v[164:165] op_sel:[0,0,1] op_sel_hi:[1,1,1] neg_lo:[1,0,0] neg_hi:[1,0,0]
  v_pk_fma_f32 v[96:97], v[96:97], s[74:75], v[164:165] op_sel:[0,0,0] op_sel_hi:[1,1,0] neg_lo:[0,0,1] neg_hi:[0,0,1]
  v_pk_fma_f32 v[158:159], v[98:99], s[74:75], v[164:165] op_sel:[0,0,1] op_sel_hi:[1,1,1] neg_lo:[1,0,0] neg_hi:[1,0,0]
  v_pk_fma_f32 v[98:99], v[98:99], s[74:75], v[164:165] op_sel:[0,0,0] op_sel_hi:[1,1,0] neg_lo:[0,0,1] neg_hi:[0,0,1]
  v_pk_fma_f32 v[160:161], v[100:101], s[74:75], v[164:165] op_sel:[0,0,1] op_sel_hi:[1,1,1] neg_lo:[1,0,0] neg_hi:[1,0,0]
  v_pk_fma_f32 v[100:101], v[100:101], s[74:75], v[164:165] op_sel:[0,0,0] op_sel_hi:[1,1,0] neg_lo:[0,0,1] neg_hi:[0,0,1]
  v_exp_f32 v84, v84
  v_exp_f32 v144, v144
  v_exp_f32 v85, v85
  v_exp_f32 v145, v145
  v_exp_f32 v86, v86
  v_exp_f32 v146, v146
  v_exp_f32 v87, v87
  v_exp_f32 v147, v147
  v_exp_f32 v88, v88
  v_exp_f32 v148, v148
  v_exp_f32 v89, v89
  v_exp_f32 v149, v149
  v_pk_add_f32 v[162:163], v[84:85], v[86:87]
  v_pk_add_f32 v[164:165], v[144:145], v[146:147]
  v_exp_f32 v90, v90
  v_exp_f32 v150, v150
  v_exp_f32 v91, v91
  v_exp_f32 v151, v151
  v_pk_add_f32 v[162:163], v[162:163], v[88:89]
  v_pk_add_f32 v[164:165], v[164:165], v[148:149]
  v_exp_f32 v92, v92
  v_exp_f32 v152, v152
  v_exp_f32 v93, v93
  v_exp_f32 v153, v153
  v_pk_add_f32 v[162:163], v[162:163], v[90:91]
  v_pk_add_f32 v[164:165], v[164:165], v[150:151]
  v_exp_f32 v94, v94
  v_exp_f32 v154, v154
  v_exp_f32 v95, v95
  v_exp_f32 v155, v155
  v_pk_add_f32 v[162:163], v[162:163], v[92:93]
  v_pk_add_f32 v[164:165], v[164:165], v[152:153]
  v_exp_f32 v96, v96
  v_exp_f32 v156, v156
  v_exp_f32 v97, v97
  v_exp_f32 v157, v157
  v_pk_add_f32 v[162:163], v[162:163], v[94:95]
  v_pk_add_f32 v[164:165], v[164:165], v[154:155]
  v_exp_f32 v98, v98
  v_exp_f32 v158, v158
  v_exp_f32 v99, v99
  v_exp_f32 v159, v159
  v_pk_add_f32 v[162:163], v[162:163], v[96:97]
  v_pk_add_f32 v[164:165], v[164:165], v[156:157]
  v_exp_f32 v100, v100
  v_exp_f32 v160, v160
  v_exp_f32 v101, v101
  v_exp_f32 v161, v161
  v_pk_add_f32 v[162:163], v[162:163], v[98:99]
  v_pk_add_f32 v[164:165], v[164:165], v[158:159]
  v_pk_add_f32 v[162:163], v[162:163], v[100:101]
  v_pk_add_f32 v[164:165], v[164:165], v[160:161]
  v_add_f32 v167, v164, v165
  v_add_f32 v166, v162, v163
  v_rcp_f32 v167, v167
  v_rcp_f32 v166, v166
  s_branch L_smbq1
.set L_thA00, L_tp0
.set L_thA01, L_tp1
.set L_thA02, L_tp6
.set L_thA03, L_tp7
.set L_thA10, L_tp8
.set L_thA11, L_tp9
.set L_thA12, L_tret1
.set L_thA13, L_tret1
.set L_thB00, L_tp0
.set L_thB01, L_tp1
.set L_thB02, L_tp2
.set L_thB03, L_tp3
.set L_thB10, L_tp4
.set L_thB11, L_tp5
.set L_thB12, L_tret1
.set L_thB13, L_tret1

.section .rodata,"a"
.p2align 6
.amdhsa_kernel concat_heads__linear_attn_block__linear_kernel_hedgehog__prompt_kernel
  .amdhsa_next_free_vgpr 512
  .amdhsa_next_free_sgpr 102
  .amdhsa_accum_offset 256
  .amdhsa_group_segment_fixed_size 0
  .amdhsa_kernarg_size 80
  .amdhsa_user_sgpr_count 2
  .amdhsa_user_sgpr_kernarg_segment_ptr 1
  .amdhsa_system_sgpr_workgroup_id_x 1
.end_amdhsa_kernel
```
